```python
import torch

def _softmax(x, axis=-1):
    return torch.softmax(x, dim=axis)

def _gelu(x):
    return torch.nn.functional.gelu(x, approximate='tanh')

def _silu(x):
    return torch.nn.functional.silu(x)

def _sigmoid(x):
    return torch.sigmoid(x)

def _layernorm(x, axis=-1, eps=1e-05):
    m = x.mean(dim=axis, keepdim=True)
    v = x.var(dim=axis, keepdim=True, unbiased=False)
    return (x - m) / torch.sqrt(v + eps)

def _scatter_add(tgt, idx, src, axis=0):
    return tgt.clone().index_add_(axis, idx, src)

def _segment_sum(src, seg, n):
    out = torch.zeros((n,) + src.shape[1:], dtype=src.dtype)
    return out.index_add_(0, seg, src)

def _pad(x, pw):
    flat = tuple((v for pair in reversed(pw) for v in pair))
    return torch.nn.functional.pad(x, flat)
kernel_name = 'adaLN_cond__mha_block__glu_gated_glu__prompt'

def setup_inputs():

    _w = lambda a: (lambda t: t.to(torch.bfloat16) if t.is_floating_point() else t)(torch.as_tensor(a))

    def _A_setup():
        B, S, D, H = (1, 2048, 640, 32)
        return {'x': _w((lambda *s: torch.randn(*s, dtype=torch.bfloat16) * 0.05)(B, S, D)), 'wqkv': _w((lambda *s: torch.randn(*s, dtype=torch.bfloat16) * 0.05)(D, 3 * D)), 'wo': _w((lambda *s: torch.randn(*s, dtype=torch.bfloat16) * 0.05)(D, D))}
    _A_in = _A_setup()

    def _B_setup():
        B, S, D, F = (1, 2048, 640, 1536)
        return {'x': _w((lambda *s: torch.randn(*s, dtype=torch.bfloat16) * 0.05)(B, S, D)), 'w_gate': _w((lambda *s: torch.randn(*s, dtype=torch.bfloat16) * 0.05)(D, F)), 'w_up': _w((lambda *s: torch.randn(*s, dtype=torch.bfloat16) * 0.05)(D, F)), 'w_down': _w((lambda *s: torch.randn(*s, dtype=torch.bfloat16) * 0.05)(F, D))}
    _B_in = _B_setup()
    return {'A_x': _A_in['x'], 'A_wqkv': _A_in['wqkv'], 'A_wo': _A_in['wo'], 'B_x': _B_in['x'], 'B_w_gate': _B_in['w_gate'], 'B_w_up': _B_in['w_up'], 'B_w_down': _B_in['w_down'], 'c': _w((lambda *s: torch.randn(*s, dtype=torch.bfloat16) * 0.1)(1, 640) * 8.0), 'w_mod': _w((lambda *s: torch.randn(*s, dtype=torch.bfloat16) * 0.1)(640, 6 * 640) * 640 ** (-0.5) * 8.0)}

def reference(A_x, A_wqkv, A_wo, B_x, B_w_gate, B_w_up, B_w_down, c, w_mod):

    def _A_ref(x, wqkv, wo):
        B, S, D = x.shape
        H = 32
        Dh = D // H
        qkv = (lambda x, *d: x.permute(*d))((x @ wqkv).reshape(B, S, 3, H, Dh), 2, 0, 3, 1, 4)
        q, k, v = (qkv[0], qkv[1], qkv[2])
        scores = torch.einsum('bhqd,bhkd->bhqk', q, k) * Dh ** (-0.5)
        p = _softmax(scores, axis=-1)
        o = torch.einsum('bhqk,bhkd->bhqd', p, v)
        return (lambda x, *d: x.permute(*d))(o, 0, 2, 1, 3).reshape(B, S, D) @ wo

    def _B_ref(x, w_gate, w_up, w_down):
        g = torch.einsum('bsd,df->bsf', x, w_gate)
        u = torch.einsum('bsd,df->bsf', x, w_up)
        h = _sigmoid(g) * u
        return torch.einsum('bsf,fd->bsd', h, w_down)
    x = A_x
    mod = (_silu(c) @ w_mod).reshape(c.shape[0], 6, 1, -1)
    sa, ca, ga, sb, cb, gb = (mod[:, 0].clone(), mod[:, 1].clone(), mod[:, 2].clone(), mod[:, 3].clone(), mod[:, 4].clone(), mod[:, 5].clone())
    h = _layernorm(x, axis=-1) * (1 + ca) + sa
    x = x + ga * _A_ref(h, A_wqkv, A_wo)
    h = _layernorm(x, axis=-1) * (1 + cb) + sb
    x = x + gb * _B_ref(h, B_w_gate, B_w_up, B_w_down)
    return x
```

```asm
; @launch grid=(256,1,1) block=(512,1,1) lds=163840
.amdgcn_target "amdgcn-amd-amdhsa--gfx950"
.text
.globl adaLN_cond__mha_block__glu_gated_glu__prompt_kernel
.p2align 8
.type adaLN_cond__mha_block__glu_gated_glu__prompt_kernel,@function
adaLN_cond__mha_block__glu_gated_glu__prompt_kernel:
  s_cmp_ge_u32 s2, 256
  s_cbranch_scc1 adaLN_cond__mha_block__glu_gated_glu__prompt_end1
  s_load_dwordx16 s[16:31], s[0:1], 0
  s_load_dwordx8 s[32:39], s[0:1], 64
  v_and_b32 v1, 63, v0
  v_lshrrev_b32 v2, 6, v0
  s_nop 0
  v_readfirstlane_b32 s12, v2
  s_and_b32 s13, s2, 7
  s_lshr_b32 s14, s2, 3
  s_and_b32 s48, s14, 3
  s_lshr_b32 s49, s13, 1
  s_lshl_b32 s49, s49, 2
  s_add_u32 s15, s49, s48
  s_lshr_b32 s48, s14, 2
  s_and_b32 s49, s13, 1
  s_lshl_b32 s49, s49, 3
  s_add_u32 s4, s49, s48
  s_mul_i32 s48, s4, 209716
  s_lshr_b32 s48, s48, 20
  s_mul_i32 s48, s48, 5
  s_sub_u32 s5, s4, s48
  s_waitcnt lgkmcnt(0)
  s_mov_b32 s8, s38
  s_mov_b32 s9, s39
  s_mov_b32 s10, 0x1ba7000
  s_mov_b32 s11, 0x20000
  s_cmp_lg_u32 s2, 255
  s_cbranch_scc1 adaLN_cond__mha_block__glu_gated_glu__prompt_noinit2
  v_mov_b32 v4, 0
  v_mov_b32 v5, 0
  v_mov_b32 v6, 0
  v_mov_b32 v7, 0
  v_lshlrev_b32 v8, 4, v1
  s_mul_i32 s48, s12, 11264
  s_add_u32 s48, s48, 0
  buffer_store_dwordx4 v[4:7], v8, s[8:11], s48 offen sc0 sc1
  s_add_u32 s48, s48, 1024
  buffer_store_dwordx4 v[4:7], v8, s[8:11], s48 offen sc0 sc1
  s_add_u32 s48, s48, 1024
  buffer_store_dwordx4 v[4:7], v8, s[8:11], s48 offen sc0 sc1
  s_add_u32 s48, s48, 1024
  buffer_store_dwordx4 v[4:7], v8, s[8:11], s48 offen sc0 sc1
  s_add_u32 s48, s48, 1024
  buffer_store_dwordx4 v[4:7], v8, s[8:11], s48 offen sc0 sc1
  s_add_u32 s48, s48, 1024
  buffer_store_dwordx4 v[4:7], v8, s[8:11], s48 offen sc0 sc1
  s_add_u32 s48, s48, 1024
  buffer_store_dwordx4 v[4:7], v8, s[8:11], s48 offen sc0 sc1
  s_add_u32 s48, s48, 1024
  buffer_store_dwordx4 v[4:7], v8, s[8:11], s48 offen sc0 sc1
  s_add_u32 s48, s48, 1024
  buffer_store_dwordx4 v[4:7], v8, s[8:11], s48 offen sc0 sc1
  s_add_u32 s48, s48, 1024
  buffer_store_dwordx4 v[4:7], v8, s[8:11], s48 offen sc0 sc1
  s_add_u32 s48, s48, 1024
  buffer_store_dwordx4 v[4:7], v8, s[8:11], s48 offen sc0 sc1
  s_add_u32 s48, s48, 1024
  s_waitcnt vmcnt(0)
  s_barrier
  s_cmp_lg_u32 s12, 0
  s_cbranch_scc1 adaLN_cond__mha_block__glu_gated_glu__prompt_noinit2
  s_mov_b32 s44, s36
  s_mov_b32 s45, s37
  s_mov_b32 s46, 0x100
  s_mov_b32 s47, 0x20000
  v_mov_b32 v4, 1
  v_mov_b32 v5, 0
  s_mov_b64 exec, 1
  buffer_store_dword v4, v5, s[44:47], 0 offen offset:4 sc0 sc1
  s_mov_b64 exec, -1
adaLN_cond__mha_block__glu_gated_glu__prompt_noinit2:
  s_cmp_lg_u32 s12, 0
  s_cbranch_scc1 adaLN_cond__mha_block__glu_gated_glu__prompt_nomacc3
  v_mov_b32 v2, 0
  v_lshlrev_b32 v3, 2, v1
  v_add_u32 v3, 162304, v3
  ds_write_b32 v3, v2
  ds_write_b32 v3, v2 offset:256
  s_waitcnt lgkmcnt(0)
adaLN_cond__mha_block__glu_gated_glu__prompt_nomacc3:
  s_barrier
  s_cmp_ge_u32 s12, 4
  s_cbranch_scc1 adaLN_cond__mha_block__glu_gated_glu__prompt_prod014
  s_cmp_ge_u32 s2, 80
  s_cbranch_scc1 adaLN_cond__mha_block__glu_gated_glu__prompt_nomod6
  s_mul_i32 s52, s2, 52429
  s_lshr_b32 s52, s52, 20
  s_mul_i32 s53, s52, 20
  s_sub_u32 s53, s2, s53
  s_mov_b32 s40, s32
  s_mov_b32 s41, s33
  s_mov_b32 s42, 0x4b0000
  s_mov_b32 s43, 0x20000
  s_mov_b32 s44, s30
  s_mov_b32 s45, s31
  s_mov_b32 s46, 0x500
  s_mov_b32 s47, 0x20000
  v_lshrrev_b32 v3, 3, v1
  v_and_b32 v4, 7, v1
  s_mul_i32 s54, s52, 160
  s_mul_i32 s55, s12, 40
  s_add_u32 s54, s54, s55
  v_add_u32 v5, s54, v3
  s_movk_i32 s55, 7680
  v_mul_u32_u24 v6, s55, v5
  s_lshl_b32 s56, s53, 7
  v_lshlrev_b32 v7, 4, v4
  v_add3_u32 v6, v6, v7, s56
  v_lshlrev_b32 v8, 1, v5
  s_mov_b32 s57, 0
  buffer_load_dwordx4 v[16:19], v6, s[40:43], s57 offen nt
  s_mov_b32 s57, 61440
  buffer_load_dwordx4 v[20:23], v6, s[40:43], s57 offen nt
  s_mov_b32 s57, 122880
  buffer_load_dwordx4 v[24:27], v6, s[40:43], s57 offen nt
  s_mov_b32 s57, 184320
  buffer_load_dwordx4 v[28:31], v6, s[40:43], s57 offen nt
  s_mov_b32 s57, 245760
  buffer_load_dwordx4 v[32:35], v6, s[40:43], s57 offen nt
  buffer_load_ushort v36, v8, s[44:47], 0 offen offset:0
  buffer_load_ushort v37, v8, s[44:47], 0 offen offset:16
  buffer_load_ushort v38, v8, s[44:47], 0 offen offset:32
  buffer_load_ushort v39, v8, s[44:47], 0 offen offset:48
  buffer_load_ushort v40, v8, s[44:47], 0 offen offset:64
  s_waitcnt vmcnt(0)
  v_mov_b32 v44, 0
  v_mov_b32 v45, 0
  v_mov_b32 v46, 0
  v_mov_b32 v47, 0
  v_mov_b32 v48, 0
  v_mov_b32 v49, 0
  v_mov_b32 v50, 0
  v_mov_b32 v51, 0
  s_mov_b32 s48, 0xbfb8aa3b
  v_lshlrev_b32 v36, 16, v36
  v_mul_f32 v52, s48, v36
  v_exp_f32 v52, v52
  v_lshlrev_b32 v37, 16, v37
  v_mul_f32 v53, s48, v37
  v_exp_f32 v53, v53
  v_lshlrev_b32 v38, 16, v38
  v_mul_f32 v54, s48, v38
  v_exp_f32 v54, v54
  v_lshlrev_b32 v39, 16, v39
  v_mul_f32 v55, s48, v39
  v_exp_f32 v55, v55
  v_lshlrev_b32 v40, 16, v40
  v_mul_f32 v56, s48, v40
  v_exp_f32 v56, v56
  v_add_f32 v52, 1.0, v52
  v_add_f32 v53, 1.0, v53
  v_add_f32 v54, 1.0, v54
  v_add_f32 v55, 1.0, v55
  v_add_f32 v56, 1.0, v56
  v_rcp_f32 v52, v52
  v_rcp_f32 v53, v53
  v_rcp_f32 v54, v54
  v_rcp_f32 v55, v55
  v_rcp_f32 v56, v56
  v_mul_f32 v36, v36, v52
  v_mul_f32 v37, v37, v53
  v_mul_f32 v38, v38, v54
  v_mul_f32 v39, v39, v55
  v_mul_f32 v40, v40, v56
  v_lshlrev_b32 v60, 16, v16
  v_and_b32 v61, 0xffff0000, v16
  v_fmac_f32 v44, v36, v60
  v_fmac_f32 v45, v36, v61
  v_lshlrev_b32 v60, 16, v17
  v_and_b32 v61, 0xffff0000, v17
  v_fmac_f32 v46, v36, v60
  v_fmac_f32 v47, v36, v61
  v_lshlrev_b32 v60, 16, v18
  v_and_b32 v61, 0xffff0000, v18
  v_fmac_f32 v48, v36, v60
  v_fmac_f32 v49, v36, v61
  v_lshlrev_b32 v60, 16, v19
  v_and_b32 v61, 0xffff0000, v19
  v_fmac_f32 v50, v36, v60
  v_fmac_f32 v51, v36, v61
  v_lshlrev_b32 v60, 16, v20
  v_and_b32 v61, 0xffff0000, v20
  v_fmac_f32 v44, v37, v60
  v_fmac_f32 v45, v37, v61
  v_lshlrev_b32 v60, 16, v21
  v_and_b32 v61, 0xffff0000, v21
  v_fmac_f32 v46, v37, v60
  v_fmac_f32 v47, v37, v61
  v_lshlrev_b32 v60, 16, v22
  v_and_b32 v61, 0xffff0000, v22
  v_fmac_f32 v48, v37, v60
  v_fmac_f32 v49, v37, v61
  v_lshlrev_b32 v60, 16, v23
  v_and_b32 v61, 0xffff0000, v23
  v_fmac_f32 v50, v37, v60
  v_fmac_f32 v51, v37, v61
  v_lshlrev_b32 v60, 16, v24
  v_and_b32 v61, 0xffff0000, v24
  v_fmac_f32 v44, v38, v60
  v_fmac_f32 v45, v38, v61
  v_lshlrev_b32 v60, 16, v25
  v_and_b32 v61, 0xffff0000, v25
  v_fmac_f32 v46, v38, v60
  v_fmac_f32 v47, v38, v61
  v_lshlrev_b32 v60, 16, v26
  v_and_b32 v61, 0xffff0000, v26
  v_fmac_f32 v48, v38, v60
  v_fmac_f32 v49, v38, v61
  v_lshlrev_b32 v60, 16, v27
  v_and_b32 v61, 0xffff0000, v27
  v_fmac_f32 v50, v38, v60
  v_fmac_f32 v51, v38, v61
  v_lshlrev_b32 v60, 16, v28
  v_and_b32 v61, 0xffff0000, v28
  v_fmac_f32 v44, v39, v60
  v_fmac_f32 v45, v39, v61
  v_lshlrev_b32 v60, 16, v29
  v_and_b32 v61, 0xffff0000, v29
  v_fmac_f32 v46, v39, v60
  v_fmac_f32 v47, v39, v61
  v_lshlrev_b32 v60, 16, v30
  v_and_b32 v61, 0xffff0000, v30
  v_fmac_f32 v48, v39, v60
  v_fmac_f32 v49, v39, v61
  v_lshlrev_b32 v60, 16, v31
  v_and_b32 v61, 0xffff0000, v31
  v_fmac_f32 v50, v39, v60
  v_fmac_f32 v51, v39, v61
  v_lshlrev_b32 v60, 16, v32
  v_and_b32 v61, 0xffff0000, v32
  v_fmac_f32 v44, v40, v60
  v_fmac_f32 v45, v40, v61
  v_lshlrev_b32 v60, 16, v33
  v_and_b32 v61, 0xffff0000, v33
  v_fmac_f32 v46, v40, v60
  v_fmac_f32 v47, v40, v61
  v_lshlrev_b32 v60, 16, v34
  v_and_b32 v61, 0xffff0000, v34
  v_fmac_f32 v48, v40, v60
  v_fmac_f32 v49, v40, v61
  v_lshlrev_b32 v60, 16, v35
  v_and_b32 v61, 0xffff0000, v35
  v_fmac_f32 v50, v40, v60
  v_fmac_f32 v51, v40, v61
  v_and_b32 v60, 8, v1
  v_cmp_ne_u32 vcc, 0, v60
  s_nop 1
  v_cndmask_b32 v52, v48, v44, vcc
  v_cndmask_b32 v56, v44, v48, vcc
  v_cndmask_b32 v53, v49, v45, vcc
  v_cndmask_b32 v57, v45, v49, vcc
  v_cndmask_b32 v54, v50, v46, vcc
  v_cndmask_b32 v58, v46, v50, vcc
  v_cndmask_b32 v55, v51, v47, vcc
  v_cndmask_b32 v59, v47, v51, vcc
  v_add_f32_dpp v56, v52, v56 row_ror:8 row_mask:0xf bank_mask:0xf
  v_add_f32_dpp v57, v53, v57 row_ror:8 row_mask:0xf bank_mask:0xf
  v_add_f32_dpp v58, v54, v58 row_ror:8 row_mask:0xf bank_mask:0xf
  v_add_f32_dpp v59, v55, v59 row_ror:8 row_mask:0xf bank_mask:0xf
  s_nop 0
  v_permlane16_swap_b32 v56, v58
  v_permlane16_swap_b32 v57, v59
  v_add_f32 v56, v56, v58
  v_add_f32 v57, v57, v59
  s_nop 1
  v_permlane32_swap_b32 v56, v57
  v_add_f32 v56, v56, v57
  v_and_b32 v60, 7, v1
  v_lshlrev_b32 v60, 3, v60
  v_bfe_u32 v61, v1, 3, 1
  v_lshl_add_u32 v60, v61, 2, v60
  v_bfe_u32 v61, v1, 4, 1
  v_lshl_add_u32 v60, v61, 1, v60
  v_lshrrev_b32 v61, 5, v1
  v_add_u32 v60, v60, v61
  v_lshlrev_b32 v60, 2, v60
  v_add_u32 v60, 162304, v60
  ds_add_f32 v60, v56
  v_mov_b32 v61, 162560
  v_mov_b32 v62, 1
  s_waitcnt lgkmcnt(0)
  s_mov_b64 exec, 1
  ds_add_rtn_u32 v63, v61, v62
  s_waitcnt lgkmcnt(0)
  s_mov_b64 exec, -1
  v_readfirstlane_b32 s57, v63
  s_nop 3
  s_cmp_lg_u32 s57, 3
  s_cbranch_scc1 adaLN_cond__mha_block__glu_gated_glu__prompt_nomod6
  v_lshlrev_b32 v60, 2, v1
  v_add_u32 v61, 162304, v60
  ds_read_b32 v62, v61
  s_mul_i32 s56, s52, 5120
  s_lshl_b32 s57, s53, 8
  s_add_u32 s56, s56, s57
  s_add_u32 s56, s56, 90112
  s_waitcnt lgkmcnt(0)
  buffer_store_dword v62, v60, s[8:11], s56 offen sc0 sc1
adaLN_cond__mha_block__glu_gated_glu__prompt_nomod6:
  s_waitcnt vmcnt(0)
  s_barrier
  s_cmp_lg_u32 s12, 1
  s_cbranch_scc1 adaLN_cond__mha_block__glu_gated_glu__prompt_s01w18
  s_cmp_ge_u32 s2, 80
  s_cbranch_scc1 adaLN_cond__mha_block__glu_gated_glu__prompt_s01w18
  s_lshr_b32 s53, s2, 4
  s_add_u32 s52, s53, 190
  s_lshl_b32 s48, s52, 8
  s_add_u32 s48, s48, 0
  v_mov_b32 v2, 0
  v_mov_b32 v3, 1
  s_mov_b64 exec, 1
  buffer_atomic_add v3, v2, s[8:11], s48 offen sc0 sc1
  s_waitcnt vmcnt(0)
  s_mov_b64 exec, -1
  v_readfirstlane_b32 s49, v3
  s_nop 3
  s_cmp_lg_u32 s49, 15
  s_cbranch_scc1 adaLN_cond__mha_block__glu_gated_glu__prompt_arr9
  s_mov_b32 s48, 41984
  s_lshl_b32 s49, s53, 2
  s_add_u32 s48, s48, s49
  v_lshlrev_b32 v2, 8, v1
  v_mov_b32 v3, 1
  s_mov_b32 exec_lo, 0xff
  s_mov_b32 exec_hi, 0
  buffer_store_dword v3, v2, s[8:11], s48 offen sc0 sc1
  s_mov_b64 exec, -1
adaLN_cond__mha_block__glu_gated_glu__prompt_arr9:
adaLN_cond__mha_block__glu_gated_glu__prompt_s01w18:
  s_cmp_lg_u32 s12, 0
  s_cbranch_scc1 adaLN_cond__mha_block__glu_gated_glu__prompt_s01w7
  s_lshr_b32 s53, s2, 4
  s_add_u32 s52, s53, 88
  s_add_u32 s53, s53, 174
  s_lshl_b32 s48, s52, 8
  s_add_u32 s48, s48, 0
  v_mov_b32 v2, 0
  v_mov_b32 v3, 1
  s_mov_b64 exec, 1
  buffer_atomic_add v3, v2, s[8:11], s48 offen sc0 sc1
  s_waitcnt vmcnt(0)
  s_mov_b64 exec, -1
  v_readfirstlane_b32 s49, v3
  s_nop 3
  s_cmp_lg_u32 s49, 15
  s_cbranch_scc1 adaLN_cond__mha_block__glu_gated_glu__prompt_arr10
  s_lshl_b32 s48, s53, 8
  s_add_u32 s48, s48, 0
  v_lshlrev_b32 v2, 8, v1
  v_mov_b32 v3, 1
  s_mov_b32 exec_lo, 0x1
  s_mov_b32 exec_hi, 0
  buffer_store_dword v3, v2, s[8:11], s48 offen sc0 sc1
  s_mov_b64 exec, -1
adaLN_cond__mha_block__glu_gated_glu__prompt_arr10:
  s_add_u32 s52, s13, 164
  s_lshl_b32 s52, s52, 8
  s_add_u32 s54, s15, 174
  s_lshl_b32 s54, s54, 8
  v_lshlrev_b32 v5, 2, v1
  v_add_u32 v5, s52, v5
  v_mov_b32 v7, s54
  v_cmp_gt_u32 vcc, 5, v1
  s_nop 1
  v_cndmask_b32 v5, v7, v5, vcc
  v_mov_b32 v6, 1
  s_mov_b32 s49, 0
  s_mov_b32 s50, 0
adaLN_cond__mha_block__glu_gated_glu__prompt_poll11:
  buffer_load_dword v4, v5, s[8:11], s49 offen sc1
  s_waitcnt vmcnt(0)
  v_cmp_lt_u32 vcc, v4, v6
  s_nop 3
  s_cmp_eq_u64 vcc, 0
  s_cbranch_scc1 adaLN_cond__mha_block__glu_gated_glu__prompt_polled12
  s_add_u32 s50, s50, 1
  s_cmp_ge_u32 s50, 200000
  s_cbranch_scc1 adaLN_cond__mha_block__glu_gated_glu__prompt_polled12
  s_sleep 2
  s_branch adaLN_cond__mha_block__glu_gated_glu__prompt_poll11
adaLN_cond__mha_block__glu_gated_glu__prompt_polled12:
adaLN_cond__mha_block__glu_gated_glu__prompt_s01w7:
  s_barrier
  s_cmp_eq_u32 s4, 15
  s_cbranch_scc1 adaLN_cond__mha_block__glu_gated_glu__prompt_qidle13
  s_cmp_ge_u32 s4, 10
  s_cbranch_scc1 adaLN_cond__mha_block__glu_gated_glu__prompt_qv14
  v_and_b32 v3, 31, v1
  v_lshrrev_b32 v4, 5, v1
  v_lshlrev_b32 v5, 4, v1
  s_lshl_b32 s53, s15, 2
  s_add_u32 s53, s53, s12
  s_mul_i32 s54, s53, 40960
  s_add_u32 s54, s54, 126976
  v_lshlrev_b32 v9, 4, v0
  v_and_b32 v15, 15, v1
  v_lshlrev_b32 v15, 4, v15
  s_lshl_b32 s55, s12, 8
  s_add_u32 s55, s55, 4096
  v_add_u32 v15, s55, v15
  s_mov_b32 s52, 90112
  buffer_load_dwordx4 v[224:227], v9, s[8:11], s52 offen sc1
  buffer_load_dwordx4 v[240:243], v15, s[8:11], s52 offen sc1
  s_mov_b32 s52, 95232
  buffer_load_dwordx4 v[228:231], v9, s[8:11], s52 offen sc1
  buffer_load_dwordx4 v[244:247], v15, s[8:11], s52 offen sc1
  s_mov_b32 s52, 100352
  buffer_load_dwordx4 v[232:235], v9, s[8:11], s52 offen sc1
  buffer_load_dwordx4 v[248:251], v15, s[8:11], s52 offen sc1
  s_mov_b32 s52, 105472
  buffer_load_dwordx4 v[236:239], v9, s[8:11], s52 offen sc1
  buffer_load_dwordx4 v[252:255], v15, s[8:11], s52 offen sc1
  s_add_u32 s55, s54, 0
  buffer_load_dwordx4 v[80:83], v5, s[8:11], s55 offen offset:0 sc1
  buffer_load_dwordx4 v[84:87], v5, s[8:11], s55 offen offset:1024 sc1
  buffer_load_dwordx4 v[88:91], v5, s[8:11], s55 offen offset:2048 sc1
  buffer_load_dwordx4 v[92:95], v5, s[8:11], s55 offen offset:3072 sc1
  v_mov_b32 v16, 0
  v_mov_b32 v17, 0
  v_mov_b32 v18, 0
  v_mov_b32 v19, 0
  v_mov_b32 v20, 0
  v_mov_b32 v21, 0
  v_mov_b32 v22, 0
  v_mov_b32 v23, 0
  v_mov_b32 v24, 0
  v_mov_b32 v25, 0
  v_mov_b32 v26, 0
  v_mov_b32 v27, 0
  v_mov_b32 v28, 0
  v_mov_b32 v29, 0
  v_mov_b32 v30, 0
  v_mov_b32 v31, 0
  v_mov_b32 v32, 0
  v_mov_b32 v33, 0
  v_mov_b32 v34, 0
  v_mov_b32 v35, 0
  v_mov_b32 v36, 0
  v_mov_b32 v37, 0
  v_mov_b32 v38, 0
  v_mov_b32 v39, 0
  v_mov_b32 v40, 0
  v_mov_b32 v41, 0
  v_mov_b32 v42, 0
  v_mov_b32 v43, 0
  v_mov_b32 v44, 0
  v_mov_b32 v45, 0
  v_mov_b32 v46, 0
  v_mov_b32 v47, 0
  v_mov_b32 v48, 0
  v_mov_b32 v49, 0
  v_mov_b32 v50, 0
  v_mov_b32 v51, 0
  v_mov_b32 v52, 0
  v_mov_b32 v53, 0
  v_mov_b32 v54, 0
  v_mov_b32 v55, 0
  v_mov_b32 v56, 0
  v_mov_b32 v57, 0
  v_mov_b32 v58, 0
  v_mov_b32 v59, 0
  v_mov_b32 v60, 0
  v_mov_b32 v61, 0
  v_mov_b32 v62, 0
  v_mov_b32 v63, 0
  v_mov_b32 v64, 0
  v_mov_b32 v65, 0
  v_mov_b32 v66, 0
  v_mov_b32 v67, 0
  v_mov_b32 v68, 0
  v_mov_b32 v69, 0
  v_mov_b32 v70, 0
  v_mov_b32 v71, 0
  v_mov_b32 v72, 0
  v_mov_b32 v73, 0
  v_mov_b32 v74, 0
  v_mov_b32 v75, 0
  v_mov_b32 v76, 0
  v_mov_b32 v77, 0
  v_mov_b32 v78, 0
  v_mov_b32 v79, 0
  v_and_b32 v8, 15, v1
  v_lshrrev_b32 v8, 2, v8
  v_lshl_add_u32 v9, v4, 3, v8
  v_lshlrev_b32 v9, 8, v9
  v_bfe_u32 v10, v1, 4, 1
  v_lshl_add_u32 v9, v10, 5, v9
  v_and_b32 v10, 3, v1
  v_lshl_add_u32 v9, v10, 3, v9
  v_xor_b32 v10, 0, v8
  v_lshl_add_u32 v208, v10, 6, v9
  v_add_u32 v212, 0x10000, v208
  v_add_u32 v216, 0x20000, v208
  v_xor_b32 v10, 1, v8
  v_lshl_add_u32 v209, v10, 6, v9
  v_add_u32 v213, 0x10000, v209
  v_add_u32 v217, 0x20000, v209
  v_xor_b32 v10, 2, v8
  v_lshl_add_u32 v210, v10, 6, v9
  v_add_u32 v214, 0x10000, v210
  v_add_u32 v218, 0x20000, v210
  v_xor_b32 v10, 3, v8
  v_lshl_add_u32 v211, v10, 6, v9
  v_add_u32 v215, 0x10000, v211
  v_add_u32 v219, 0x20000, v211
  v_lshlrev_b32 v14, 4, v4
  v_add_u32 v14, 143360, v14
  s_mul_i32 s58, s53, 40960
  s_lshl_b32 s56, s5, 13
  s_add_u32 s58, s58, s56
  s_mov_b32 s56, 9465856
  s_mov_b32 s60, 0x3ea52b5c
  s_cmp_lt_u32 s4, 5
  s_cselect_b32 s56, s56, 12087296
  s_cselect_b32 s60, s60, 1.0
  s_add_u32 s58, s58, s56
  s_mov_b32 s61, 0
  s_waitcnt vmcnt(4)
  v_cmp_le_u32 vcc, 160, v0
  v_mov_b32 v6, 0
  s_nop 0
  v_cndmask_b32_e64 v6, v6, 1.0, vcc
  v_add_f32 v224, v224, v228
  v_add_f32 v232, v232, v236
  v_add_f32 v225, v225, v229
  v_add_f32 v233, v233, v237
  v_add_f32 v226, v226, v230
  v_add_f32 v234, v234, v238
  v_add_f32 v227, v227, v231
  v_add_f32 v235, v235, v239
  v_add_f32 v224, v224, v232
  v_add_f32 v225, v225, v233
  v_add_f32 v226, v226, v234
  v_add_f32 v227, v227, v235
  v_add_f32 v240, v240, v244
  v_add_f32 v248, v248, v252
  v_add_f32 v241, v241, v245
  v_add_f32 v249, v249, v253
  v_add_f32 v242, v242, v246
  v_add_f32 v250, v250, v254
  v_add_f32 v243, v243, v247
  v_add_f32 v251, v251, v255
  v_add_f32 v240, v240, v248
  v_add_f32 v241, v241, v249
  v_add_f32 v242, v242, v250
  v_add_f32 v243, v243, v251
  v_add_f32 v224, v224, v6
  v_add_f32 v240, 1.0, v240
  v_add_f32 v225, v225, v6
  v_add_f32 v241, 1.0, v241
  v_add_f32 v226, v226, v6
  v_add_f32 v242, 1.0, v242
  v_add_f32 v227, v227, v6
  v_add_f32 v243, 1.0, v243
  v_mul_f32 v224, s60, v224
  v_mul_f32 v240, s60, v240
  v_mul_f32 v225, s60, v225
  v_mul_f32 v241, s60, v241
  v_mul_f32 v226, s60, v226
  v_mul_f32 v242, s60, v242
  v_mul_f32 v227, s60, v227
  v_mul_f32 v243, s60, v243
  v_cvt_pk_f16_f32 v228, v224, v225
  v_cvt_pk_f16_f32 v229, v226, v227
  v_lshlrev_b32 v7, 3, v0
  v_add_u32 v7, 143360, v7
  ds_write_b64 v7, v[228:229]
  v_cvt_pk_f16_f32 v244, v240, v241
  v_cvt_pk_f16_f32 v245, v242, v243
  v_lshrrev_b32 v7, 1, v15
  v_add_u32 v7, 143360, v7
  ds_write_b64 v7, v[244:245]
  s_waitcnt lgkmcnt(0)
  s_barrier
  ds_read_b128 v[176:179], v14 offset:1280
  ds_read_b128 v[180:183], v14 offset:0
  ds_read_b64_tr_b16 v[144:145], v208 offset:0
  ds_read_b64_tr_b16 v[146:147], v208 offset:1024
  ds_read_b64_tr_b16 v[148:149], v209 offset:0
  ds_read_b64_tr_b16 v[150:151], v209 offset:1024
  ds_read_b64_tr_b16 v[152:153], v210 offset:0
  ds_read_b64_tr_b16 v[154:155], v210 offset:1024
  ds_read_b64_tr_b16 v[156:157], v211 offset:0
  ds_read_b64_tr_b16 v[158:159], v211 offset:1024
  ds_read_b128 v[184:187], v14 offset:1312
  ds_read_b128 v[188:191], v14 offset:32
  s_waitcnt lgkmcnt(10)
  s_waitcnt vmcnt(3)
  v_fma_mix_f32 v192, v80, v176, v180 op_sel:[0,0,0] op_sel_hi:[1,1,1]
  v_fma_mix_f32 v193, v80, v176, v180 op_sel:[1,1,1] op_sel_hi:[1,1,1]
  v_fma_mix_f32 v194, v81, v177, v181 op_sel:[0,0,0] op_sel_hi:[1,1,1]
  v_fma_mix_f32 v195, v81, v177, v181 op_sel:[1,1,1] op_sel_hi:[1,1,1]
  v_fma_mix_f32 v196, v82, v178, v182 op_sel:[0,0,0] op_sel_hi:[1,1,1]
  v_fma_mix_f32 v197, v82, v178, v182 op_sel:[1,1,1] op_sel_hi:[1,1,1]
  v_fma_mix_f32 v198, v83, v179, v183 op_sel:[0,0,0] op_sel_hi:[1,1,1]
  v_fma_mix_f32 v199, v83, v179, v183 op_sel:[1,1,1] op_sel_hi:[1,1,1]
  v_cvt_pk_bf16_f32 v200, v192, v193
  v_cvt_pk_bf16_f32 v201, v194, v195
  v_cvt_pk_bf16_f32 v202, v196, v197
  v_cvt_pk_bf16_f32 v203, v198, v199
  s_waitcnt lgkmcnt(8)
  s_nop 0
  v_mfma_f32_32x32x16_bf16 v[16:31], v[144:147], v[200:203], v[16:31]
  ds_read_b64_tr_b16 v[160:161], v208 offset:4096
  ds_read_b64_tr_b16 v[162:163], v208 offset:5120
  ds_read_b128 v[176:179], v14 offset:1344
  s_waitcnt lgkmcnt(3)
  s_waitcnt vmcnt(2)
  v_fma_mix_f32 v192, v84, v184, v188 op_sel:[0,0,0] op_sel_hi:[1,1,1]
  v_fma_mix_f32 v193, v84, v184, v188 op_sel:[1,1,1] op_sel_hi:[1,1,1]
  v_fma_mix_f32 v194, v85, v185, v189 op_sel:[0,0,0] op_sel_hi:[1,1,1]
  v_mfma_f32_32x32x16_bf16 v[32:47], v[148:151], v[200:203], v[32:47]
  ds_read_b64_tr_b16 v[164:165], v209 offset:4096
  ds_read_b64_tr_b16 v[166:167], v209 offset:5120
  ds_read_b128 v[180:183], v14 offset:64
  v_fma_mix_f32 v195, v85, v185, v189 op_sel:[1,1,1] op_sel_hi:[1,1,1]
  v_fma_mix_f32 v196, v86, v186, v190 op_sel:[0,0,0] op_sel_hi:[1,1,1]
  v_fma_mix_f32 v197, v86, v186, v190 op_sel:[1,1,1] op_sel_hi:[1,1,1]
  v_mfma_f32_32x32x16_bf16 v[48:63], v[152:155], v[200:203], v[48:63]
  ds_read_b64_tr_b16 v[168:169], v210 offset:4096
  ds_read_b64_tr_b16 v[170:171], v210 offset:5120
  v_fma_mix_f32 v198, v87, v187, v191 op_sel:[0,0,0] op_sel_hi:[1,1,1]
  v_fma_mix_f32 v199, v87, v187, v191 op_sel:[1,1,1] op_sel_hi:[1,1,1]
  v_cvt_pk_bf16_f32 v204, v192, v193
  v_cvt_pk_bf16_f32 v205, v194, v195
  v_mfma_f32_32x32x16_bf16 v[64:79], v[156:159], v[200:203], v[64:79]
  ds_read_b64_tr_b16 v[172:173], v211 offset:4096
  ds_read_b64_tr_b16 v[174:175], v211 offset:5120
  v_cvt_pk_bf16_f32 v206, v196, v197
  v_cvt_pk_bf16_f32 v207, v198, v199
  s_add_u32 s55, s54, 4096
  buffer_load_dwordx4 v[96:99], v5, s[8:11], s55 offen offset:0 sc1
  buffer_load_dwordx4 v[100:103], v5, s[8:11], s55 offen offset:1024 sc1
  s_waitcnt lgkmcnt(8)
  v_mfma_f32_32x32x16_bf16 v[16:31], v[160:163], v[204:207], v[16:31]
  ds_read_b64_tr_b16 v[144:145], v208 offset:8192
  ds_read_b64_tr_b16 v[146:147], v208 offset:9216
  ds_read_b128 v[184:187], v14 offset:1376
  s_waitcnt lgkmcnt(7)
  s_waitcnt vmcnt(3)
  v_fma_mix_f32 v192, v88, v176, v180 op_sel:[0,0,0] op_sel_hi:[1,1,1]
  v_fma_mix_f32 v193, v88, v176, v180 op_sel:[1,1,1] op_sel_hi:[1,1,1]
  v_fma_mix_f32 v194, v89, v177, v181 op_sel:[0,0,0] op_sel_hi:[1,1,1]
  v_mfma_f32_32x32x16_bf16 v[32:47], v[164:167], v[204:207], v[32:47]
  ds_read_b64_tr_b16 v[148:149], v209 offset:8192
  ds_read_b64_tr_b16 v[150:151], v209 offset:9216
  ds_read_b128 v[188:191], v14 offset:96
  v_fma_mix_f32 v195, v89, v177, v181 op_sel:[1,1,1] op_sel_hi:[1,1,1]
  v_fma_mix_f32 v196, v90, v178, v182 op_sel:[0,0,0] op_sel_hi:[1,1,1]
  v_fma_mix_f32 v197, v90, v178, v182 op_sel:[1,1,1] op_sel_hi:[1,1,1]
  s_waitcnt lgkmcnt(8)
  v_mfma_f32_32x32x16_bf16 v[48:63], v[168:171], v[204:207], v[48:63]
  ds_read_b64_tr_b16 v[152:153], v210 offset:8192
  ds_read_b64_tr_b16 v[154:155], v210 offset:9216
  v_fma_mix_f32 v198, v91, v179, v183 op_sel:[0,0,0] op_sel_hi:[1,1,1]
  v_fma_mix_f32 v199, v91, v179, v183 op_sel:[1,1,1] op_sel_hi:[1,1,1]
  v_cvt_pk_bf16_f32 v200, v192, v193
  v_cvt_pk_bf16_f32 v201, v194, v195
  s_waitcnt lgkmcnt(8)
  v_mfma_f32_32x32x16_bf16 v[64:79], v[172:175], v[204:207], v[64:79]
  ds_read_b64_tr_b16 v[156:157], v211 offset:8192
  ds_read_b64_tr_b16 v[158:159], v211 offset:9216
  v_cvt_pk_bf16_f32 v202, v196, v197
  v_cvt_pk_bf16_f32 v203, v198, v199
  buffer_load_dwordx4 v[104:107], v5, s[8:11], s55 offen offset:2048 sc1
  buffer_load_dwordx4 v[108:111], v5, s[8:11], s55 offen offset:3072 sc1
  s_waitcnt lgkmcnt(8)
  v_mfma_f32_32x32x16_bf16 v[16:31], v[144:147], v[200:203], v[16:31]
  ds_read_b64_tr_b16 v[160:161], v208 offset:12288
  ds_read_b64_tr_b16 v[162:163], v208 offset:13312
  ds_read_b128 v[176:179], v14 offset:1408
  s_waitcnt lgkmcnt(7)
  s_waitcnt vmcnt(4)
  v_fma_mix_f32 v192, v92, v184, v188 op_sel:[0,0,0] op_sel_hi:[1,1,1]
  v_fma_mix_f32 v193, v92, v184, v188 op_sel:[1,1,1] op_sel_hi:[1,1,1]
  v_fma_mix_f32 v194, v93, v185, v189 op_sel:[0,0,0] op_sel_hi:[1,1,1]
  v_mfma_f32_32x32x16_bf16 v[32:47], v[148:151], v[200:203], v[32:47]
  ds_read_b64_tr_b16 v[164:165], v209 offset:12288
  ds_read_b64_tr_b16 v[166:167], v209 offset:13312
  ds_read_b128 v[180:183], v14 offset:128
  v_fma_mix_f32 v195, v93, v185, v189 op_sel:[1,1,1] op_sel_hi:[1,1,1]
  v_fma_mix_f32 v196, v94, v186, v190 op_sel:[0,0,0] op_sel_hi:[1,1,1]
  v_fma_mix_f32 v197, v94, v186, v190 op_sel:[1,1,1] op_sel_hi:[1,1,1]
  s_waitcnt lgkmcnt(8)
  v_mfma_f32_32x32x16_bf16 v[48:63], v[152:155], v[200:203], v[48:63]
  ds_read_b64_tr_b16 v[168:169], v210 offset:12288
  ds_read_b64_tr_b16 v[170:171], v210 offset:13312
  v_fma_mix_f32 v198, v95, v187, v191 op_sel:[0,0,0] op_sel_hi:[1,1,1]
  v_fma_mix_f32 v199, v95, v187, v191 op_sel:[1,1,1] op_sel_hi:[1,1,1]
  v_cvt_pk_bf16_f32 v204, v192, v193
  v_cvt_pk_bf16_f32 v205, v194, v195
  s_waitcnt lgkmcnt(8)
  v_mfma_f32_32x32x16_bf16 v[64:79], v[156:159], v[200:203], v[64:79]
  ds_read_b64_tr_b16 v[172:173], v211 offset:12288
  ds_read_b64_tr_b16 v[174:175], v211 offset:13312
  v_cvt_pk_bf16_f32 v206, v196, v197
  v_cvt_pk_bf16_f32 v207, v198, v199
  s_add_u32 s55, s54, 8192
  buffer_load_dwordx4 v[112:115], v5, s[8:11], s55 offen offset:0 sc1
  buffer_load_dwordx4 v[116:119], v5, s[8:11], s55 offen offset:1024 sc1
  s_waitcnt lgkmcnt(8)
  v_mfma_f32_32x32x16_bf16 v[16:31], v[160:163], v[204:207], v[16:31]
  ds_read_b64_tr_b16 v[144:145], v208 offset:16384
  ds_read_b64_tr_b16 v[146:147], v208 offset:17408
  ds_read_b128 v[184:187], v14 offset:1440
  s_waitcnt lgkmcnt(7)
  s_waitcnt vmcnt(5)
  v_fma_mix_f32 v192, v96, v176, v180 op_sel:[0,0,0] op_sel_hi:[1,1,1]
  v_fma_mix_f32 v193, v96, v176, v180 op_sel:[1,1,1] op_sel_hi:[1,1,1]
  v_fma_mix_f32 v194, v97, v177, v181 op_sel:[0,0,0] op_sel_hi:[1,1,1]
  v_mfma_f32_32x32x16_bf16 v[32:47], v[164:167], v[204:207], v[32:47]
  ds_read_b64_tr_b16 v[148:149], v209 offset:16384
  ds_read_b64_tr_b16 v[150:151], v209 offset:17408
  ds_read_b128 v[188:191], v14 offset:160
  v_fma_mix_f32 v195, v97, v177, v181 op_sel:[1,1,1] op_sel_hi:[1,1,1]
  v_fma_mix_f32 v196, v98, v178, v182 op_sel:[0,0,0] op_sel_hi:[1,1,1]
  v_fma_mix_f32 v197, v98, v178, v182 op_sel:[1,1,1] op_sel_hi:[1,1,1]
  s_waitcnt lgkmcnt(8)
  v_mfma_f32_32x32x16_bf16 v[48:63], v[168:171], v[204:207], v[48:63]
  ds_read_b64_tr_b16 v[152:153], v210 offset:16384
  ds_read_b64_tr_b16 v[154:155], v210 offset:17408
  v_fma_mix_f32 v198, v99, v179, v183 op_sel:[0,0,0] op_sel_hi:[1,1,1]
  v_fma_mix_f32 v199, v99, v179, v183 op_sel:[1,1,1] op_sel_hi:[1,1,1]
  v_cvt_pk_bf16_f32 v200, v192, v193
  v_cvt_pk_bf16_f32 v201, v194, v195
  s_waitcnt lgkmcnt(8)
  v_mfma_f32_32x32x16_bf16 v[64:79], v[172:175], v[204:207], v[64:79]
  ds_read_b64_tr_b16 v[156:157], v211 offset:16384
  ds_read_b64_tr_b16 v[158:159], v211 offset:17408
  v_cvt_pk_bf16_f32 v202, v196, v197
  v_cvt_pk_bf16_f32 v203, v198, v199
  buffer_load_dwordx4 v[120:123], v5, s[8:11], s55 offen offset:2048 sc1
  buffer_load_dwordx4 v[124:127], v5, s[8:11], s55 offen offset:3072 sc1
  s_waitcnt lgkmcnt(8)
  v_mfma_f32_32x32x16_bf16 v[16:31], v[144:147], v[200:203], v[16:31]
  ds_read_b64_tr_b16 v[160:161], v208 offset:20480
  ds_read_b64_tr_b16 v[162:163], v208 offset:21504
  ds_read_b128 v[176:179], v14 offset:1472
  s_waitcnt lgkmcnt(7)
  s_waitcnt vmcnt(6)
  v_fma_mix_f32 v192, v100, v184, v188 op_sel:[0,0,0] op_sel_hi:[1,1,1]
  v_fma_mix_f32 v193, v100, v184, v188 op_sel:[1,1,1] op_sel_hi:[1,1,1]
  v_fma_mix_f32 v194, v101, v185, v189 op_sel:[0,0,0] op_sel_hi:[1,1,1]
  v_mfma_f32_32x32x16_bf16 v[32:47], v[148:151], v[200:203], v[32:47]
  ds_read_b64_tr_b16 v[164:165], v209 offset:20480
  ds_read_b64_tr_b16 v[166:167], v209 offset:21504
  ds_read_b128 v[180:183], v14 offset:192
  v_fma_mix_f32 v195, v101, v185, v189 op_sel:[1,1,1] op_sel_hi:[1,1,1]
  v_fma_mix_f32 v196, v102, v186, v190 op_sel:[0,0,0] op_sel_hi:[1,1,1]
  v_fma_mix_f32 v197, v102, v186, v190 op_sel:[1,1,1] op_sel_hi:[1,1,1]
  s_waitcnt lgkmcnt(8)
  v_mfma_f32_32x32x16_bf16 v[48:63], v[152:155], v[200:203], v[48:63]
  ds_read_b64_tr_b16 v[168:169], v210 offset:20480
  ds_read_b64_tr_b16 v[170:171], v210 offset:21504
  v_fma_mix_f32 v198, v103, v187, v191 op_sel:[0,0,0] op_sel_hi:[1,1,1]
  v_fma_mix_f32 v199, v103, v187, v191 op_sel:[1,1,1] op_sel_hi:[1,1,1]
  v_cvt_pk_bf16_f32 v204, v192, v193
  v_cvt_pk_bf16_f32 v205, v194, v195
  s_waitcnt lgkmcnt(8)
  v_mfma_f32_32x32x16_bf16 v[64:79], v[156:159], v[200:203], v[64:79]
  ds_read_b64_tr_b16 v[172:173], v211 offset:20480
  ds_read_b64_tr_b16 v[174:175], v211 offset:21504
  v_cvt_pk_bf16_f32 v206, v196, v197
  v_cvt_pk_bf16_f32 v207, v198, v199
  s_add_u32 s55, s54, 12288
  buffer_load_dwordx4 v[128:131], v5, s[8:11], s55 offen offset:0 sc1
  buffer_load_dwordx4 v[132:135], v5, s[8:11], s55 offen offset:1024 sc1
  s_waitcnt lgkmcnt(8)
  v_mfma_f32_32x32x16_bf16 v[16:31], v[160:163], v[204:207], v[16:31]
  s_barrier
  ds_read_b64_tr_b16 v[144:145], v208 offset:24576
  ds_read_b64_tr_b16 v[146:147], v208 offset:25600
  ds_read_b128 v[184:187], v14 offset:1504
  s_waitcnt lgkmcnt(7)
  s_waitcnt vmcnt(7)
  v_fma_mix_f32 v192, v104, v176, v180 op_sel:[0,0,0] op_sel_hi:[1,1,1]
  v_fma_mix_f32 v193, v104, v176, v180 op_sel:[1,1,1] op_sel_hi:[1,1,1]
  v_fma_mix_f32 v194, v105, v177, v181 op_sel:[0,0,0] op_sel_hi:[1,1,1]
  v_mfma_f32_32x32x16_bf16 v[32:47], v[164:167], v[204:207], v[32:47]
  ds_read_b64_tr_b16 v[148:149], v209 offset:24576
  ds_read_b64_tr_b16 v[150:151], v209 offset:25600
  ds_read_b128 v[188:191], v14 offset:224
  v_fma_mix_f32 v195, v105, v177, v181 op_sel:[1,1,1] op_sel_hi:[1,1,1]
  v_fma_mix_f32 v196, v106, v178, v182 op_sel:[0,0,0] op_sel_hi:[1,1,1]
  v_fma_mix_f32 v197, v106, v178, v182 op_sel:[1,1,1] op_sel_hi:[1,1,1]
  s_waitcnt lgkmcnt(8)
  v_mfma_f32_32x32x16_bf16 v[48:63], v[168:171], v[204:207], v[48:63]
  ds_read_b64_tr_b16 v[152:153], v210 offset:24576
  ds_read_b64_tr_b16 v[154:155], v210 offset:25600
  v_fma_mix_f32 v198, v107, v179, v183 op_sel:[0,0,0] op_sel_hi:[1,1,1]
  v_fma_mix_f32 v199, v107, v179, v183 op_sel:[1,1,1] op_sel_hi:[1,1,1]
  v_cvt_pk_bf16_f32 v200, v192, v193
  v_cvt_pk_bf16_f32 v201, v194, v195
  s_waitcnt lgkmcnt(8)
  v_mfma_f32_32x32x16_bf16 v[64:79], v[172:175], v[204:207], v[64:79]
  ds_read_b64_tr_b16 v[156:157], v211 offset:24576
  ds_read_b64_tr_b16 v[158:159], v211 offset:25600
  v_cvt_pk_bf16_f32 v202, v196, v197
  v_cvt_pk_bf16_f32 v203, v198, v199
  buffer_load_dwordx4 v[136:139], v5, s[8:11], s55 offen offset:2048 sc1
  buffer_load_dwordx4 v[140:143], v5, s[8:11], s55 offen offset:3072 sc1
  s_waitcnt lgkmcnt(8)
  v_mfma_f32_32x32x16_bf16 v[16:31], v[144:147], v[200:203], v[16:31]
  ds_read_b64_tr_b16 v[160:161], v208 offset:28672
  ds_read_b64_tr_b16 v[162:163], v208 offset:29696
  ds_read_b128 v[176:179], v14 offset:1536
  s_waitcnt lgkmcnt(7)
  s_waitcnt vmcnt(8)
  v_fma_mix_f32 v192, v108, v184, v188 op_sel:[0,0,0] op_sel_hi:[1,1,1]
  v_fma_mix_f32 v193, v108, v184, v188 op_sel:[1,1,1] op_sel_hi:[1,1,1]
  v_fma_mix_f32 v194, v109, v185, v189 op_sel:[0,0,0] op_sel_hi:[1,1,1]
  v_mfma_f32_32x32x16_bf16 v[32:47], v[148:151], v[200:203], v[32:47]
  ds_read_b64_tr_b16 v[164:165], v209 offset:28672
  ds_read_b64_tr_b16 v[166:167], v209 offset:29696
  ds_read_b128 v[180:183], v14 offset:256
  v_fma_mix_f32 v195, v109, v185, v189 op_sel:[1,1,1] op_sel_hi:[1,1,1]
  v_fma_mix_f32 v196, v110, v186, v190 op_sel:[0,0,0] op_sel_hi:[1,1,1]
  v_fma_mix_f32 v197, v110, v186, v190 op_sel:[1,1,1] op_sel_hi:[1,1,1]
  s_waitcnt lgkmcnt(8)
  v_mfma_f32_32x32x16_bf16 v[48:63], v[152:155], v[200:203], v[48:63]
  ds_read_b64_tr_b16 v[168:169], v210 offset:28672
  ds_read_b64_tr_b16 v[170:171], v210 offset:29696
  v_fma_mix_f32 v198, v111, v187, v191 op_sel:[0,0,0] op_sel_hi:[1,1,1]
  v_fma_mix_f32 v199, v111, v187, v191 op_sel:[1,1,1] op_sel_hi:[1,1,1]
  v_cvt_pk_bf16_f32 v204, v192, v193
  v_cvt_pk_bf16_f32 v205, v194, v195
  s_waitcnt lgkmcnt(8)
  v_mfma_f32_32x32x16_bf16 v[64:79], v[156:159], v[200:203], v[64:79]
  ds_read_b64_tr_b16 v[172:173], v211 offset:28672
  ds_read_b64_tr_b16 v[174:175], v211 offset:29696
  v_cvt_pk_bf16_f32 v206, v196, v197
  v_cvt_pk_bf16_f32 v207, v198, v199
  s_add_u32 s55, s54, 16384
  buffer_load_dwordx4 v[80:83], v5, s[8:11], s55 offen offset:0 sc1
  buffer_load_dwordx4 v[84:87], v5, s[8:11], s55 offen offset:1024 sc1
  s_waitcnt lgkmcnt(8)
  v_mfma_f32_32x32x16_bf16 v[16:31], v[160:163], v[204:207], v[16:31]
  ds_read_b64_tr_b16 v[144:145], v208 offset:32768
  ds_read_b64_tr_b16 v[146:147], v208 offset:33792
  ds_read_b128 v[184:187], v14 offset:1568
  s_waitcnt lgkmcnt(7)
  s_waitcnt vmcnt(9)
  v_fma_mix_f32 v192, v112, v176, v180 op_sel:[0,0,0] op_sel_hi:[1,1,1]
  v_fma_mix_f32 v193, v112, v176, v180 op_sel:[1,1,1] op_sel_hi:[1,1,1]
  v_fma_mix_f32 v194, v113, v177, v181 op_sel:[0,0,0] op_sel_hi:[1,1,1]
  v_mfma_f32_32x32x16_bf16 v[32:47], v[164:167], v[204:207], v[32:47]
  ds_read_b64_tr_b16 v[148:149], v209 offset:32768
  ds_read_b64_tr_b16 v[150:151], v209 offset:33792
  ds_read_b128 v[188:191], v14 offset:288
  v_fma_mix_f32 v195, v113, v177, v181 op_sel:[1,1,1] op_sel_hi:[1,1,1]
  v_fma_mix_f32 v196, v114, v178, v182 op_sel:[0,0,0] op_sel_hi:[1,1,1]
  v_fma_mix_f32 v197, v114, v178, v182 op_sel:[1,1,1] op_sel_hi:[1,1,1]
  s_waitcnt lgkmcnt(8)
  v_mfma_f32_32x32x16_bf16 v[48:63], v[168:171], v[204:207], v[48:63]
  ds_read_b64_tr_b16 v[152:153], v210 offset:32768
  ds_read_b64_tr_b16 v[154:155], v210 offset:33792
  v_fma_mix_f32 v198, v115, v179, v183 op_sel:[0,0,0] op_sel_hi:[1,1,1]
  v_fma_mix_f32 v199, v115, v179, v183 op_sel:[1,1,1] op_sel_hi:[1,1,1]
  v_cvt_pk_bf16_f32 v200, v192, v193
  v_cvt_pk_bf16_f32 v201, v194, v195
  s_waitcnt lgkmcnt(8)
  v_mfma_f32_32x32x16_bf16 v[64:79], v[172:175], v[204:207], v[64:79]
  ds_read_b64_tr_b16 v[156:157], v211 offset:32768
  ds_read_b64_tr_b16 v[158:159], v211 offset:33792
  v_cvt_pk_bf16_f32 v202, v196, v197
  v_cvt_pk_bf16_f32 v203, v198, v199
  buffer_load_dwordx4 v[88:91], v5, s[8:11], s55 offen offset:2048 sc1
  s_waitcnt lgkmcnt(8)
  v_mfma_f32_32x32x16_bf16 v[16:31], v[144:147], v[200:203], v[16:31]
  ds_read_b64_tr_b16 v[160:161], v208 offset:36864
  ds_read_b64_tr_b16 v[162:163], v208 offset:37888
  ds_read_b128 v[176:179], v14 offset:1600
  s_waitcnt lgkmcnt(7)
  s_waitcnt vmcnt(9)
  v_fma_mix_f32 v192, v116, v184, v188 op_sel:[0,0,0] op_sel_hi:[1,1,1]
  v_fma_mix_f32 v193, v116, v184, v188 op_sel:[1,1,1] op_sel_hi:[1,1,1]
  v_fma_mix_f32 v194, v117, v185, v189 op_sel:[0,0,0] op_sel_hi:[1,1,1]
  v_mfma_f32_32x32x16_bf16 v[32:47], v[148:151], v[200:203], v[32:47]
  ds_read_b64_tr_b16 v[164:165], v209 offset:36864
  ds_read_b64_tr_b16 v[166:167], v209 offset:37888
  ds_read_b128 v[180:183], v14 offset:320
  v_fma_mix_f32 v195, v117, v185, v189 op_sel:[1,1,1] op_sel_hi:[1,1,1]
  v_fma_mix_f32 v196, v118, v186, v190 op_sel:[0,0,0] op_sel_hi:[1,1,1]
  v_fma_mix_f32 v197, v118, v186, v190 op_sel:[1,1,1] op_sel_hi:[1,1,1]
  s_waitcnt lgkmcnt(8)
  v_mfma_f32_32x32x16_bf16 v[48:63], v[152:155], v[200:203], v[48:63]
  ds_read_b64_tr_b16 v[168:169], v210 offset:36864
  ds_read_b64_tr_b16 v[170:171], v210 offset:37888
  v_fma_mix_f32 v198, v119, v187, v191 op_sel:[0,0,0] op_sel_hi:[1,1,1]
  v_fma_mix_f32 v199, v119, v187, v191 op_sel:[1,1,1] op_sel_hi:[1,1,1]
  v_cvt_pk_bf16_f32 v204, v192, v193
  v_cvt_pk_bf16_f32 v205, v194, v195
  s_waitcnt lgkmcnt(8)
  v_mfma_f32_32x32x16_bf16 v[64:79], v[156:159], v[200:203], v[64:79]
  ds_read_b64_tr_b16 v[172:173], v211 offset:36864
  ds_read_b64_tr_b16 v[174:175], v211 offset:37888
  v_cvt_pk_bf16_f32 v206, v196, v197
  v_cvt_pk_bf16_f32 v207, v198, v199
  buffer_load_dwordx4 v[92:95], v5, s[8:11], s55 offen offset:3072 sc1
  s_waitcnt lgkmcnt(8)
  v_mfma_f32_32x32x16_bf16 v[16:31], v[160:163], v[204:207], v[16:31]
  ds_read_b64_tr_b16 v[144:145], v208 offset:40960
  ds_read_b64_tr_b16 v[146:147], v208 offset:41984
  ds_read_b128 v[184:187], v14 offset:1632
  s_waitcnt lgkmcnt(7)
  s_waitcnt vmcnt(9)
  v_fma_mix_f32 v192, v120, v176, v180 op_sel:[0,0,0] op_sel_hi:[1,1,1]
  v_fma_mix_f32 v193, v120, v176, v180 op_sel:[1,1,1] op_sel_hi:[1,1,1]
  v_fma_mix_f32 v194, v121, v177, v181 op_sel:[0,0,0] op_sel_hi:[1,1,1]
  v_mfma_f32_32x32x16_bf16 v[32:47], v[164:167], v[204:207], v[32:47]
  ds_read_b64_tr_b16 v[148:149], v209 offset:40960
  ds_read_b64_tr_b16 v[150:151], v209 offset:41984
  ds_read_b128 v[188:191], v14 offset:352
  v_fma_mix_f32 v195, v121, v177, v181 op_sel:[1,1,1] op_sel_hi:[1,1,1]
  v_fma_mix_f32 v196, v122, v178, v182 op_sel:[0,0,0] op_sel_hi:[1,1,1]
  v_fma_mix_f32 v197, v122, v178, v182 op_sel:[1,1,1] op_sel_hi:[1,1,1]
  s_waitcnt lgkmcnt(8)
  v_mfma_f32_32x32x16_bf16 v[48:63], v[168:171], v[204:207], v[48:63]
  ds_read_b64_tr_b16 v[152:153], v210 offset:40960
  ds_read_b64_tr_b16 v[154:155], v210 offset:41984
  v_fma_mix_f32 v198, v123, v179, v183 op_sel:[0,0,0] op_sel_hi:[1,1,1]
  v_fma_mix_f32 v199, v123, v179, v183 op_sel:[1,1,1] op_sel_hi:[1,1,1]
  v_cvt_pk_bf16_f32 v200, v192, v193
  v_cvt_pk_bf16_f32 v201, v194, v195
  s_waitcnt lgkmcnt(8)
  v_mfma_f32_32x32x16_bf16 v[64:79], v[172:175], v[204:207], v[64:79]
  ds_read_b64_tr_b16 v[156:157], v211 offset:40960
  ds_read_b64_tr_b16 v[158:159], v211 offset:41984
  v_cvt_pk_bf16_f32 v202, v196, v197
  v_cvt_pk_bf16_f32 v203, v198, v199
  s_add_u32 s55, s54, 20480
  buffer_load_dwordx4 v[96:99], v5, s[8:11], s55 offen offset:0 sc1
  s_waitcnt lgkmcnt(8)
  v_mfma_f32_32x32x16_bf16 v[16:31], v[144:147], v[200:203], v[16:31]
  ds_read_b64_tr_b16 v[160:161], v208 offset:45056
  ds_read_b64_tr_b16 v[162:163], v208 offset:46080
  ds_read_b128 v[176:179], v14 offset:1664
  s_waitcnt lgkmcnt(7)
  s_waitcnt vmcnt(9)
  v_fma_mix_f32 v192, v124, v184, v188 op_sel:[0,0,0] op_sel_hi:[1,1,1]
  v_fma_mix_f32 v193, v124, v184, v188 op_sel:[1,1,1] op_sel_hi:[1,1,1]
  v_fma_mix_f32 v194, v125, v185, v189 op_sel:[0,0,0] op_sel_hi:[1,1,1]
  v_mfma_f32_32x32x16_bf16 v[32:47], v[148:151], v[200:203], v[32:47]
  ds_read_b64_tr_b16 v[164:165], v209 offset:45056
  ds_read_b64_tr_b16 v[166:167], v209 offset:46080
  ds_read_b128 v[180:183], v14 offset:384
  v_fma_mix_f32 v195, v125, v185, v189 op_sel:[1,1,1] op_sel_hi:[1,1,1]
  v_fma_mix_f32 v196, v126, v186, v190 op_sel:[0,0,0] op_sel_hi:[1,1,1]
  v_fma_mix_f32 v197, v126, v186, v190 op_sel:[1,1,1] op_sel_hi:[1,1,1]
  s_waitcnt lgkmcnt(8)
  v_mfma_f32_32x32x16_bf16 v[48:63], v[152:155], v[200:203], v[48:63]
  ds_read_b64_tr_b16 v[168:169], v210 offset:45056
  ds_read_b64_tr_b16 v[170:171], v210 offset:46080
  v_fma_mix_f32 v198, v127, v187, v191 op_sel:[0,0,0] op_sel_hi:[1,1,1]
  v_fma_mix_f32 v199, v127, v187, v191 op_sel:[1,1,1] op_sel_hi:[1,1,1]
  v_cvt_pk_bf16_f32 v204, v192, v193
  v_cvt_pk_bf16_f32 v205, v194, v195
  s_waitcnt lgkmcnt(8)
  v_mfma_f32_32x32x16_bf16 v[64:79], v[156:159], v[200:203], v[64:79]
  ds_read_b64_tr_b16 v[172:173], v211 offset:45056
  ds_read_b64_tr_b16 v[174:175], v211 offset:46080
  v_cvt_pk_bf16_f32 v206, v196, v197
  v_cvt_pk_bf16_f32 v207, v198, v199
  buffer_load_dwordx4 v[100:103], v5, s[8:11], s55 offen offset:1024 sc1
  s_waitcnt lgkmcnt(8)
  v_mfma_f32_32x32x16_bf16 v[16:31], v[160:163], v[204:207], v[16:31]
  ds_read_b64_tr_b16 v[144:145], v208 offset:49152
  ds_read_b64_tr_b16 v[146:147], v208 offset:50176
  ds_read_b128 v[184:187], v14 offset:1696
  s_waitcnt lgkmcnt(7)
  s_waitcnt vmcnt(9)
  v_fma_mix_f32 v192, v128, v176, v180 op_sel:[0,0,0] op_sel_hi:[1,1,1]
  v_fma_mix_f32 v193, v128, v176, v180 op_sel:[1,1,1] op_sel_hi:[1,1,1]
  v_fma_mix_f32 v194, v129, v177, v181 op_sel:[0,0,0] op_sel_hi:[1,1,1]
  v_mfma_f32_32x32x16_bf16 v[32:47], v[164:167], v[204:207], v[32:47]
  ds_read_b64_tr_b16 v[148:149], v209 offset:49152
  ds_read_b64_tr_b16 v[150:151], v209 offset:50176
  ds_read_b128 v[188:191], v14 offset:416
  v_fma_mix_f32 v195, v129, v177, v181 op_sel:[1,1,1] op_sel_hi:[1,1,1]
  v_fma_mix_f32 v196, v130, v178, v182 op_sel:[0,0,0] op_sel_hi:[1,1,1]
  v_fma_mix_f32 v197, v130, v178, v182 op_sel:[1,1,1] op_sel_hi:[1,1,1]
  s_waitcnt lgkmcnt(8)
  v_mfma_f32_32x32x16_bf16 v[48:63], v[168:171], v[204:207], v[48:63]
  ds_read_b64_tr_b16 v[152:153], v210 offset:49152
  ds_read_b64_tr_b16 v[154:155], v210 offset:50176
  v_fma_mix_f32 v198, v131, v179, v183 op_sel:[0,0,0] op_sel_hi:[1,1,1]
  v_fma_mix_f32 v199, v131, v179, v183 op_sel:[1,1,1] op_sel_hi:[1,1,1]
  v_cvt_pk_bf16_f32 v200, v192, v193
  v_cvt_pk_bf16_f32 v201, v194, v195
  s_waitcnt lgkmcnt(8)
  v_mfma_f32_32x32x16_bf16 v[64:79], v[172:175], v[204:207], v[64:79]
  ds_read_b64_tr_b16 v[156:157], v211 offset:49152
  ds_read_b64_tr_b16 v[158:159], v211 offset:50176
  v_cvt_pk_bf16_f32 v202, v196, v197
  v_cvt_pk_bf16_f32 v203, v198, v199
  buffer_load_dwordx4 v[104:107], v5, s[8:11], s55 offen offset:2048 sc1
  s_waitcnt lgkmcnt(8)
  v_mfma_f32_32x32x16_bf16 v[16:31], v[144:147], v[200:203], v[16:31]
  ds_read_b64_tr_b16 v[160:161], v208 offset:53248
  ds_read_b64_tr_b16 v[162:163], v208 offset:54272
  ds_read_b128 v[176:179], v14 offset:1728
  s_waitcnt lgkmcnt(7)
  s_waitcnt vmcnt(9)
  v_fma_mix_f32 v192, v132, v184, v188 op_sel:[0,0,0] op_sel_hi:[1,1,1]
  v_fma_mix_f32 v193, v132, v184, v188 op_sel:[1,1,1] op_sel_hi:[1,1,1]
  v_fma_mix_f32 v194, v133, v185, v189 op_sel:[0,0,0] op_sel_hi:[1,1,1]
  v_mfma_f32_32x32x16_bf16 v[32:47], v[148:151], v[200:203], v[32:47]
  ds_read_b64_tr_b16 v[164:165], v209 offset:53248
  ds_read_b64_tr_b16 v[166:167], v209 offset:54272
  ds_read_b128 v[180:183], v14 offset:448
  v_fma_mix_f32 v195, v133, v185, v189 op_sel:[1,1,1] op_sel_hi:[1,1,1]
  v_fma_mix_f32 v196, v134, v186, v190 op_sel:[0,0,0] op_sel_hi:[1,1,1]
  v_fma_mix_f32 v197, v134, v186, v190 op_sel:[1,1,1] op_sel_hi:[1,1,1]
  s_waitcnt lgkmcnt(8)
  v_mfma_f32_32x32x16_bf16 v[48:63], v[152:155], v[200:203], v[48:63]
  ds_read_b64_tr_b16 v[168:169], v210 offset:53248
  ds_read_b64_tr_b16 v[170:171], v210 offset:54272
  v_fma_mix_f32 v198, v135, v187, v191 op_sel:[0,0,0] op_sel_hi:[1,1,1]
  v_fma_mix_f32 v199, v135, v187, v191 op_sel:[1,1,1] op_sel_hi:[1,1,1]
  v_cvt_pk_bf16_f32 v204, v192, v193
  v_cvt_pk_bf16_f32 v205, v194, v195
  s_waitcnt lgkmcnt(8)
  v_mfma_f32_32x32x16_bf16 v[64:79], v[156:159], v[200:203], v[64:79]
  ds_read_b64_tr_b16 v[172:173], v211 offset:53248
  ds_read_b64_tr_b16 v[174:175], v211 offset:54272
  v_cvt_pk_bf16_f32 v206, v196, v197
  v_cvt_pk_bf16_f32 v207, v198, v199
  buffer_load_dwordx4 v[108:111], v5, s[8:11], s55 offen offset:3072 sc1
  s_waitcnt lgkmcnt(8)
  v_mfma_f32_32x32x16_bf16 v[16:31], v[160:163], v[204:207], v[16:31]
  ds_read_b64_tr_b16 v[144:145], v208 offset:57344
  ds_read_b64_tr_b16 v[146:147], v208 offset:58368
  ds_read_b128 v[184:187], v14 offset:1760
  s_waitcnt lgkmcnt(7)
  s_waitcnt vmcnt(9)
  v_fma_mix_f32 v192, v136, v176, v180 op_sel:[0,0,0] op_sel_hi:[1,1,1]
  v_fma_mix_f32 v193, v136, v176, v180 op_sel:[1,1,1] op_sel_hi:[1,1,1]
  v_fma_mix_f32 v194, v137, v177, v181 op_sel:[0,0,0] op_sel_hi:[1,1,1]
  v_mfma_f32_32x32x16_bf16 v[32:47], v[164:167], v[204:207], v[32:47]
  ds_read_b64_tr_b16 v[148:149], v209 offset:57344
  ds_read_b64_tr_b16 v[150:151], v209 offset:58368
  ds_read_b128 v[188:191], v14 offset:480
  v_fma_mix_f32 v195, v137, v177, v181 op_sel:[1,1,1] op_sel_hi:[1,1,1]
  v_fma_mix_f32 v196, v138, v178, v182 op_sel:[0,0,0] op_sel_hi:[1,1,1]
  v_fma_mix_f32 v197, v138, v178, v182 op_sel:[1,1,1] op_sel_hi:[1,1,1]
  s_waitcnt lgkmcnt(8)
  v_mfma_f32_32x32x16_bf16 v[48:63], v[168:171], v[204:207], v[48:63]
  ds_read_b64_tr_b16 v[152:153], v210 offset:57344
  ds_read_b64_tr_b16 v[154:155], v210 offset:58368
  v_fma_mix_f32 v198, v139, v179, v183 op_sel:[0,0,0] op_sel_hi:[1,1,1]
  v_fma_mix_f32 v199, v139, v179, v183 op_sel:[1,1,1] op_sel_hi:[1,1,1]
  v_cvt_pk_bf16_f32 v200, v192, v193
  v_cvt_pk_bf16_f32 v201, v194, v195
  s_waitcnt lgkmcnt(8)
  v_mfma_f32_32x32x16_bf16 v[64:79], v[172:175], v[204:207], v[64:79]
  ds_read_b64_tr_b16 v[156:157], v211 offset:57344
  ds_read_b64_tr_b16 v[158:159], v211 offset:58368
  v_cvt_pk_bf16_f32 v202, v196, v197
  v_cvt_pk_bf16_f32 v203, v198, v199
  s_add_u32 s55, s54, 24576
  buffer_load_dwordx4 v[112:115], v5, s[8:11], s55 offen offset:0 sc1
  s_waitcnt lgkmcnt(8)
  v_mfma_f32_32x32x16_bf16 v[16:31], v[144:147], v[200:203], v[16:31]
  ds_read_b64_tr_b16 v[160:161], v208 offset:61440
  ds_read_b64_tr_b16 v[162:163], v208 offset:62464
  ds_read_b128 v[176:179], v14 offset:1792
  s_waitcnt lgkmcnt(7)
  s_waitcnt vmcnt(9)
  v_fma_mix_f32 v192, v140, v184, v188 op_sel:[0,0,0] op_sel_hi:[1,1,1]
  v_fma_mix_f32 v193, v140, v184, v188 op_sel:[1,1,1] op_sel_hi:[1,1,1]
  v_fma_mix_f32 v194, v141, v185, v189 op_sel:[0,0,0] op_sel_hi:[1,1,1]
  v_mfma_f32_32x32x16_bf16 v[32:47], v[148:151], v[200:203], v[32:47]
  ds_read_b64_tr_b16 v[164:165], v209 offset:61440
  ds_read_b64_tr_b16 v[166:167], v209 offset:62464
  ds_read_b128 v[180:183], v14 offset:512
  v_fma_mix_f32 v195, v141, v185, v189 op_sel:[1,1,1] op_sel_hi:[1,1,1]
  v_fma_mix_f32 v196, v142, v186, v190 op_sel:[0,0,0] op_sel_hi:[1,1,1]
  v_fma_mix_f32 v197, v142, v186, v190 op_sel:[1,1,1] op_sel_hi:[1,1,1]
  s_waitcnt lgkmcnt(8)
  v_mfma_f32_32x32x16_bf16 v[48:63], v[152:155], v[200:203], v[48:63]
  ds_read_b64_tr_b16 v[168:169], v210 offset:61440
  ds_read_b64_tr_b16 v[170:171], v210 offset:62464
  v_fma_mix_f32 v198, v143, v187, v191 op_sel:[0,0,0] op_sel_hi:[1,1,1]
  v_fma_mix_f32 v199, v143, v187, v191 op_sel:[1,1,1] op_sel_hi:[1,1,1]
  v_cvt_pk_bf16_f32 v204, v192, v193
  v_cvt_pk_bf16_f32 v205, v194, v195
  s_waitcnt lgkmcnt(8)
  v_mfma_f32_32x32x16_bf16 v[64:79], v[156:159], v[200:203], v[64:79]
  ds_read_b64_tr_b16 v[172:173], v211 offset:61440
  ds_read_b64_tr_b16 v[174:175], v211 offset:62464
  v_cvt_pk_bf16_f32 v206, v196, v197
  v_cvt_pk_bf16_f32 v207, v198, v199
  buffer_load_dwordx4 v[116:119], v5, s[8:11], s55 offen offset:1024 sc1
  s_waitcnt lgkmcnt(8)
  v_mfma_f32_32x32x16_bf16 v[16:31], v[160:163], v[204:207], v[16:31]
  ds_read_b64_tr_b16 v[144:145], v212 offset:0
  ds_read_b64_tr_b16 v[146:147], v212 offset:1024
  ds_read_b128 v[184:187], v14 offset:1824
  s_waitcnt lgkmcnt(7)
  s_waitcnt vmcnt(9)
  v_fma_mix_f32 v192, v80, v176, v180 op_sel:[0,0,0] op_sel_hi:[1,1,1]
  v_fma_mix_f32 v193, v80, v176, v180 op_sel:[1,1,1] op_sel_hi:[1,1,1]
  v_fma_mix_f32 v194, v81, v177, v181 op_sel:[0,0,0] op_sel_hi:[1,1,1]
  v_mfma_f32_32x32x16_bf16 v[32:47], v[164:167], v[204:207], v[32:47]
  ds_read_b64_tr_b16 v[148:149], v213 offset:0
  ds_read_b64_tr_b16 v[150:151], v213 offset:1024
  ds_read_b128 v[188:191], v14 offset:544
  v_fma_mix_f32 v195, v81, v177, v181 op_sel:[1,1,1] op_sel_hi:[1,1,1]
  v_fma_mix_f32 v196, v82, v178, v182 op_sel:[0,0,0] op_sel_hi:[1,1,1]
  v_fma_mix_f32 v197, v82, v178, v182 op_sel:[1,1,1] op_sel_hi:[1,1,1]
  s_waitcnt lgkmcnt(8)
  v_mfma_f32_32x32x16_bf16 v[48:63], v[168:171], v[204:207], v[48:63]
  ds_read_b64_tr_b16 v[152:153], v214 offset:0
  ds_read_b64_tr_b16 v[154:155], v214 offset:1024
  v_fma_mix_f32 v198, v83, v179, v183 op_sel:[0,0,0] op_sel_hi:[1,1,1]
  v_fma_mix_f32 v199, v83, v179, v183 op_sel:[1,1,1] op_sel_hi:[1,1,1]
  v_cvt_pk_bf16_f32 v200, v192, v193
  v_cvt_pk_bf16_f32 v201, v194, v195
  s_waitcnt lgkmcnt(8)
  v_mfma_f32_32x32x16_bf16 v[64:79], v[172:175], v[204:207], v[64:79]
  ds_read_b64_tr_b16 v[156:157], v215 offset:0
  ds_read_b64_tr_b16 v[158:159], v215 offset:1024
  v_cvt_pk_bf16_f32 v202, v196, v197
  v_cvt_pk_bf16_f32 v203, v198, v199
  buffer_load_dwordx4 v[120:123], v5, s[8:11], s55 offen offset:2048 sc1
  s_waitcnt lgkmcnt(8)
  v_mfma_f32_32x32x16_bf16 v[16:31], v[144:147], v[200:203], v[16:31]
  ds_read_b64_tr_b16 v[160:161], v212 offset:4096
  ds_read_b64_tr_b16 v[162:163], v212 offset:5120
  ds_read_b128 v[176:179], v14 offset:1856
  s_waitcnt lgkmcnt(7)
  s_waitcnt vmcnt(9)
  v_fma_mix_f32 v192, v84, v184, v188 op_sel:[0,0,0] op_sel_hi:[1,1,1]
  v_fma_mix_f32 v193, v84, v184, v188 op_sel:[1,1,1] op_sel_hi:[1,1,1]
  v_fma_mix_f32 v194, v85, v185, v189 op_sel:[0,0,0] op_sel_hi:[1,1,1]
  v_mfma_f32_32x32x16_bf16 v[32:47], v[148:151], v[200:203], v[32:47]
  ds_read_b64_tr_b16 v[164:165], v213 offset:4096
  ds_read_b64_tr_b16 v[166:167], v213 offset:5120
  ds_read_b128 v[180:183], v14 offset:576
  v_fma_mix_f32 v195, v85, v185, v189 op_sel:[1,1,1] op_sel_hi:[1,1,1]
  v_fma_mix_f32 v196, v86, v186, v190 op_sel:[0,0,0] op_sel_hi:[1,1,1]
  v_fma_mix_f32 v197, v86, v186, v190 op_sel:[1,1,1] op_sel_hi:[1,1,1]
  s_waitcnt lgkmcnt(8)
  v_mfma_f32_32x32x16_bf16 v[48:63], v[152:155], v[200:203], v[48:63]
  ds_read_b64_tr_b16 v[168:169], v214 offset:4096
  ds_read_b64_tr_b16 v[170:171], v214 offset:5120
  v_fma_mix_f32 v198, v87, v187, v191 op_sel:[0,0,0] op_sel_hi:[1,1,1]
  v_fma_mix_f32 v199, v87, v187, v191 op_sel:[1,1,1] op_sel_hi:[1,1,1]
  v_cvt_pk_bf16_f32 v204, v192, v193
  v_cvt_pk_bf16_f32 v205, v194, v195
  s_waitcnt lgkmcnt(8)
  v_mfma_f32_32x32x16_bf16 v[64:79], v[156:159], v[200:203], v[64:79]
  ds_read_b64_tr_b16 v[172:173], v215 offset:4096
  ds_read_b64_tr_b16 v[174:175], v215 offset:5120
  v_cvt_pk_bf16_f32 v206, v196, v197
  v_cvt_pk_bf16_f32 v207, v198, v199
  buffer_load_dwordx4 v[124:127], v5, s[8:11], s55 offen offset:3072 sc1
  s_waitcnt lgkmcnt(8)
  v_mfma_f32_32x32x16_bf16 v[16:31], v[160:163], v[204:207], v[16:31]
  ds_read_b64_tr_b16 v[144:145], v212 offset:8192
  ds_read_b64_tr_b16 v[146:147], v212 offset:9216
  ds_read_b128 v[184:187], v14 offset:1888
  s_waitcnt lgkmcnt(7)
  s_waitcnt vmcnt(9)
  v_fma_mix_f32 v192, v88, v176, v180 op_sel:[0,0,0] op_sel_hi:[1,1,1]
  v_fma_mix_f32 v193, v88, v176, v180 op_sel:[1,1,1] op_sel_hi:[1,1,1]
  v_fma_mix_f32 v194, v89, v177, v181 op_sel:[0,0,0] op_sel_hi:[1,1,1]
  v_mfma_f32_32x32x16_bf16 v[32:47], v[164:167], v[204:207], v[32:47]
  ds_read_b64_tr_b16 v[148:149], v213 offset:8192
  ds_read_b64_tr_b16 v[150:151], v213 offset:9216
  ds_read_b128 v[188:191], v14 offset:608
  v_fma_mix_f32 v195, v89, v177, v181 op_sel:[1,1,1] op_sel_hi:[1,1,1]
  v_fma_mix_f32 v196, v90, v178, v182 op_sel:[0,0,0] op_sel_hi:[1,1,1]
  v_fma_mix_f32 v197, v90, v178, v182 op_sel:[1,1,1] op_sel_hi:[1,1,1]
  s_waitcnt lgkmcnt(8)
  v_mfma_f32_32x32x16_bf16 v[48:63], v[168:171], v[204:207], v[48:63]
  ds_read_b64_tr_b16 v[152:153], v214 offset:8192
  ds_read_b64_tr_b16 v[154:155], v214 offset:9216
  v_fma_mix_f32 v198, v91, v179, v183 op_sel:[0,0,0] op_sel_hi:[1,1,1]
  v_fma_mix_f32 v199, v91, v179, v183 op_sel:[1,1,1] op_sel_hi:[1,1,1]
  v_cvt_pk_bf16_f32 v200, v192, v193
  v_cvt_pk_bf16_f32 v201, v194, v195
  s_waitcnt lgkmcnt(8)
  v_mfma_f32_32x32x16_bf16 v[64:79], v[172:175], v[204:207], v[64:79]
  ds_read_b64_tr_b16 v[156:157], v215 offset:8192
  ds_read_b64_tr_b16 v[158:159], v215 offset:9216
  v_cvt_pk_bf16_f32 v202, v196, v197
  v_cvt_pk_bf16_f32 v203, v198, v199
  s_add_u32 s55, s54, 28672
  buffer_load_dwordx4 v[128:131], v5, s[8:11], s55 offen offset:0 sc1
  s_waitcnt lgkmcnt(8)
  v_mfma_f32_32x32x16_bf16 v[16:31], v[144:147], v[200:203], v[16:31]
  ds_read_b64_tr_b16 v[160:161], v212 offset:12288
  ds_read_b64_tr_b16 v[162:163], v212 offset:13312
  ds_read_b128 v[176:179], v14 offset:1920
  s_waitcnt lgkmcnt(7)
  s_waitcnt vmcnt(9)
  v_fma_mix_f32 v192, v92, v184, v188 op_sel:[0,0,0] op_sel_hi:[1,1,1]
  v_fma_mix_f32 v193, v92, v184, v188 op_sel:[1,1,1] op_sel_hi:[1,1,1]
  v_fma_mix_f32 v194, v93, v185, v189 op_sel:[0,0,0] op_sel_hi:[1,1,1]
  v_mfma_f32_32x32x16_bf16 v[32:47], v[148:151], v[200:203], v[32:47]
  ds_read_b64_tr_b16 v[164:165], v213 offset:12288
  ds_read_b64_tr_b16 v[166:167], v213 offset:13312
  ds_read_b128 v[180:183], v14 offset:640
  v_fma_mix_f32 v195, v93, v185, v189 op_sel:[1,1,1] op_sel_hi:[1,1,1]
  v_fma_mix_f32 v196, v94, v186, v190 op_sel:[0,0,0] op_sel_hi:[1,1,1]
  v_fma_mix_f32 v197, v94, v186, v190 op_sel:[1,1,1] op_sel_hi:[1,1,1]
  s_waitcnt lgkmcnt(8)
  v_mfma_f32_32x32x16_bf16 v[48:63], v[152:155], v[200:203], v[48:63]
  ds_read_b64_tr_b16 v[168:169], v214 offset:12288
  ds_read_b64_tr_b16 v[170:171], v214 offset:13312
  v_fma_mix_f32 v198, v95, v187, v191 op_sel:[0,0,0] op_sel_hi:[1,1,1]
  v_fma_mix_f32 v199, v95, v187, v191 op_sel:[1,1,1] op_sel_hi:[1,1,1]
  v_cvt_pk_bf16_f32 v204, v192, v193
  v_cvt_pk_bf16_f32 v205, v194, v195
  s_waitcnt lgkmcnt(8)
  v_mfma_f32_32x32x16_bf16 v[64:79], v[156:159], v[200:203], v[64:79]
  ds_read_b64_tr_b16 v[172:173], v215 offset:12288
  ds_read_b64_tr_b16 v[174:175], v215 offset:13312
  v_cvt_pk_bf16_f32 v206, v196, v197
  v_cvt_pk_bf16_f32 v207, v198, v199
  buffer_load_dwordx4 v[132:135], v5, s[8:11], s55 offen offset:1024 sc1
  s_waitcnt lgkmcnt(8)
  v_mfma_f32_32x32x16_bf16 v[16:31], v[160:163], v[204:207], v[16:31]
  ds_read_b64_tr_b16 v[144:145], v212 offset:16384
  ds_read_b64_tr_b16 v[146:147], v212 offset:17408
  ds_read_b128 v[184:187], v14 offset:1952
  s_waitcnt lgkmcnt(7)
  s_waitcnt vmcnt(9)
  v_fma_mix_f32 v192, v96, v176, v180 op_sel:[0,0,0] op_sel_hi:[1,1,1]
  v_fma_mix_f32 v193, v96, v176, v180 op_sel:[1,1,1] op_sel_hi:[1,1,1]
  v_fma_mix_f32 v194, v97, v177, v181 op_sel:[0,0,0] op_sel_hi:[1,1,1]
  v_mfma_f32_32x32x16_bf16 v[32:47], v[164:167], v[204:207], v[32:47]
  ds_read_b64_tr_b16 v[148:149], v213 offset:16384
  ds_read_b64_tr_b16 v[150:151], v213 offset:17408
  ds_read_b128 v[188:191], v14 offset:672
  v_fma_mix_f32 v195, v97, v177, v181 op_sel:[1,1,1] op_sel_hi:[1,1,1]
  v_fma_mix_f32 v196, v98, v178, v182 op_sel:[0,0,0] op_sel_hi:[1,1,1]
  v_fma_mix_f32 v197, v98, v178, v182 op_sel:[1,1,1] op_sel_hi:[1,1,1]
  s_waitcnt lgkmcnt(8)
  v_mfma_f32_32x32x16_bf16 v[48:63], v[168:171], v[204:207], v[48:63]
  ds_read_b64_tr_b16 v[152:153], v214 offset:16384
  ds_read_b64_tr_b16 v[154:155], v214 offset:17408
  v_fma_mix_f32 v198, v99, v179, v183 op_sel:[0,0,0] op_sel_hi:[1,1,1]
  v_fma_mix_f32 v199, v99, v179, v183 op_sel:[1,1,1] op_sel_hi:[1,1,1]
  v_cvt_pk_bf16_f32 v200, v192, v193
  v_cvt_pk_bf16_f32 v201, v194, v195
  s_waitcnt lgkmcnt(8)
  v_mfma_f32_32x32x16_bf16 v[64:79], v[172:175], v[204:207], v[64:79]
  ds_read_b64_tr_b16 v[156:157], v215 offset:16384
  ds_read_b64_tr_b16 v[158:159], v215 offset:17408
  v_cvt_pk_bf16_f32 v202, v196, v197
  v_cvt_pk_bf16_f32 v203, v198, v199
  buffer_load_dwordx4 v[136:139], v5, s[8:11], s55 offen offset:2048 sc1
  s_waitcnt lgkmcnt(8)
  v_mfma_f32_32x32x16_bf16 v[16:31], v[144:147], v[200:203], v[16:31]
  ds_read_b64_tr_b16 v[160:161], v212 offset:20480
  ds_read_b64_tr_b16 v[162:163], v212 offset:21504
  ds_read_b128 v[176:179], v14 offset:1984
  s_waitcnt lgkmcnt(7)
  s_waitcnt vmcnt(9)
  v_fma_mix_f32 v192, v100, v184, v188 op_sel:[0,0,0] op_sel_hi:[1,1,1]
  v_fma_mix_f32 v193, v100, v184, v188 op_sel:[1,1,1] op_sel_hi:[1,1,1]
  v_fma_mix_f32 v194, v101, v185, v189 op_sel:[0,0,0] op_sel_hi:[1,1,1]
  v_mfma_f32_32x32x16_bf16 v[32:47], v[148:151], v[200:203], v[32:47]
  ds_read_b64_tr_b16 v[164:165], v213 offset:20480
  ds_read_b64_tr_b16 v[166:167], v213 offset:21504
  ds_read_b128 v[180:183], v14 offset:704
  v_fma_mix_f32 v195, v101, v185, v189 op_sel:[1,1,1] op_sel_hi:[1,1,1]
  v_fma_mix_f32 v196, v102, v186, v190 op_sel:[0,0,0] op_sel_hi:[1,1,1]
  v_fma_mix_f32 v197, v102, v186, v190 op_sel:[1,1,1] op_sel_hi:[1,1,1]
  s_waitcnt lgkmcnt(8)
  v_mfma_f32_32x32x16_bf16 v[48:63], v[152:155], v[200:203], v[48:63]
  ds_read_b64_tr_b16 v[168:169], v214 offset:20480
  ds_read_b64_tr_b16 v[170:171], v214 offset:21504
  v_fma_mix_f32 v198, v103, v187, v191 op_sel:[0,0,0] op_sel_hi:[1,1,1]
  v_fma_mix_f32 v199, v103, v187, v191 op_sel:[1,1,1] op_sel_hi:[1,1,1]
  v_cvt_pk_bf16_f32 v204, v192, v193
  v_cvt_pk_bf16_f32 v205, v194, v195
  s_waitcnt lgkmcnt(8)
  v_mfma_f32_32x32x16_bf16 v[64:79], v[156:159], v[200:203], v[64:79]
  ds_read_b64_tr_b16 v[172:173], v215 offset:20480
  ds_read_b64_tr_b16 v[174:175], v215 offset:21504
  v_cvt_pk_bf16_f32 v206, v196, v197
  v_cvt_pk_bf16_f32 v207, v198, v199
  buffer_load_dwordx4 v[140:143], v5, s[8:11], s55 offen offset:3072 sc1
  s_waitcnt lgkmcnt(8)
  v_mfma_f32_32x32x16_bf16 v[16:31], v[160:163], v[204:207], v[16:31]
  ds_read_b64_tr_b16 v[144:145], v212 offset:24576
  ds_read_b64_tr_b16 v[146:147], v212 offset:25600
  ds_read_b128 v[184:187], v14 offset:2016
  s_waitcnt lgkmcnt(7)
  s_waitcnt vmcnt(9)
  v_fma_mix_f32 v192, v104, v176, v180 op_sel:[0,0,0] op_sel_hi:[1,1,1]
  v_fma_mix_f32 v193, v104, v176, v180 op_sel:[1,1,1] op_sel_hi:[1,1,1]
  v_fma_mix_f32 v194, v105, v177, v181 op_sel:[0,0,0] op_sel_hi:[1,1,1]
  v_mfma_f32_32x32x16_bf16 v[32:47], v[164:167], v[204:207], v[32:47]
  ds_read_b64_tr_b16 v[148:149], v213 offset:24576
  ds_read_b64_tr_b16 v[150:151], v213 offset:25600
  ds_read_b128 v[188:191], v14 offset:736
  v_fma_mix_f32 v195, v105, v177, v181 op_sel:[1,1,1] op_sel_hi:[1,1,1]
  v_fma_mix_f32 v196, v106, v178, v182 op_sel:[0,0,0] op_sel_hi:[1,1,1]
  v_fma_mix_f32 v197, v106, v178, v182 op_sel:[1,1,1] op_sel_hi:[1,1,1]
  s_waitcnt lgkmcnt(8)
  v_mfma_f32_32x32x16_bf16 v[48:63], v[168:171], v[204:207], v[48:63]
  ds_read_b64_tr_b16 v[152:153], v214 offset:24576
  ds_read_b64_tr_b16 v[154:155], v214 offset:25600
  v_fma_mix_f32 v198, v107, v179, v183 op_sel:[0,0,0] op_sel_hi:[1,1,1]
  v_fma_mix_f32 v199, v107, v179, v183 op_sel:[1,1,1] op_sel_hi:[1,1,1]
  v_cvt_pk_bf16_f32 v200, v192, v193
  v_cvt_pk_bf16_f32 v201, v194, v195
  s_waitcnt lgkmcnt(8)
  v_mfma_f32_32x32x16_bf16 v[64:79], v[172:175], v[204:207], v[64:79]
  ds_read_b64_tr_b16 v[156:157], v215 offset:24576
  ds_read_b64_tr_b16 v[158:159], v215 offset:25600
  v_cvt_pk_bf16_f32 v202, v196, v197
  v_cvt_pk_bf16_f32 v203, v198, v199
  s_add_u32 s55, s54, 32768
  buffer_load_dwordx4 v[80:83], v5, s[8:11], s55 offen offset:0 sc1
  s_waitcnt lgkmcnt(8)
  v_mfma_f32_32x32x16_bf16 v[16:31], v[144:147], v[200:203], v[16:31]
  ds_read_b64_tr_b16 v[160:161], v212 offset:28672
  ds_read_b64_tr_b16 v[162:163], v212 offset:29696
  ds_read_b128 v[176:179], v14 offset:2048
  s_waitcnt lgkmcnt(7)
  s_waitcnt vmcnt(9)
  v_fma_mix_f32 v192, v108, v184, v188 op_sel:[0,0,0] op_sel_hi:[1,1,1]
  v_fma_mix_f32 v193, v108, v184, v188 op_sel:[1,1,1] op_sel_hi:[1,1,1]
  v_fma_mix_f32 v194, v109, v185, v189 op_sel:[0,0,0] op_sel_hi:[1,1,1]
  v_mfma_f32_32x32x16_bf16 v[32:47], v[148:151], v[200:203], v[32:47]
  ds_read_b64_tr_b16 v[164:165], v213 offset:28672
  ds_read_b64_tr_b16 v[166:167], v213 offset:29696
  ds_read_b128 v[180:183], v14 offset:768
  v_fma_mix_f32 v195, v109, v185, v189 op_sel:[1,1,1] op_sel_hi:[1,1,1]
  v_fma_mix_f32 v196, v110, v186, v190 op_sel:[0,0,0] op_sel_hi:[1,1,1]
  v_fma_mix_f32 v197, v110, v186, v190 op_sel:[1,1,1] op_sel_hi:[1,1,1]
  s_waitcnt lgkmcnt(8)
  v_mfma_f32_32x32x16_bf16 v[48:63], v[152:155], v[200:203], v[48:63]
  ds_read_b64_tr_b16 v[168:169], v214 offset:28672
  ds_read_b64_tr_b16 v[170:171], v214 offset:29696
  v_fma_mix_f32 v198, v111, v187, v191 op_sel:[0,0,0] op_sel_hi:[1,1,1]
  v_fma_mix_f32 v199, v111, v187, v191 op_sel:[1,1,1] op_sel_hi:[1,1,1]
  v_cvt_pk_bf16_f32 v204, v192, v193
  v_cvt_pk_bf16_f32 v205, v194, v195
  s_waitcnt lgkmcnt(8)
  v_mfma_f32_32x32x16_bf16 v[64:79], v[156:159], v[200:203], v[64:79]
  ds_read_b64_tr_b16 v[172:173], v215 offset:28672
  ds_read_b64_tr_b16 v[174:175], v215 offset:29696
  v_cvt_pk_bf16_f32 v206, v196, v197
  v_cvt_pk_bf16_f32 v207, v198, v199
  buffer_load_dwordx4 v[84:87], v5, s[8:11], s55 offen offset:1024 sc1
  s_waitcnt lgkmcnt(8)
  v_mfma_f32_32x32x16_bf16 v[16:31], v[160:163], v[204:207], v[16:31]
  ds_read_b64_tr_b16 v[144:145], v212 offset:32768
  ds_read_b64_tr_b16 v[146:147], v212 offset:33792
  ds_read_b128 v[184:187], v14 offset:2080
  s_waitcnt lgkmcnt(7)
  s_waitcnt vmcnt(9)
  v_fma_mix_f32 v192, v112, v176, v180 op_sel:[0,0,0] op_sel_hi:[1,1,1]
  v_fma_mix_f32 v193, v112, v176, v180 op_sel:[1,1,1] op_sel_hi:[1,1,1]
  v_fma_mix_f32 v194, v113, v177, v181 op_sel:[0,0,0] op_sel_hi:[1,1,1]
  v_mfma_f32_32x32x16_bf16 v[32:47], v[164:167], v[204:207], v[32:47]
  ds_read_b64_tr_b16 v[148:149], v213 offset:32768
  ds_read_b64_tr_b16 v[150:151], v213 offset:33792
  ds_read_b128 v[188:191], v14 offset:800
  v_fma_mix_f32 v195, v113, v177, v181 op_sel:[1,1,1] op_sel_hi:[1,1,1]
  v_fma_mix_f32 v196, v114, v178, v182 op_sel:[0,0,0] op_sel_hi:[1,1,1]
  v_fma_mix_f32 v197, v114, v178, v182 op_sel:[1,1,1] op_sel_hi:[1,1,1]
  s_waitcnt lgkmcnt(8)
  v_mfma_f32_32x32x16_bf16 v[48:63], v[168:171], v[204:207], v[48:63]
  ds_read_b64_tr_b16 v[152:153], v214 offset:32768
  ds_read_b64_tr_b16 v[154:155], v214 offset:33792
  v_fma_mix_f32 v198, v115, v179, v183 op_sel:[0,0,0] op_sel_hi:[1,1,1]
  v_fma_mix_f32 v199, v115, v179, v183 op_sel:[1,1,1] op_sel_hi:[1,1,1]
  v_cvt_pk_bf16_f32 v200, v192, v193
  v_cvt_pk_bf16_f32 v201, v194, v195
  s_waitcnt lgkmcnt(8)
  v_mfma_f32_32x32x16_bf16 v[64:79], v[172:175], v[204:207], v[64:79]
  ds_read_b64_tr_b16 v[156:157], v215 offset:32768
  ds_read_b64_tr_b16 v[158:159], v215 offset:33792
  v_cvt_pk_bf16_f32 v202, v196, v197
  v_cvt_pk_bf16_f32 v203, v198, v199
  buffer_load_dwordx4 v[88:91], v5, s[8:11], s55 offen offset:2048 sc1
  s_waitcnt lgkmcnt(8)
  v_mfma_f32_32x32x16_bf16 v[16:31], v[144:147], v[200:203], v[16:31]
  ds_read_b64_tr_b16 v[160:161], v212 offset:36864
  ds_read_b64_tr_b16 v[162:163], v212 offset:37888
  ds_read_b128 v[176:179], v14 offset:2112
  s_waitcnt lgkmcnt(7)
  s_waitcnt vmcnt(9)
  v_fma_mix_f32 v192, v116, v184, v188 op_sel:[0,0,0] op_sel_hi:[1,1,1]
  v_fma_mix_f32 v193, v116, v184, v188 op_sel:[1,1,1] op_sel_hi:[1,1,1]
  v_fma_mix_f32 v194, v117, v185, v189 op_sel:[0,0,0] op_sel_hi:[1,1,1]
  v_mfma_f32_32x32x16_bf16 v[32:47], v[148:151], v[200:203], v[32:47]
  ds_read_b64_tr_b16 v[164:165], v213 offset:36864
  ds_read_b64_tr_b16 v[166:167], v213 offset:37888
  ds_read_b128 v[180:183], v14 offset:832
  v_fma_mix_f32 v195, v117, v185, v189 op_sel:[1,1,1] op_sel_hi:[1,1,1]
  v_fma_mix_f32 v196, v118, v186, v190 op_sel:[0,0,0] op_sel_hi:[1,1,1]
  v_fma_mix_f32 v197, v118, v186, v190 op_sel:[1,1,1] op_sel_hi:[1,1,1]
  s_waitcnt lgkmcnt(8)
  v_mfma_f32_32x32x16_bf16 v[48:63], v[152:155], v[200:203], v[48:63]
  ds_read_b64_tr_b16 v[168:169], v214 offset:36864
  ds_read_b64_tr_b16 v[170:171], v214 offset:37888
  v_fma_mix_f32 v198, v119, v187, v191 op_sel:[0,0,0] op_sel_hi:[1,1,1]
  v_fma_mix_f32 v199, v119, v187, v191 op_sel:[1,1,1] op_sel_hi:[1,1,1]
  v_cvt_pk_bf16_f32 v204, v192, v193
  v_cvt_pk_bf16_f32 v205, v194, v195
  s_waitcnt lgkmcnt(8)
  v_mfma_f32_32x32x16_bf16 v[64:79], v[156:159], v[200:203], v[64:79]
  ds_read_b64_tr_b16 v[172:173], v215 offset:36864
  ds_read_b64_tr_b16 v[174:175], v215 offset:37888
  v_cvt_pk_bf16_f32 v206, v196, v197
  v_cvt_pk_bf16_f32 v207, v198, v199
  buffer_load_dwordx4 v[92:95], v5, s[8:11], s55 offen offset:3072 sc1
  s_waitcnt lgkmcnt(8)
  v_mfma_f32_32x32x16_bf16 v[16:31], v[160:163], v[204:207], v[16:31]
  ds_read_b64_tr_b16 v[144:145], v212 offset:40960
  ds_read_b64_tr_b16 v[146:147], v212 offset:41984
  ds_read_b128 v[184:187], v14 offset:2144
  s_waitcnt lgkmcnt(7)
  s_waitcnt vmcnt(9)
  v_fma_mix_f32 v192, v120, v176, v180 op_sel:[0,0,0] op_sel_hi:[1,1,1]
  v_fma_mix_f32 v193, v120, v176, v180 op_sel:[1,1,1] op_sel_hi:[1,1,1]
  v_fma_mix_f32 v194, v121, v177, v181 op_sel:[0,0,0] op_sel_hi:[1,1,1]
  v_mfma_f32_32x32x16_bf16 v[32:47], v[164:167], v[204:207], v[32:47]
  ds_read_b64_tr_b16 v[148:149], v213 offset:40960
  ds_read_b64_tr_b16 v[150:151], v213 offset:41984
  ds_read_b128 v[188:191], v14 offset:864
  v_fma_mix_f32 v195, v121, v177, v181 op_sel:[1,1,1] op_sel_hi:[1,1,1]
  v_fma_mix_f32 v196, v122, v178, v182 op_sel:[0,0,0] op_sel_hi:[1,1,1]
  v_fma_mix_f32 v197, v122, v178, v182 op_sel:[1,1,1] op_sel_hi:[1,1,1]
  s_waitcnt lgkmcnt(8)
  v_mfma_f32_32x32x16_bf16 v[48:63], v[168:171], v[204:207], v[48:63]
  ds_read_b64_tr_b16 v[152:153], v214 offset:40960
  ds_read_b64_tr_b16 v[154:155], v214 offset:41984
  v_fma_mix_f32 v198, v123, v179, v183 op_sel:[0,0,0] op_sel_hi:[1,1,1]
  v_fma_mix_f32 v199, v123, v179, v183 op_sel:[1,1,1] op_sel_hi:[1,1,1]
  v_cvt_pk_bf16_f32 v200, v192, v193
  v_cvt_pk_bf16_f32 v201, v194, v195
  s_waitcnt lgkmcnt(8)
  v_mfma_f32_32x32x16_bf16 v[64:79], v[172:175], v[204:207], v[64:79]
  ds_read_b64_tr_b16 v[156:157], v215 offset:40960
  ds_read_b64_tr_b16 v[158:159], v215 offset:41984
  v_cvt_pk_bf16_f32 v202, v196, v197
  v_cvt_pk_bf16_f32 v203, v198, v199
  s_add_u32 s55, s54, 36864
  buffer_load_dwordx4 v[96:99], v5, s[8:11], s55 offen offset:0 sc1
  s_waitcnt lgkmcnt(8)
  v_mfma_f32_32x32x16_bf16 v[16:31], v[144:147], v[200:203], v[16:31]
  ds_read_b64_tr_b16 v[160:161], v212 offset:45056
  ds_read_b64_tr_b16 v[162:163], v212 offset:46080
  ds_read_b128 v[176:179], v14 offset:2176
  s_waitcnt lgkmcnt(7)
  s_waitcnt vmcnt(9)
  v_fma_mix_f32 v192, v124, v184, v188 op_sel:[0,0,0] op_sel_hi:[1,1,1]
  v_fma_mix_f32 v193, v124, v184, v188 op_sel:[1,1,1] op_sel_hi:[1,1,1]
  v_fma_mix_f32 v194, v125, v185, v189 op_sel:[0,0,0] op_sel_hi:[1,1,1]
  v_mfma_f32_32x32x16_bf16 v[32:47], v[148:151], v[200:203], v[32:47]
  ds_read_b64_tr_b16 v[164:165], v213 offset:45056
  ds_read_b64_tr_b16 v[166:167], v213 offset:46080
  ds_read_b128 v[180:183], v14 offset:896
  v_fma_mix_f32 v195, v125, v185, v189 op_sel:[1,1,1] op_sel_hi:[1,1,1]
  v_fma_mix_f32 v196, v126, v186, v190 op_sel:[0,0,0] op_sel_hi:[1,1,1]
  v_fma_mix_f32 v197, v126, v186, v190 op_sel:[1,1,1] op_sel_hi:[1,1,1]
  s_waitcnt lgkmcnt(8)
  v_mfma_f32_32x32x16_bf16 v[48:63], v[152:155], v[200:203], v[48:63]
  ds_read_b64_tr_b16 v[168:169], v214 offset:45056
  ds_read_b64_tr_b16 v[170:171], v214 offset:46080
  v_fma_mix_f32 v198, v127, v187, v191 op_sel:[0,0,0] op_sel_hi:[1,1,1]
  v_fma_mix_f32 v199, v127, v187, v191 op_sel:[1,1,1] op_sel_hi:[1,1,1]
  v_cvt_pk_bf16_f32 v204, v192, v193
  v_cvt_pk_bf16_f32 v205, v194, v195
  s_waitcnt lgkmcnt(8)
  v_mfma_f32_32x32x16_bf16 v[64:79], v[156:159], v[200:203], v[64:79]
  ds_read_b64_tr_b16 v[172:173], v215 offset:45056
  ds_read_b64_tr_b16 v[174:175], v215 offset:46080
  v_cvt_pk_bf16_f32 v206, v196, v197
  v_cvt_pk_bf16_f32 v207, v198, v199
  buffer_load_dwordx4 v[100:103], v5, s[8:11], s55 offen offset:1024 sc1
  s_waitcnt lgkmcnt(8)
  v_mfma_f32_32x32x16_bf16 v[16:31], v[160:163], v[204:207], v[16:31]
  ds_read_b64_tr_b16 v[144:145], v212 offset:49152
  ds_read_b64_tr_b16 v[146:147], v212 offset:50176
  ds_read_b128 v[184:187], v14 offset:2208
  s_waitcnt lgkmcnt(7)
  s_waitcnt vmcnt(9)
  v_fma_mix_f32 v192, v128, v176, v180 op_sel:[0,0,0] op_sel_hi:[1,1,1]
  v_fma_mix_f32 v193, v128, v176, v180 op_sel:[1,1,1] op_sel_hi:[1,1,1]
  v_fma_mix_f32 v194, v129, v177, v181 op_sel:[0,0,0] op_sel_hi:[1,1,1]
  v_mfma_f32_32x32x16_bf16 v[32:47], v[164:167], v[204:207], v[32:47]
  ds_read_b64_tr_b16 v[148:149], v213 offset:49152
  ds_read_b64_tr_b16 v[150:151], v213 offset:50176
  ds_read_b128 v[188:191], v14 offset:928
  v_fma_mix_f32 v195, v129, v177, v181 op_sel:[1,1,1] op_sel_hi:[1,1,1]
  v_fma_mix_f32 v196, v130, v178, v182 op_sel:[0,0,0] op_sel_hi:[1,1,1]
  v_fma_mix_f32 v197, v130, v178, v182 op_sel:[1,1,1] op_sel_hi:[1,1,1]
  s_waitcnt lgkmcnt(8)
  v_mfma_f32_32x32x16_bf16 v[48:63], v[168:171], v[204:207], v[48:63]
  ds_read_b64_tr_b16 v[152:153], v214 offset:49152
  ds_read_b64_tr_b16 v[154:155], v214 offset:50176
  v_fma_mix_f32 v198, v131, v179, v183 op_sel:[0,0,0] op_sel_hi:[1,1,1]
  v_fma_mix_f32 v199, v131, v179, v183 op_sel:[1,1,1] op_sel_hi:[1,1,1]
  v_cvt_pk_bf16_f32 v200, v192, v193
  v_cvt_pk_bf16_f32 v201, v194, v195
  s_waitcnt lgkmcnt(8)
  v_mfma_f32_32x32x16_bf16 v[64:79], v[172:175], v[204:207], v[64:79]
  ds_read_b64_tr_b16 v[156:157], v215 offset:49152
  ds_read_b64_tr_b16 v[158:159], v215 offset:50176
  v_cvt_pk_bf16_f32 v202, v196, v197
  v_cvt_pk_bf16_f32 v203, v198, v199
  buffer_load_dwordx4 v[104:107], v5, s[8:11], s55 offen offset:2048 sc1
  s_waitcnt lgkmcnt(8)
  v_mfma_f32_32x32x16_bf16 v[16:31], v[144:147], v[200:203], v[16:31]
  ds_read_b64_tr_b16 v[160:161], v212 offset:53248
  ds_read_b64_tr_b16 v[162:163], v212 offset:54272
  ds_read_b128 v[176:179], v14 offset:2240
  s_waitcnt lgkmcnt(7)
  s_waitcnt vmcnt(9)
  v_fma_mix_f32 v192, v132, v184, v188 op_sel:[0,0,0] op_sel_hi:[1,1,1]
  v_fma_mix_f32 v193, v132, v184, v188 op_sel:[1,1,1] op_sel_hi:[1,1,1]
  v_fma_mix_f32 v194, v133, v185, v189 op_sel:[0,0,0] op_sel_hi:[1,1,1]
  v_mfma_f32_32x32x16_bf16 v[32:47], v[148:151], v[200:203], v[32:47]
  ds_read_b64_tr_b16 v[164:165], v213 offset:53248
  ds_read_b64_tr_b16 v[166:167], v213 offset:54272
  ds_read_b128 v[180:183], v14 offset:960
  v_fma_mix_f32 v195, v133, v185, v189 op_sel:[1,1,1] op_sel_hi:[1,1,1]
  v_fma_mix_f32 v196, v134, v186, v190 op_sel:[0,0,0] op_sel_hi:[1,1,1]
  v_fma_mix_f32 v197, v134, v186, v190 op_sel:[1,1,1] op_sel_hi:[1,1,1]
  s_waitcnt lgkmcnt(8)
  v_mfma_f32_32x32x16_bf16 v[48:63], v[152:155], v[200:203], v[48:63]
  ds_read_b64_tr_b16 v[168:169], v214 offset:53248
  ds_read_b64_tr_b16 v[170:171], v214 offset:54272
  v_fma_mix_f32 v198, v135, v187, v191 op_sel:[0,0,0] op_sel_hi:[1,1,1]
  v_fma_mix_f32 v199, v135, v187, v191 op_sel:[1,1,1] op_sel_hi:[1,1,1]
  v_cvt_pk_bf16_f32 v204, v192, v193
  v_cvt_pk_bf16_f32 v205, v194, v195
  s_waitcnt lgkmcnt(8)
  v_mfma_f32_32x32x16_bf16 v[64:79], v[156:159], v[200:203], v[64:79]
  ds_read_b64_tr_b16 v[172:173], v215 offset:53248
  ds_read_b64_tr_b16 v[174:175], v215 offset:54272
  v_cvt_pk_bf16_f32 v206, v196, v197
  v_cvt_pk_bf16_f32 v207, v198, v199
  buffer_load_dwordx4 v[108:111], v5, s[8:11], s55 offen offset:3072 sc1
  s_waitcnt lgkmcnt(8)
  v_mfma_f32_32x32x16_bf16 v[16:31], v[160:163], v[204:207], v[16:31]
  ds_read_b64_tr_b16 v[144:145], v212 offset:57344
  ds_read_b64_tr_b16 v[146:147], v212 offset:58368
  ds_read_b128 v[184:187], v14 offset:2272
  s_waitcnt lgkmcnt(7)
  s_waitcnt vmcnt(9)
  v_fma_mix_f32 v192, v136, v176, v180 op_sel:[0,0,0] op_sel_hi:[1,1,1]
  v_fma_mix_f32 v193, v136, v176, v180 op_sel:[1,1,1] op_sel_hi:[1,1,1]
  v_fma_mix_f32 v194, v137, v177, v181 op_sel:[0,0,0] op_sel_hi:[1,1,1]
  v_mfma_f32_32x32x16_bf16 v[32:47], v[164:167], v[204:207], v[32:47]
  ds_read_b64_tr_b16 v[148:149], v213 offset:57344
  ds_read_b64_tr_b16 v[150:151], v213 offset:58368
  ds_read_b128 v[188:191], v14 offset:992
  v_fma_mix_f32 v195, v137, v177, v181 op_sel:[1,1,1] op_sel_hi:[1,1,1]
  v_fma_mix_f32 v196, v138, v178, v182 op_sel:[0,0,0] op_sel_hi:[1,1,1]
  v_fma_mix_f32 v197, v138, v178, v182 op_sel:[1,1,1] op_sel_hi:[1,1,1]
  s_waitcnt lgkmcnt(8)
  v_mfma_f32_32x32x16_bf16 v[48:63], v[168:171], v[204:207], v[48:63]
  ds_read_b64_tr_b16 v[152:153], v214 offset:57344
  ds_read_b64_tr_b16 v[154:155], v214 offset:58368
  v_fma_mix_f32 v198, v139, v179, v183 op_sel:[0,0,0] op_sel_hi:[1,1,1]
  v_fma_mix_f32 v199, v139, v179, v183 op_sel:[1,1,1] op_sel_hi:[1,1,1]
  v_cvt_pk_bf16_f32 v200, v192, v193
  v_cvt_pk_bf16_f32 v201, v194, v195
  s_waitcnt lgkmcnt(8)
  v_mfma_f32_32x32x16_bf16 v[64:79], v[172:175], v[204:207], v[64:79]
  ds_read_b64_tr_b16 v[156:157], v215 offset:57344
  ds_read_b64_tr_b16 v[158:159], v215 offset:58368
  v_cvt_pk_bf16_f32 v202, v196, v197
  v_cvt_pk_bf16_f32 v203, v198, v199
  s_waitcnt lgkmcnt(8)
  s_nop 0
  v_mfma_f32_32x32x16_bf16 v[16:31], v[144:147], v[200:203], v[16:31]
  ds_read_b64_tr_b16 v[160:161], v212 offset:61440
  ds_read_b64_tr_b16 v[162:163], v212 offset:62464
  ds_read_b128 v[176:179], v14 offset:2304
  s_waitcnt lgkmcnt(7)
  s_waitcnt vmcnt(8)
  v_fma_mix_f32 v192, v140, v184, v188 op_sel:[0,0,0] op_sel_hi:[1,1,1]
  v_fma_mix_f32 v193, v140, v184, v188 op_sel:[1,1,1] op_sel_hi:[1,1,1]
  v_fma_mix_f32 v194, v141, v185, v189 op_sel:[0,0,0] op_sel_hi:[1,1,1]
  v_mfma_f32_32x32x16_bf16 v[32:47], v[148:151], v[200:203], v[32:47]
  ds_read_b64_tr_b16 v[164:165], v213 offset:61440
  ds_read_b64_tr_b16 v[166:167], v213 offset:62464
  ds_read_b128 v[180:183], v14 offset:1024
  v_fma_mix_f32 v195, v141, v185, v189 op_sel:[1,1,1] op_sel_hi:[1,1,1]
  v_fma_mix_f32 v196, v142, v186, v190 op_sel:[0,0,0] op_sel_hi:[1,1,1]
  v_fma_mix_f32 v197, v142, v186, v190 op_sel:[1,1,1] op_sel_hi:[1,1,1]
  s_waitcnt lgkmcnt(8)
  v_mfma_f32_32x32x16_bf16 v[48:63], v[152:155], v[200:203], v[48:63]
  ds_read_b64_tr_b16 v[168:169], v214 offset:61440
  ds_read_b64_tr_b16 v[170:171], v214 offset:62464
  v_fma_mix_f32 v198, v143, v187, v191 op_sel:[0,0,0] op_sel_hi:[1,1,1]
  v_fma_mix_f32 v199, v143, v187, v191 op_sel:[1,1,1] op_sel_hi:[1,1,1]
  v_cvt_pk_bf16_f32 v204, v192, v193
  v_cvt_pk_bf16_f32 v205, v194, v195
  s_waitcnt lgkmcnt(8)
  v_mfma_f32_32x32x16_bf16 v[64:79], v[156:159], v[200:203], v[64:79]
  ds_read_b64_tr_b16 v[172:173], v215 offset:61440
  ds_read_b64_tr_b16 v[174:175], v215 offset:62464
  v_cvt_pk_bf16_f32 v206, v196, v197
  v_cvt_pk_bf16_f32 v207, v198, v199
  s_waitcnt lgkmcnt(8)
  s_nop 0
  v_mfma_f32_32x32x16_bf16 v[16:31], v[160:163], v[204:207], v[16:31]
  ds_read_b64_tr_b16 v[144:145], v216 offset:0
  ds_read_b64_tr_b16 v[146:147], v216 offset:1024
  ds_read_b128 v[184:187], v14 offset:2336
  s_waitcnt lgkmcnt(7)
  s_waitcnt vmcnt(7)
  v_fma_mix_f32 v192, v80, v176, v180 op_sel:[0,0,0] op_sel_hi:[1,1,1]
  v_fma_mix_f32 v193, v80, v176, v180 op_sel:[1,1,1] op_sel_hi:[1,1,1]
  v_fma_mix_f32 v194, v81, v177, v181 op_sel:[0,0,0] op_sel_hi:[1,1,1]
  v_mfma_f32_32x32x16_bf16 v[32:47], v[164:167], v[204:207], v[32:47]
  ds_read_b64_tr_b16 v[148:149], v217 offset:0
  ds_read_b64_tr_b16 v[150:151], v217 offset:1024
  ds_read_b128 v[188:191], v14 offset:1056
  v_fma_mix_f32 v195, v81, v177, v181 op_sel:[1,1,1] op_sel_hi:[1,1,1]
  v_fma_mix_f32 v196, v82, v178, v182 op_sel:[0,0,0] op_sel_hi:[1,1,1]
  v_fma_mix_f32 v197, v82, v178, v182 op_sel:[1,1,1] op_sel_hi:[1,1,1]
  s_waitcnt lgkmcnt(8)
  v_mfma_f32_32x32x16_bf16 v[48:63], v[168:171], v[204:207], v[48:63]
  ds_read_b64_tr_b16 v[152:153], v218 offset:0
  ds_read_b64_tr_b16 v[154:155], v218 offset:1024
  v_fma_mix_f32 v198, v83, v179, v183 op_sel:[0,0,0] op_sel_hi:[1,1,1]
  v_fma_mix_f32 v199, v83, v179, v183 op_sel:[1,1,1] op_sel_hi:[1,1,1]
  v_cvt_pk_bf16_f32 v200, v192, v193
  v_cvt_pk_bf16_f32 v201, v194, v195
  s_waitcnt lgkmcnt(8)
  v_mfma_f32_32x32x16_bf16 v[64:79], v[172:175], v[204:207], v[64:79]
  ds_read_b64_tr_b16 v[156:157], v219 offset:0
  ds_read_b64_tr_b16 v[158:159], v219 offset:1024
  v_cvt_pk_bf16_f32 v202, v196, v197
  v_cvt_pk_bf16_f32 v203, v198, v199
  s_waitcnt lgkmcnt(8)
  s_nop 0
  v_mfma_f32_32x32x16_bf16 v[16:31], v[144:147], v[200:203], v[16:31]
  ds_read_b64_tr_b16 v[160:161], v216 offset:4096
  ds_read_b64_tr_b16 v[162:163], v216 offset:5120
  ds_read_b128 v[176:179], v14 offset:2368
  s_waitcnt lgkmcnt(7)
  s_waitcnt vmcnt(6)
  v_fma_mix_f32 v192, v84, v184, v188 op_sel:[0,0,0] op_sel_hi:[1,1,1]
  v_fma_mix_f32 v193, v84, v184, v188 op_sel:[1,1,1] op_sel_hi:[1,1,1]
  v_fma_mix_f32 v194, v85, v185, v189 op_sel:[0,0,0] op_sel_hi:[1,1,1]
  v_mfma_f32_32x32x16_bf16 v[32:47], v[148:151], v[200:203], v[32:47]
  ds_read_b64_tr_b16 v[164:165], v217 offset:4096
  ds_read_b64_tr_b16 v[166:167], v217 offset:5120
  ds_read_b128 v[180:183], v14 offset:1088
  v_fma_mix_f32 v195, v85, v185, v189 op_sel:[1,1,1] op_sel_hi:[1,1,1]
  v_fma_mix_f32 v196, v86, v186, v190 op_sel:[0,0,0] op_sel_hi:[1,1,1]
  v_fma_mix_f32 v197, v86, v186, v190 op_sel:[1,1,1] op_sel_hi:[1,1,1]
  s_waitcnt lgkmcnt(8)
  v_mfma_f32_32x32x16_bf16 v[48:63], v[152:155], v[200:203], v[48:63]
  ds_read_b64_tr_b16 v[168:169], v218 offset:4096
  ds_read_b64_tr_b16 v[170:171], v218 offset:5120
  v_fma_mix_f32 v198, v87, v187, v191 op_sel:[0,0,0] op_sel_hi:[1,1,1]
  v_fma_mix_f32 v199, v87, v187, v191 op_sel:[1,1,1] op_sel_hi:[1,1,1]
  v_cvt_pk_bf16_f32 v204, v192, v193
  v_cvt_pk_bf16_f32 v205, v194, v195
  s_waitcnt lgkmcnt(8)
  v_mfma_f32_32x32x16_bf16 v[64:79], v[156:159], v[200:203], v[64:79]
  ds_read_b64_tr_b16 v[172:173], v219 offset:4096
  ds_read_b64_tr_b16 v[174:175], v219 offset:5120
  v_cvt_pk_bf16_f32 v206, v196, v197
  v_cvt_pk_bf16_f32 v207, v198, v199
  s_waitcnt lgkmcnt(8)
  s_nop 0
  v_mfma_f32_32x32x16_bf16 v[16:31], v[160:163], v[204:207], v[16:31]
  ds_read_b64_tr_b16 v[144:145], v216 offset:8192
  ds_read_b64_tr_b16 v[146:147], v216 offset:9216
  ds_read_b128 v[184:187], v14 offset:2400
  s_waitcnt lgkmcnt(7)
  s_waitcnt vmcnt(5)
  v_fma_mix_f32 v192, v88, v176, v180 op_sel:[0,0,0] op_sel_hi:[1,1,1]
  v_fma_mix_f32 v193, v88, v176, v180 op_sel:[1,1,1] op_sel_hi:[1,1,1]
  v_fma_mix_f32 v194, v89, v177, v181 op_sel:[0,0,0] op_sel_hi:[1,1,1]
  v_mfma_f32_32x32x16_bf16 v[32:47], v[164:167], v[204:207], v[32:47]
  ds_read_b64_tr_b16 v[148:149], v217 offset:8192
  ds_read_b64_tr_b16 v[150:151], v217 offset:9216
  ds_read_b128 v[188:191], v14 offset:1120
  v_fma_mix_f32 v195, v89, v177, v181 op_sel:[1,1,1] op_sel_hi:[1,1,1]
  v_fma_mix_f32 v196, v90, v178, v182 op_sel:[0,0,0] op_sel_hi:[1,1,1]
  v_fma_mix_f32 v197, v90, v178, v182 op_sel:[1,1,1] op_sel_hi:[1,1,1]
  s_waitcnt lgkmcnt(8)
  v_mfma_f32_32x32x16_bf16 v[48:63], v[168:171], v[204:207], v[48:63]
  ds_read_b64_tr_b16 v[152:153], v218 offset:8192
  ds_read_b64_tr_b16 v[154:155], v218 offset:9216
  v_fma_mix_f32 v198, v91, v179, v183 op_sel:[0,0,0] op_sel_hi:[1,1,1]
  v_fma_mix_f32 v199, v91, v179, v183 op_sel:[1,1,1] op_sel_hi:[1,1,1]
  v_cvt_pk_bf16_f32 v200, v192, v193
  v_cvt_pk_bf16_f32 v201, v194, v195
  s_waitcnt lgkmcnt(8)
  v_mfma_f32_32x32x16_bf16 v[64:79], v[172:175], v[204:207], v[64:79]
  ds_read_b64_tr_b16 v[156:157], v219 offset:8192
  ds_read_b64_tr_b16 v[158:159], v219 offset:9216
  v_cvt_pk_bf16_f32 v202, v196, v197
  v_cvt_pk_bf16_f32 v203, v198, v199
  s_waitcnt lgkmcnt(8)
  s_nop 0
  v_mfma_f32_32x32x16_bf16 v[16:31], v[144:147], v[200:203], v[16:31]
  s_barrier
  ds_read_b64_tr_b16 v[160:161], v208 offset:0
  ds_read_b64_tr_b16 v[162:163], v208 offset:1024
  ds_read_b128 v[176:179], v14 offset:2432
  s_waitcnt lgkmcnt(7)
  s_waitcnt vmcnt(4)
  v_fma_mix_f32 v192, v92, v184, v188 op_sel:[0,0,0] op_sel_hi:[1,1,1]
  v_fma_mix_f32 v193, v92, v184, v188 op_sel:[1,1,1] op_sel_hi:[1,1,1]
  v_fma_mix_f32 v194, v93, v185, v189 op_sel:[0,0,0] op_sel_hi:[1,1,1]
  v_mfma_f32_32x32x16_bf16 v[32:47], v[148:151], v[200:203], v[32:47]
  ds_read_b64_tr_b16 v[164:165], v209 offset:0
  ds_read_b64_tr_b16 v[166:167], v209 offset:1024
  ds_read_b128 v[180:183], v14 offset:1152
  v_fma_mix_f32 v195, v93, v185, v189 op_sel:[1,1,1] op_sel_hi:[1,1,1]
  v_fma_mix_f32 v196, v94, v186, v190 op_sel:[0,0,0] op_sel_hi:[1,1,1]
  v_fma_mix_f32 v197, v94, v186, v190 op_sel:[1,1,1] op_sel_hi:[1,1,1]
  s_waitcnt lgkmcnt(8)
  v_mfma_f32_32x32x16_bf16 v[48:63], v[152:155], v[200:203], v[48:63]
  ds_read_b64_tr_b16 v[168:169], v210 offset:0
  ds_read_b64_tr_b16 v[170:171], v210 offset:1024
  v_fma_mix_f32 v198, v95, v187, v191 op_sel:[0,0,0] op_sel_hi:[1,1,1]
  v_fma_mix_f32 v199, v95, v187, v191 op_sel:[1,1,1] op_sel_hi:[1,1,1]
  v_cvt_pk_bf16_f32 v204, v192, v193
  v_cvt_pk_bf16_f32 v205, v194, v195
  s_waitcnt lgkmcnt(8)
  v_mfma_f32_32x32x16_bf16 v[64:79], v[156:159], v[200:203], v[64:79]
  ds_read_b64_tr_b16 v[172:173], v211 offset:0
  ds_read_b64_tr_b16 v[174:175], v211 offset:1024
  v_cvt_pk_bf16_f32 v206, v196, v197
  v_cvt_pk_bf16_f32 v207, v198, v199
  s_waitcnt lgkmcnt(8)
  s_nop 0
  v_mfma_f32_32x32x16_bf16 v[16:31], v[160:163], v[204:207], v[16:31]
  ds_read_b64_tr_b16 v[144:145], v208 offset:4096
  ds_read_b64_tr_b16 v[146:147], v208 offset:5120
  ds_read_b128 v[184:187], v14 offset:2464
  s_waitcnt lgkmcnt(7)
  s_waitcnt vmcnt(3)
  v_fma_mix_f32 v192, v96, v176, v180 op_sel:[0,0,0] op_sel_hi:[1,1,1]
  v_fma_mix_f32 v193, v96, v176, v180 op_sel:[1,1,1] op_sel_hi:[1,1,1]
  v_fma_mix_f32 v194, v97, v177, v181 op_sel:[0,0,0] op_sel_hi:[1,1,1]
  v_mfma_f32_32x32x16_bf16 v[32:47], v[164:167], v[204:207], v[32:47]
  ds_read_b64_tr_b16 v[148:149], v209 offset:4096
  ds_read_b64_tr_b16 v[150:151], v209 offset:5120
  ds_read_b128 v[188:191], v14 offset:1184
  v_fma_mix_f32 v195, v97, v177, v181 op_sel:[1,1,1] op_sel_hi:[1,1,1]
  v_fma_mix_f32 v196, v98, v178, v182 op_sel:[0,0,0] op_sel_hi:[1,1,1]
  v_fma_mix_f32 v197, v98, v178, v182 op_sel:[1,1,1] op_sel_hi:[1,1,1]
  s_waitcnt lgkmcnt(8)
  v_mfma_f32_32x32x16_bf16 v[48:63], v[168:171], v[204:207], v[48:63]
  ds_read_b64_tr_b16 v[152:153], v210 offset:4096
  ds_read_b64_tr_b16 v[154:155], v210 offset:5120
  v_fma_mix_f32 v198, v99, v179, v183 op_sel:[0,0,0] op_sel_hi:[1,1,1]
  v_fma_mix_f32 v199, v99, v179, v183 op_sel:[1,1,1] op_sel_hi:[1,1,1]
  v_cvt_pk_bf16_f32 v200, v192, v193
  v_cvt_pk_bf16_f32 v201, v194, v195
  s_waitcnt lgkmcnt(8)
  v_mfma_f32_32x32x16_bf16 v[64:79], v[172:175], v[204:207], v[64:79]
  ds_read_b64_tr_b16 v[156:157], v211 offset:4096
  ds_read_b64_tr_b16 v[158:159], v211 offset:5120
  v_cvt_pk_bf16_f32 v202, v196, v197
  v_cvt_pk_bf16_f32 v203, v198, v199
  s_waitcnt lgkmcnt(8)
  s_nop 0
  v_mfma_f32_32x32x16_bf16 v[16:31], v[144:147], v[200:203], v[16:31]
  ds_read_b64_tr_b16 v[160:161], v208 offset:8192
  ds_read_b64_tr_b16 v[162:163], v208 offset:9216
  ds_read_b128 v[176:179], v14 offset:2496
  s_waitcnt lgkmcnt(7)
  s_waitcnt vmcnt(2)
  v_fma_mix_f32 v192, v100, v184, v188 op_sel:[0,0,0] op_sel_hi:[1,1,1]
  v_fma_mix_f32 v193, v100, v184, v188 op_sel:[1,1,1] op_sel_hi:[1,1,1]
  v_fma_mix_f32 v194, v101, v185, v189 op_sel:[0,0,0] op_sel_hi:[1,1,1]
  v_mfma_f32_32x32x16_bf16 v[32:47], v[148:151], v[200:203], v[32:47]
  ds_read_b64_tr_b16 v[164:165], v209 offset:8192
  ds_read_b64_tr_b16 v[166:167], v209 offset:9216
  ds_read_b128 v[180:183], v14 offset:1216
  v_fma_mix_f32 v195, v101, v185, v189 op_sel:[1,1,1] op_sel_hi:[1,1,1]
  v_fma_mix_f32 v196, v102, v186, v190 op_sel:[0,0,0] op_sel_hi:[1,1,1]
  v_fma_mix_f32 v197, v102, v186, v190 op_sel:[1,1,1] op_sel_hi:[1,1,1]
  s_waitcnt lgkmcnt(8)
  v_mfma_f32_32x32x16_bf16 v[48:63], v[152:155], v[200:203], v[48:63]
  ds_read_b64_tr_b16 v[168:169], v210 offset:8192
  ds_read_b64_tr_b16 v[170:171], v210 offset:9216
  v_fma_mix_f32 v198, v103, v187, v191 op_sel:[0,0,0] op_sel_hi:[1,1,1]
  v_fma_mix_f32 v199, v103, v187, v191 op_sel:[1,1,1] op_sel_hi:[1,1,1]
  v_cvt_pk_bf16_f32 v204, v192, v193
  v_cvt_pk_bf16_f32 v205, v194, v195
  s_waitcnt lgkmcnt(8)
  v_mfma_f32_32x32x16_bf16 v[64:79], v[156:159], v[200:203], v[64:79]
  ds_read_b64_tr_b16 v[172:173], v211 offset:8192
  ds_read_b64_tr_b16 v[174:175], v211 offset:9216
  v_cvt_pk_bf16_f32 v206, v196, v197
  v_cvt_pk_bf16_f32 v207, v198, v199
  s_waitcnt lgkmcnt(8)
  s_nop 0
  v_mfma_f32_32x32x16_bf16 v[16:31], v[160:163], v[204:207], v[16:31]
  ds_read_b64_tr_b16 v[144:145], v208 offset:12288
  ds_read_b64_tr_b16 v[146:147], v208 offset:13312
  ds_read_b128 v[184:187], v14 offset:2528
  s_waitcnt lgkmcnt(7)
  s_waitcnt vmcnt(1)
  v_fma_mix_f32 v192, v104, v176, v180 op_sel:[0,0,0] op_sel_hi:[1,1,1]
  v_fma_mix_f32 v193, v104, v176, v180 op_sel:[1,1,1] op_sel_hi:[1,1,1]
  v_fma_mix_f32 v194, v105, v177, v181 op_sel:[0,0,0] op_sel_hi:[1,1,1]
  v_mfma_f32_32x32x16_bf16 v[32:47], v[164:167], v[204:207], v[32:47]
  ds_read_b64_tr_b16 v[148:149], v209 offset:12288
  ds_read_b64_tr_b16 v[150:151], v209 offset:13312
  ds_read_b128 v[188:191], v14 offset:1248
  v_fma_mix_f32 v195, v105, v177, v181 op_sel:[1,1,1] op_sel_hi:[1,1,1]
  v_fma_mix_f32 v196, v106, v178, v182 op_sel:[0,0,0] op_sel_hi:[1,1,1]
  v_fma_mix_f32 v197, v106, v178, v182 op_sel:[1,1,1] op_sel_hi:[1,1,1]
  s_waitcnt lgkmcnt(8)
  v_mfma_f32_32x32x16_bf16 v[48:63], v[168:171], v[204:207], v[48:63]
  ds_read_b64_tr_b16 v[152:153], v210 offset:12288
  ds_read_b64_tr_b16 v[154:155], v210 offset:13312
  v_fma_mix_f32 v198, v107, v179, v183 op_sel:[0,0,0] op_sel_hi:[1,1,1]
  v_fma_mix_f32 v199, v107, v179, v183 op_sel:[1,1,1] op_sel_hi:[1,1,1]
  v_cvt_pk_bf16_f32 v200, v192, v193
  v_cvt_pk_bf16_f32 v201, v194, v195
  s_waitcnt lgkmcnt(8)
  v_mfma_f32_32x32x16_bf16 v[64:79], v[172:175], v[204:207], v[64:79]
  ds_read_b64_tr_b16 v[156:157], v211 offset:12288
  ds_read_b64_tr_b16 v[158:159], v211 offset:13312
  v_cvt_pk_bf16_f32 v202, v196, v197
  v_cvt_pk_bf16_f32 v203, v198, v199
  s_waitcnt lgkmcnt(8)
  s_nop 0
  v_mfma_f32_32x32x16_bf16 v[16:31], v[144:147], v[200:203], v[16:31]
  ds_read_b64_tr_b16 v[160:161], v208 offset:16384
  ds_read_b64_tr_b16 v[162:163], v208 offset:17408
  s_waitcnt lgkmcnt(6)
  s_waitcnt vmcnt(0)
  v_fma_mix_f32 v192, v108, v184, v188 op_sel:[0,0,0] op_sel_hi:[1,1,1]
  v_fma_mix_f32 v193, v108, v184, v188 op_sel:[1,1,1] op_sel_hi:[1,1,1]
  v_fma_mix_f32 v194, v109, v185, v189 op_sel:[0,0,0] op_sel_hi:[1,1,1]
  v_mfma_f32_32x32x16_bf16 v[32:47], v[148:151], v[200:203], v[32:47]
  ds_read_b64_tr_b16 v[164:165], v209 offset:16384
  ds_read_b64_tr_b16 v[166:167], v209 offset:17408
  v_fma_mix_f32 v195, v109, v185, v189 op_sel:[1,1,1] op_sel_hi:[1,1,1]
  v_fma_mix_f32 v196, v110, v186, v190 op_sel:[0,0,0] op_sel_hi:[1,1,1]
  v_fma_mix_f32 v197, v110, v186, v190 op_sel:[1,1,1] op_sel_hi:[1,1,1]
  s_waitcnt lgkmcnt(6)
  v_mfma_f32_32x32x16_bf16 v[48:63], v[152:155], v[200:203], v[48:63]
  ds_read_b64_tr_b16 v[168:169], v210 offset:16384
  ds_read_b64_tr_b16 v[170:171], v210 offset:17408
  v_fma_mix_f32 v198, v111, v187, v191 op_sel:[0,0,0] op_sel_hi:[1,1,1]
  v_fma_mix_f32 v199, v111, v187, v191 op_sel:[1,1,1] op_sel_hi:[1,1,1]
  v_cvt_pk_bf16_f32 v204, v192, v193
  v_cvt_pk_bf16_f32 v205, v194, v195
  s_waitcnt lgkmcnt(6)
  v_mfma_f32_32x32x16_bf16 v[64:79], v[156:159], v[200:203], v[64:79]
  ds_read_b64_tr_b16 v[172:173], v211 offset:16384
  ds_read_b64_tr_b16 v[174:175], v211 offset:17408
  v_cvt_pk_bf16_f32 v206, v196, v197
  v_cvt_pk_bf16_f32 v207, v198, v199
  s_waitcnt lgkmcnt(6)
  s_nop 0
  v_mfma_f32_32x32x16_bf16 v[16:31], v[160:163], v[204:207], v[16:31]
  s_waitcnt lgkmcnt(4)
  v_mfma_f32_32x32x16_bf16 v[32:47], v[164:167], v[204:207], v[32:47]
  s_waitcnt lgkmcnt(2)
  v_mfma_f32_32x32x16_bf16 v[48:63], v[168:171], v[204:207], v[48:63]
  s_waitcnt lgkmcnt(0)
  v_mfma_f32_32x32x16_bf16 v[64:79], v[172:175], v[204:207], v[64:79]
  s_nop 5
  v_cvt_pk_bf16_f32 v80, v16, v17
  v_cvt_pk_bf16_f32 v81, v18, v19
  v_cvt_pk_bf16_f32 v82, v20, v21
  v_cvt_pk_bf16_f32 v83, v22, v23
  v_cvt_pk_bf16_f32 v84, v24, v25
  v_cvt_pk_bf16_f32 v85, v26, v27
  v_cvt_pk_bf16_f32 v86, v28, v29
  v_cvt_pk_bf16_f32 v87, v30, v31
  v_permlane32_swap_b32 v80, v82
  v_permlane32_swap_b32 v81, v83
  buffer_store_dwordx4 v[80:83], v5, s[8:11], s58 offen offset:0 sc0 sc1
  v_permlane32_swap_b32 v84, v86
  v_permlane32_swap_b32 v85, v87
  buffer_store_dwordx4 v[84:87], v5, s[8:11], s58 offen offset:1024 sc0 sc1
  s_add_u32 s58, s58, 2048
  v_cvt_pk_bf16_f32 v88, v32, v33
  v_cvt_pk_bf16_f32 v89, v34, v35
  v_cvt_pk_bf16_f32 v90, v36, v37
  v_cvt_pk_bf16_f32 v91, v38, v39
  v_cvt_pk_bf16_f32 v92, v40, v41
  v_cvt_pk_bf16_f32 v93, v42, v43
  v_cvt_pk_bf16_f32 v94, v44, v45
  v_cvt_pk_bf16_f32 v95, v46, v47
  v_permlane32_swap_b32 v88, v90
  v_permlane32_swap_b32 v89, v91
  buffer_store_dwordx4 v[88:91], v5, s[8:11], s58 offen offset:0 sc0 sc1
  v_permlane32_swap_b32 v92, v94
  v_permlane32_swap_b32 v93, v95
  buffer_store_dwordx4 v[92:95], v5, s[8:11], s58 offen offset:1024 sc0 sc1
  s_add_u32 s58, s58, 2048
  v_cvt_pk_bf16_f32 v96, v48, v49
  v_cvt_pk_bf16_f32 v97, v50, v51
  v_cvt_pk_bf16_f32 v98, v52, v53
  v_cvt_pk_bf16_f32 v99, v54, v55
  v_cvt_pk_bf16_f32 v100, v56, v57
  v_cvt_pk_bf16_f32 v101, v58, v59
  v_cvt_pk_bf16_f32 v102, v60, v61
  v_cvt_pk_bf16_f32 v103, v62, v63
  v_permlane32_swap_b32 v96, v98
  v_permlane32_swap_b32 v97, v99
  buffer_store_dwordx4 v[96:99], v5, s[8:11], s58 offen offset:0 sc0 sc1
  v_permlane32_swap_b32 v100, v102
  v_permlane32_swap_b32 v101, v103
  buffer_store_dwordx4 v[100:103], v5, s[8:11], s58 offen offset:1024 sc0 sc1
  s_add_u32 s58, s58, 2048
  v_cvt_pk_bf16_f32 v104, v64, v65
  v_cvt_pk_bf16_f32 v105, v66, v67
  v_cvt_pk_bf16_f32 v106, v68, v69
  v_cvt_pk_bf16_f32 v107, v70, v71
  v_cvt_pk_bf16_f32 v108, v72, v73
  v_cvt_pk_bf16_f32 v109, v74, v75
  v_cvt_pk_bf16_f32 v110, v76, v77
  v_cvt_pk_bf16_f32 v111, v78, v79
  v_permlane32_swap_b32 v104, v106
  v_permlane32_swap_b32 v105, v107
  buffer_store_dwordx4 v[104:107], v5, s[8:11], s58 offen offset:0 sc0 sc1
  v_permlane32_swap_b32 v108, v110
  v_permlane32_swap_b32 v109, v111
  buffer_store_dwordx4 v[108:111], v5, s[8:11], s58 offen offset:1024 sc0 sc1
  s_add_u32 s58, s58, 2048
  s_branch adaLN_cond__mha_block__glu_gated_glu__prompt_p1done5
adaLN_cond__mha_block__glu_gated_glu__prompt_qv14:
  v_and_b32 v3, 31, v1
  v_lshrrev_b32 v4, 5, v1
  v_lshlrev_b32 v5, 4, v1
  s_lshl_b32 s53, s15, 2
  s_add_u32 s53, s53, s12
  s_mul_i32 s54, s53, 40960
  s_add_u32 s54, s54, 126976
  v_lshlrev_b32 v9, 4, v0
  v_and_b32 v15, 15, v1
  v_lshlrev_b32 v15, 4, v15
  s_lshl_b32 s55, s12, 8
  s_add_u32 s55, s55, 4096
  v_add_u32 v15, s55, v15
  s_mov_b32 s52, 90112
  buffer_load_dwordx4 v[224:227], v9, s[8:11], s52 offen sc1
  buffer_load_dwordx4 v[240:243], v15, s[8:11], s52 offen sc1
  s_mov_b32 s52, 95232
  buffer_load_dwordx4 v[228:231], v9, s[8:11], s52 offen sc1
  buffer_load_dwordx4 v[244:247], v15, s[8:11], s52 offen sc1
  s_mov_b32 s52, 100352
  buffer_load_dwordx4 v[232:235], v9, s[8:11], s52 offen sc1
  buffer_load_dwordx4 v[248:251], v15, s[8:11], s52 offen sc1
  s_mov_b32 s52, 105472
  buffer_load_dwordx4 v[236:239], v9, s[8:11], s52 offen sc1
  buffer_load_dwordx4 v[252:255], v15, s[8:11], s52 offen sc1
  s_add_u32 s55, s54, 0
  buffer_load_dwordx4 v[80:83], v5, s[8:11], s55 offen offset:0 sc1
  buffer_load_dwordx4 v[84:87], v5, s[8:11], s55 offen offset:1024 sc1
  buffer_load_dwordx4 v[88:91], v5, s[8:11], s55 offen offset:2048 sc1
  buffer_load_dwordx4 v[92:95], v5, s[8:11], s55 offen offset:3072 sc1
  v_mov_b32 v16, 0
  v_mov_b32 v17, 0
  v_mov_b32 v18, 0
  v_mov_b32 v19, 0
  v_mov_b32 v20, 0
  v_mov_b32 v21, 0
  v_mov_b32 v22, 0
  v_mov_b32 v23, 0
  v_mov_b32 v24, 0
  v_mov_b32 v25, 0
  v_mov_b32 v26, 0
  v_mov_b32 v27, 0
  v_mov_b32 v28, 0
  v_mov_b32 v29, 0
  v_mov_b32 v30, 0
  v_mov_b32 v31, 0
  v_mov_b32 v32, 0
  v_mov_b32 v33, 0
  v_mov_b32 v34, 0
  v_mov_b32 v35, 0
  v_mov_b32 v36, 0
  v_mov_b32 v37, 0
  v_mov_b32 v38, 0
  v_mov_b32 v39, 0
  v_mov_b32 v40, 0
  v_mov_b32 v41, 0
  v_mov_b32 v42, 0
  v_mov_b32 v43, 0
  v_mov_b32 v44, 0
  v_mov_b32 v45, 0
  v_mov_b32 v46, 0
  v_mov_b32 v47, 0
  v_mov_b32 v48, 0
  v_mov_b32 v49, 0
  v_mov_b32 v50, 0
  v_mov_b32 v51, 0
  v_mov_b32 v52, 0
  v_mov_b32 v53, 0
  v_mov_b32 v54, 0
  v_mov_b32 v55, 0
  v_mov_b32 v56, 0
  v_mov_b32 v57, 0
  v_mov_b32 v58, 0
  v_mov_b32 v59, 0
  v_mov_b32 v60, 0
  v_mov_b32 v61, 0
  v_mov_b32 v62, 0
  v_mov_b32 v63, 0
  v_mov_b32 v64, 0
  v_mov_b32 v65, 0
  v_mov_b32 v66, 0
  v_mov_b32 v67, 0
  v_mov_b32 v68, 0
  v_mov_b32 v69, 0
  v_mov_b32 v70, 0
  v_mov_b32 v71, 0
  v_mov_b32 v72, 0
  v_mov_b32 v73, 0
  v_mov_b32 v74, 0
  v_mov_b32 v75, 0
  v_mov_b32 v76, 0
  v_mov_b32 v77, 0
  v_mov_b32 v78, 0
  v_mov_b32 v79, 0
  v_and_b32 v8, 15, v1
  v_lshrrev_b32 v8, 2, v8
  v_lshl_add_u32 v9, v4, 3, v8
  v_lshlrev_b32 v9, 8, v9
  v_bfe_u32 v10, v1, 4, 1
  v_lshl_add_u32 v9, v10, 5, v9
  v_and_b32 v10, 3, v1
  v_lshl_add_u32 v9, v10, 3, v9
  v_xor_b32 v10, 0, v8
  v_lshl_add_u32 v208, v10, 6, v9
  v_add_u32 v212, 0x10000, v208
  v_add_u32 v216, 0x20000, v208
  v_xor_b32 v10, 1, v8
  v_lshl_add_u32 v209, v10, 6, v9
  v_add_u32 v213, 0x10000, v209
  v_add_u32 v217, 0x20000, v209
  v_xor_b32 v10, 2, v8
  v_lshl_add_u32 v210, v10, 6, v9
  v_add_u32 v214, 0x10000, v210
  v_add_u32 v218, 0x20000, v210
  v_xor_b32 v10, 3, v8
  v_lshl_add_u32 v211, v10, 6, v9
  v_add_u32 v215, 0x10000, v211
  v_add_u32 v219, 0x20000, v211
  v_lshlrev_b32 v14, 4, v4
  v_add_u32 v14, 143360, v14
  s_lshl_b32 s56, s5, 7
  v_add_u32 v6, s56, v3
  s_movk_i32 s56, 3277
  s_mov_b32 s57, 81920
  v_mul_u32_u24 v7, 0x140, v4
  v_add_u32 v9, 0, v6
  v_mul_u32_u24 v10, s56, v9
  v_lshrrev_b32 v10, 16, v10
  v_mad_i32_i24 v9, v10, -16, v9
  v_mad_i32_i24 v9, v10, -4, v9
  v_lshl_add_u32 v9, v9, 4, v7
  v_mad_u32_u24 v220, v10, s57, v9
  v_add_u32 v9, 32, v6
  v_mul_u32_u24 v10, s56, v9
  v_lshrrev_b32 v10, 16, v10
  v_mad_i32_i24 v9, v10, -16, v9
  v_mad_i32_i24 v9, v10, -4, v9
  v_lshl_add_u32 v9, v9, 4, v7
  v_mad_u32_u24 v221, v10, s57, v9
  v_add_u32 v9, 64, v6
  v_mul_u32_u24 v10, s56, v9
  v_lshrrev_b32 v10, 16, v10
  v_mad_i32_i24 v9, v10, -16, v9
  v_mad_i32_i24 v9, v10, -4, v9
  v_lshl_add_u32 v9, v9, 4, v7
  v_mad_u32_u24 v222, v10, s57, v9
  v_add_u32 v9, 96, v6
  v_mul_u32_u24 v10, s56, v9
  v_lshrrev_b32 v10, 16, v10
  v_mad_i32_i24 v9, v10, -16, v9
  v_mad_i32_i24 v9, v10, -4, v9
  v_lshl_add_u32 v9, v9, 4, v7
  v_mad_u32_u24 v223, v10, s57, v9
  s_lshl_b32 s58, s53, 1
  s_mul_i32 s58, s58, 640
  s_add_u32 s58, s58, 14708736
  s_mov_b32 s60, 1.0
  s_waitcnt vmcnt(4)
  v_cmp_le_u32 vcc, 160, v0
  v_mov_b32 v6, 0
  s_nop 0
  v_cndmask_b32_e64 v6, v6, 1.0, vcc
  v_add_f32 v224, v224, v228
  v_add_f32 v232, v232, v236
  v_add_f32 v225, v225, v229
  v_add_f32 v233, v233, v237
  v_add_f32 v226, v226, v230
  v_add_f32 v234, v234, v238
  v_add_f32 v227, v227, v231
  v_add_f32 v235, v235, v239
  v_add_f32 v224, v224, v232
  v_add_f32 v225, v225, v233
  v_add_f32 v226, v226, v234
  v_add_f32 v227, v227, v235
  v_add_f32 v240, v240, v244
  v_add_f32 v248, v248, v252
  v_add_f32 v241, v241, v245
  v_add_f32 v249, v249, v253
  v_add_f32 v242, v242, v246
  v_add_f32 v250, v250, v254
  v_add_f32 v243, v243, v247
  v_add_f32 v251, v251, v255
  v_add_f32 v240, v240, v248
  v_add_f32 v241, v241, v249
  v_add_f32 v242, v242, v250
  v_add_f32 v243, v243, v251
  v_add_f32 v224, v224, v6
  v_add_f32 v240, 1.0, v240
  v_add_f32 v225, v225, v6
  v_add_f32 v241, 1.0, v241
  v_add_f32 v226, v226, v6
  v_add_f32 v242, 1.0, v242
  v_add_f32 v227, v227, v6
  v_add_f32 v243, 1.0, v243
  v_mul_f32 v224, s60, v224
  v_mul_f32 v240, s60, v240
  v_mul_f32 v225, s60, v225
  v_mul_f32 v241, s60, v241
  v_mul_f32 v226, s60, v226
  v_mul_f32 v242, s60, v242
  v_mul_f32 v227, s60, v227
  v_mul_f32 v243, s60, v243
  v_cvt_pk_f16_f32 v228, v224, v225
  v_cvt_pk_f16_f32 v229, v226, v227
  v_lshlrev_b32 v7, 3, v0
  v_add_u32 v7, 143360, v7
  ds_write_b64 v7, v[228:229]
  v_cvt_pk_f16_f32 v244, v240, v241
  v_cvt_pk_f16_f32 v245, v242, v243
  v_lshrrev_b32 v7, 1, v15
  v_add_u32 v7, 143360, v7
  ds_write_b64 v7, v[244:245]
  s_waitcnt lgkmcnt(0)
  s_barrier
  ds_read_b128 v[176:179], v14 offset:1280
  ds_read_b128 v[180:183], v14 offset:0
  ds_read_b64_tr_b16 v[144:145], v208 offset:0
  ds_read_b64_tr_b16 v[146:147], v208 offset:1024
  ds_read_b64_tr_b16 v[148:149], v209 offset:0
  ds_read_b64_tr_b16 v[150:151], v209 offset:1024
  ds_read_b64_tr_b16 v[152:153], v210 offset:0
  ds_read_b64_tr_b16 v[154:155], v210 offset:1024
  ds_read_b64_tr_b16 v[156:157], v211 offset:0
  ds_read_b64_tr_b16 v[158:159], v211 offset:1024
  ds_read_b128 v[184:187], v14 offset:1312
  ds_read_b128 v[188:191], v14 offset:32
  s_waitcnt lgkmcnt(10)
  s_waitcnt vmcnt(3)
  v_fma_mix_f32 v192, v80, v176, v180 op_sel:[0,0,0] op_sel_hi:[1,1,1]
  v_fma_mix_f32 v193, v80, v176, v180 op_sel:[1,1,1] op_sel_hi:[1,1,1]
  v_fma_mix_f32 v194, v81, v177, v181 op_sel:[0,0,0] op_sel_hi:[1,1,1]
  v_fma_mix_f32 v195, v81, v177, v181 op_sel:[1,1,1] op_sel_hi:[1,1,1]
  v_fma_mix_f32 v196, v82, v178, v182 op_sel:[0,0,0] op_sel_hi:[1,1,1]
  v_fma_mix_f32 v197, v82, v178, v182 op_sel:[1,1,1] op_sel_hi:[1,1,1]
  v_fma_mix_f32 v198, v83, v179, v183 op_sel:[0,0,0] op_sel_hi:[1,1,1]
  v_fma_mix_f32 v199, v83, v179, v183 op_sel:[1,1,1] op_sel_hi:[1,1,1]
  v_cvt_pk_bf16_f32 v200, v192, v193
  v_cvt_pk_bf16_f32 v201, v194, v195
  v_cvt_pk_bf16_f32 v202, v196, v197
  v_cvt_pk_bf16_f32 v203, v198, v199
  s_waitcnt lgkmcnt(8)
  s_nop 0
  v_mfma_f32_32x32x16_bf16 v[16:31], v[200:203], v[144:147], v[16:31]
  ds_read_b64_tr_b16 v[160:161], v208 offset:4096
  ds_read_b64_tr_b16 v[162:163], v208 offset:5120
  ds_read_b128 v[176:179], v14 offset:1344
  s_waitcnt lgkmcnt(3)
  s_waitcnt vmcnt(2)
  v_fma_mix_f32 v192, v84, v184, v188 op_sel:[0,0,0] op_sel_hi:[1,1,1]
  v_fma_mix_f32 v193, v84, v184, v188 op_sel:[1,1,1] op_sel_hi:[1,1,1]
  v_fma_mix_f32 v194, v85, v185, v189 op_sel:[0,0,0] op_sel_hi:[1,1,1]
  v_mfma_f32_32x32x16_bf16 v[32:47], v[200:203], v[148:151], v[32:47]
  ds_read_b64_tr_b16 v[164:165], v209 offset:4096
  ds_read_b64_tr_b16 v[166:167], v209 offset:5120
  ds_read_b128 v[180:183], v14 offset:64
  v_fma_mix_f32 v195, v85, v185, v189 op_sel:[1,1,1] op_sel_hi:[1,1,1]
  v_fma_mix_f32 v196, v86, v186, v190 op_sel:[0,0,0] op_sel_hi:[1,1,1]
  v_fma_mix_f32 v197, v86, v186, v190 op_sel:[1,1,1] op_sel_hi:[1,1,1]
  v_mfma_f32_32x32x16_bf16 v[48:63], v[200:203], v[152:155], v[48:63]
  ds_read_b64_tr_b16 v[168:169], v210 offset:4096
  ds_read_b64_tr_b16 v[170:171], v210 offset:5120
  v_fma_mix_f32 v198, v87, v187, v191 op_sel:[0,0,0] op_sel_hi:[1,1,1]
  v_fma_mix_f32 v199, v87, v187, v191 op_sel:[1,1,1] op_sel_hi:[1,1,1]
  v_cvt_pk_bf16_f32 v204, v192, v193
  v_cvt_pk_bf16_f32 v205, v194, v195
  v_mfma_f32_32x32x16_bf16 v[64:79], v[200:203], v[156:159], v[64:79]
  ds_read_b64_tr_b16 v[172:173], v211 offset:4096
  ds_read_b64_tr_b16 v[174:175], v211 offset:5120
  v_cvt_pk_bf16_f32 v206, v196, v197
  v_cvt_pk_bf16_f32 v207, v198, v199
  s_add_u32 s55, s54, 4096
  buffer_load_dwordx4 v[96:99], v5, s[8:11], s55 offen offset:0 sc1
  buffer_load_dwordx4 v[100:103], v5, s[8:11], s55 offen offset:1024 sc1
  s_waitcnt lgkmcnt(8)
  v_mfma_f32_32x32x16_bf16 v[16:31], v[204:207], v[160:163], v[16:31]
  ds_read_b64_tr_b16 v[144:145], v208 offset:8192
  ds_read_b64_tr_b16 v[146:147], v208 offset:9216
  ds_read_b128 v[184:187], v14 offset:1376
  s_waitcnt lgkmcnt(7)
  s_waitcnt vmcnt(3)
  v_fma_mix_f32 v192, v88, v176, v180 op_sel:[0,0,0] op_sel_hi:[1,1,1]
  v_fma_mix_f32 v193, v88, v176, v180 op_sel:[1,1,1] op_sel_hi:[1,1,1]
  v_fma_mix_f32 v194, v89, v177, v181 op_sel:[0,0,0] op_sel_hi:[1,1,1]
  v_mfma_f32_32x32x16_bf16 v[32:47], v[204:207], v[164:167], v[32:47]
  ds_read_b64_tr_b16 v[148:149], v209 offset:8192
  ds_read_b64_tr_b16 v[150:151], v209 offset:9216
  ds_read_b128 v[188:191], v14 offset:96
  v_fma_mix_f32 v195, v89, v177, v181 op_sel:[1,1,1] op_sel_hi:[1,1,1]
  v_fma_mix_f32 v196, v90, v178, v182 op_sel:[0,0,0] op_sel_hi:[1,1,1]
  v_fma_mix_f32 v197, v90, v178, v182 op_sel:[1,1,1] op_sel_hi:[1,1,1]
  s_waitcnt lgkmcnt(8)
  v_mfma_f32_32x32x16_bf16 v[48:63], v[204:207], v[168:171], v[48:63]
  ds_read_b64_tr_b16 v[152:153], v210 offset:8192
  ds_read_b64_tr_b16 v[154:155], v210 offset:9216
  v_fma_mix_f32 v198, v91, v179, v183 op_sel:[0,0,0] op_sel_hi:[1,1,1]
  v_fma_mix_f32 v199, v91, v179, v183 op_sel:[1,1,1] op_sel_hi:[1,1,1]
  v_cvt_pk_bf16_f32 v200, v192, v193
  v_cvt_pk_bf16_f32 v201, v194, v195
  s_waitcnt lgkmcnt(8)
  v_mfma_f32_32x32x16_bf16 v[64:79], v[204:207], v[172:175], v[64:79]
  ds_read_b64_tr_b16 v[156:157], v211 offset:8192
  ds_read_b64_tr_b16 v[158:159], v211 offset:9216
  v_cvt_pk_bf16_f32 v202, v196, v197
  v_cvt_pk_bf16_f32 v203, v198, v199
  buffer_load_dwordx4 v[104:107], v5, s[8:11], s55 offen offset:2048 sc1
  buffer_load_dwordx4 v[108:111], v5, s[8:11], s55 offen offset:3072 sc1
  s_waitcnt lgkmcnt(8)
  v_mfma_f32_32x32x16_bf16 v[16:31], v[200:203], v[144:147], v[16:31]
  ds_read_b64_tr_b16 v[160:161], v208 offset:12288
  ds_read_b64_tr_b16 v[162:163], v208 offset:13312
  ds_read_b128 v[176:179], v14 offset:1408
  s_waitcnt lgkmcnt(7)
  s_waitcnt vmcnt(4)
  v_fma_mix_f32 v192, v92, v184, v188 op_sel:[0,0,0] op_sel_hi:[1,1,1]
  v_fma_mix_f32 v193, v92, v184, v188 op_sel:[1,1,1] op_sel_hi:[1,1,1]
  v_fma_mix_f32 v194, v93, v185, v189 op_sel:[0,0,0] op_sel_hi:[1,1,1]
  v_mfma_f32_32x32x16_bf16 v[32:47], v[200:203], v[148:151], v[32:47]
  ds_read_b64_tr_b16 v[164:165], v209 offset:12288
  ds_read_b64_tr_b16 v[166:167], v209 offset:13312
  ds_read_b128 v[180:183], v14 offset:128
  v_fma_mix_f32 v195, v93, v185, v189 op_sel:[1,1,1] op_sel_hi:[1,1,1]
  v_fma_mix_f32 v196, v94, v186, v190 op_sel:[0,0,0] op_sel_hi:[1,1,1]
  v_fma_mix_f32 v197, v94, v186, v190 op_sel:[1,1,1] op_sel_hi:[1,1,1]
  s_waitcnt lgkmcnt(8)
  v_mfma_f32_32x32x16_bf16 v[48:63], v[200:203], v[152:155], v[48:63]
  ds_read_b64_tr_b16 v[168:169], v210 offset:12288
  ds_read_b64_tr_b16 v[170:171], v210 offset:13312
  v_fma_mix_f32 v198, v95, v187, v191 op_sel:[0,0,0] op_sel_hi:[1,1,1]
  v_fma_mix_f32 v199, v95, v187, v191 op_sel:[1,1,1] op_sel_hi:[1,1,1]
  v_cvt_pk_bf16_f32 v204, v192, v193
  v_cvt_pk_bf16_f32 v205, v194, v195
  s_waitcnt lgkmcnt(8)
  v_mfma_f32_32x32x16_bf16 v[64:79], v[200:203], v[156:159], v[64:79]
  ds_read_b64_tr_b16 v[172:173], v211 offset:12288
  ds_read_b64_tr_b16 v[174:175], v211 offset:13312
  v_cvt_pk_bf16_f32 v206, v196, v197
  v_cvt_pk_bf16_f32 v207, v198, v199
  s_add_u32 s55, s54, 8192
  buffer_load_dwordx4 v[112:115], v5, s[8:11], s55 offen offset:0 sc1
  buffer_load_dwordx4 v[116:119], v5, s[8:11], s55 offen offset:1024 sc1
  s_waitcnt lgkmcnt(8)
  v_mfma_f32_32x32x16_bf16 v[16:31], v[204:207], v[160:163], v[16:31]
  ds_read_b64_tr_b16 v[144:145], v208 offset:16384
  ds_read_b64_tr_b16 v[146:147], v208 offset:17408
  ds_read_b128 v[184:187], v14 offset:1440
  s_waitcnt lgkmcnt(7)
  s_waitcnt vmcnt(5)
  v_fma_mix_f32 v192, v96, v176, v180 op_sel:[0,0,0] op_sel_hi:[1,1,1]
  v_fma_mix_f32 v193, v96, v176, v180 op_sel:[1,1,1] op_sel_hi:[1,1,1]
  v_fma_mix_f32 v194, v97, v177, v181 op_sel:[0,0,0] op_sel_hi:[1,1,1]
  v_mfma_f32_32x32x16_bf16 v[32:47], v[204:207], v[164:167], v[32:47]
  ds_read_b64_tr_b16 v[148:149], v209 offset:16384
  ds_read_b64_tr_b16 v[150:151], v209 offset:17408
  ds_read_b128 v[188:191], v14 offset:160
  v_fma_mix_f32 v195, v97, v177, v181 op_sel:[1,1,1] op_sel_hi:[1,1,1]
  v_fma_mix_f32 v196, v98, v178, v182 op_sel:[0,0,0] op_sel_hi:[1,1,1]
  v_fma_mix_f32 v197, v98, v178, v182 op_sel:[1,1,1] op_sel_hi:[1,1,1]
  s_waitcnt lgkmcnt(8)
  v_mfma_f32_32x32x16_bf16 v[48:63], v[204:207], v[168:171], v[48:63]
  ds_read_b64_tr_b16 v[152:153], v210 offset:16384
  ds_read_b64_tr_b16 v[154:155], v210 offset:17408
  v_fma_mix_f32 v198, v99, v179, v183 op_sel:[0,0,0] op_sel_hi:[1,1,1]
  v_fma_mix_f32 v199, v99, v179, v183 op_sel:[1,1,1] op_sel_hi:[1,1,1]
  v_cvt_pk_bf16_f32 v200, v192, v193
  v_cvt_pk_bf16_f32 v201, v194, v195
  s_waitcnt lgkmcnt(8)
  v_mfma_f32_32x32x16_bf16 v[64:79], v[204:207], v[172:175], v[64:79]
  ds_read_b64_tr_b16 v[156:157], v211 offset:16384
  ds_read_b64_tr_b16 v[158:159], v211 offset:17408
  v_cvt_pk_bf16_f32 v202, v196, v197
  v_cvt_pk_bf16_f32 v203, v198, v199
  buffer_load_dwordx4 v[120:123], v5, s[8:11], s55 offen offset:2048 sc1
  buffer_load_dwordx4 v[124:127], v5, s[8:11], s55 offen offset:3072 sc1
  s_waitcnt lgkmcnt(8)
  v_mfma_f32_32x32x16_bf16 v[16:31], v[200:203], v[144:147], v[16:31]
  ds_read_b64_tr_b16 v[160:161], v208 offset:20480
  ds_read_b64_tr_b16 v[162:163], v208 offset:21504
  ds_read_b128 v[176:179], v14 offset:1472
  s_waitcnt lgkmcnt(7)
  s_waitcnt vmcnt(6)
  v_fma_mix_f32 v192, v100, v184, v188 op_sel:[0,0,0] op_sel_hi:[1,1,1]
  v_fma_mix_f32 v193, v100, v184, v188 op_sel:[1,1,1] op_sel_hi:[1,1,1]
  v_fma_mix_f32 v194, v101, v185, v189 op_sel:[0,0,0] op_sel_hi:[1,1,1]
  v_mfma_f32_32x32x16_bf16 v[32:47], v[200:203], v[148:151], v[32:47]
  ds_read_b64_tr_b16 v[164:165], v209 offset:20480
  ds_read_b64_tr_b16 v[166:167], v209 offset:21504
  ds_read_b128 v[180:183], v14 offset:192
  v_fma_mix_f32 v195, v101, v185, v189 op_sel:[1,1,1] op_sel_hi:[1,1,1]
  v_fma_mix_f32 v196, v102, v186, v190 op_sel:[0,0,0] op_sel_hi:[1,1,1]
  v_fma_mix_f32 v197, v102, v186, v190 op_sel:[1,1,1] op_sel_hi:[1,1,1]
  s_waitcnt lgkmcnt(8)
  v_mfma_f32_32x32x16_bf16 v[48:63], v[200:203], v[152:155], v[48:63]
  ds_read_b64_tr_b16 v[168:169], v210 offset:20480
  ds_read_b64_tr_b16 v[170:171], v210 offset:21504
  v_fma_mix_f32 v198, v103, v187, v191 op_sel:[0,0,0] op_sel_hi:[1,1,1]
  v_fma_mix_f32 v199, v103, v187, v191 op_sel:[1,1,1] op_sel_hi:[1,1,1]
  v_cvt_pk_bf16_f32 v204, v192, v193
  v_cvt_pk_bf16_f32 v205, v194, v195
  s_waitcnt lgkmcnt(8)
  v_mfma_f32_32x32x16_bf16 v[64:79], v[200:203], v[156:159], v[64:79]
  ds_read_b64_tr_b16 v[172:173], v211 offset:20480
  ds_read_b64_tr_b16 v[174:175], v211 offset:21504
  v_cvt_pk_bf16_f32 v206, v196, v197
  v_cvt_pk_bf16_f32 v207, v198, v199
  s_add_u32 s55, s54, 12288
  buffer_load_dwordx4 v[128:131], v5, s[8:11], s55 offen offset:0 sc1
  buffer_load_dwordx4 v[132:135], v5, s[8:11], s55 offen offset:1024 sc1
  s_waitcnt lgkmcnt(8)
  v_mfma_f32_32x32x16_bf16 v[16:31], v[204:207], v[160:163], v[16:31]
  s_barrier
  ds_read_b64_tr_b16 v[144:145], v208 offset:24576
  ds_read_b64_tr_b16 v[146:147], v208 offset:25600
  ds_read_b128 v[184:187], v14 offset:1504
  s_waitcnt lgkmcnt(7)
  s_waitcnt vmcnt(7)
  v_fma_mix_f32 v192, v104, v176, v180 op_sel:[0,0,0] op_sel_hi:[1,1,1]
  v_fma_mix_f32 v193, v104, v176, v180 op_sel:[1,1,1] op_sel_hi:[1,1,1]
  v_fma_mix_f32 v194, v105, v177, v181 op_sel:[0,0,0] op_sel_hi:[1,1,1]
  v_mfma_f32_32x32x16_bf16 v[32:47], v[204:207], v[164:167], v[32:47]
  ds_read_b64_tr_b16 v[148:149], v209 offset:24576
  ds_read_b64_tr_b16 v[150:151], v209 offset:25600
  ds_read_b128 v[188:191], v14 offset:224
  v_fma_mix_f32 v195, v105, v177, v181 op_sel:[1,1,1] op_sel_hi:[1,1,1]
  v_fma_mix_f32 v196, v106, v178, v182 op_sel:[0,0,0] op_sel_hi:[1,1,1]
  v_fma_mix_f32 v197, v106, v178, v182 op_sel:[1,1,1] op_sel_hi:[1,1,1]
  s_waitcnt lgkmcnt(8)
  v_mfma_f32_32x32x16_bf16 v[48:63], v[204:207], v[168:171], v[48:63]
  ds_read_b64_tr_b16 v[152:153], v210 offset:24576
  ds_read_b64_tr_b16 v[154:155], v210 offset:25600
  v_fma_mix_f32 v198, v107, v179, v183 op_sel:[0,0,0] op_sel_hi:[1,1,1]
  v_fma_mix_f32 v199, v107, v179, v183 op_sel:[1,1,1] op_sel_hi:[1,1,1]
  v_cvt_pk_bf16_f32 v200, v192, v193
  v_cvt_pk_bf16_f32 v201, v194, v195
  s_waitcnt lgkmcnt(8)
  v_mfma_f32_32x32x16_bf16 v[64:79], v[204:207], v[172:175], v[64:79]
  ds_read_b64_tr_b16 v[156:157], v211 offset:24576
  ds_read_b64_tr_b16 v[158:159], v211 offset:25600
  v_cvt_pk_bf16_f32 v202, v196, v197
  v_cvt_pk_bf16_f32 v203, v198, v199
  buffer_load_dwordx4 v[136:139], v5, s[8:11], s55 offen offset:2048 sc1
  buffer_load_dwordx4 v[140:143], v5, s[8:11], s55 offen offset:3072 sc1
  s_waitcnt lgkmcnt(8)
  v_mfma_f32_32x32x16_bf16 v[16:31], v[200:203], v[144:147], v[16:31]
  ds_read_b64_tr_b16 v[160:161], v208 offset:28672
  ds_read_b64_tr_b16 v[162:163], v208 offset:29696
  ds_read_b128 v[176:179], v14 offset:1536
  s_waitcnt lgkmcnt(7)
  s_waitcnt vmcnt(8)
  v_fma_mix_f32 v192, v108, v184, v188 op_sel:[0,0,0] op_sel_hi:[1,1,1]
  v_fma_mix_f32 v193, v108, v184, v188 op_sel:[1,1,1] op_sel_hi:[1,1,1]
  v_fma_mix_f32 v194, v109, v185, v189 op_sel:[0,0,0] op_sel_hi:[1,1,1]
  v_mfma_f32_32x32x16_bf16 v[32:47], v[200:203], v[148:151], v[32:47]
  ds_read_b64_tr_b16 v[164:165], v209 offset:28672
  ds_read_b64_tr_b16 v[166:167], v209 offset:29696
  ds_read_b128 v[180:183], v14 offset:256
  v_fma_mix_f32 v195, v109, v185, v189 op_sel:[1,1,1] op_sel_hi:[1,1,1]
  v_fma_mix_f32 v196, v110, v186, v190 op_sel:[0,0,0] op_sel_hi:[1,1,1]
  v_fma_mix_f32 v197, v110, v186, v190 op_sel:[1,1,1] op_sel_hi:[1,1,1]
  s_waitcnt lgkmcnt(8)
  v_mfma_f32_32x32x16_bf16 v[48:63], v[200:203], v[152:155], v[48:63]
  ds_read_b64_tr_b16 v[168:169], v210 offset:28672
  ds_read_b64_tr_b16 v[170:171], v210 offset:29696
  v_fma_mix_f32 v198, v111, v187, v191 op_sel:[0,0,0] op_sel_hi:[1,1,1]
  v_fma_mix_f32 v199, v111, v187, v191 op_sel:[1,1,1] op_sel_hi:[1,1,1]
  v_cvt_pk_bf16_f32 v204, v192, v193
  v_cvt_pk_bf16_f32 v205, v194, v195
  s_waitcnt lgkmcnt(8)
  v_mfma_f32_32x32x16_bf16 v[64:79], v[200:203], v[156:159], v[64:79]
  ds_read_b64_tr_b16 v[172:173], v211 offset:28672
  ds_read_b64_tr_b16 v[174:175], v211 offset:29696
  v_cvt_pk_bf16_f32 v206, v196, v197
  v_cvt_pk_bf16_f32 v207, v198, v199
  s_add_u32 s55, s54, 16384
  buffer_load_dwordx4 v[80:83], v5, s[8:11], s55 offen offset:0 sc1
  buffer_load_dwordx4 v[84:87], v5, s[8:11], s55 offen offset:1024 sc1
  s_waitcnt lgkmcnt(8)
  v_mfma_f32_32x32x16_bf16 v[16:31], v[204:207], v[160:163], v[16:31]
  ds_read_b64_tr_b16 v[144:145], v208 offset:32768
  ds_read_b64_tr_b16 v[146:147], v208 offset:33792
  ds_read_b128 v[184:187], v14 offset:1568
  s_waitcnt lgkmcnt(7)
  s_waitcnt vmcnt(9)
  v_fma_mix_f32 v192, v112, v176, v180 op_sel:[0,0,0] op_sel_hi:[1,1,1]
  v_fma_mix_f32 v193, v112, v176, v180 op_sel:[1,1,1] op_sel_hi:[1,1,1]
  v_fma_mix_f32 v194, v113, v177, v181 op_sel:[0,0,0] op_sel_hi:[1,1,1]
  v_mfma_f32_32x32x16_bf16 v[32:47], v[204:207], v[164:167], v[32:47]
  ds_read_b64_tr_b16 v[148:149], v209 offset:32768
  ds_read_b64_tr_b16 v[150:151], v209 offset:33792
  ds_read_b128 v[188:191], v14 offset:288
  v_fma_mix_f32 v195, v113, v177, v181 op_sel:[1,1,1] op_sel_hi:[1,1,1]
  v_fma_mix_f32 v196, v114, v178, v182 op_sel:[0,0,0] op_sel_hi:[1,1,1]
  v_fma_mix_f32 v197, v114, v178, v182 op_sel:[1,1,1] op_sel_hi:[1,1,1]
  s_waitcnt lgkmcnt(8)
  v_mfma_f32_32x32x16_bf16 v[48:63], v[204:207], v[168:171], v[48:63]
  ds_read_b64_tr_b16 v[152:153], v210 offset:32768
  ds_read_b64_tr_b16 v[154:155], v210 offset:33792
  v_fma_mix_f32 v198, v115, v179, v183 op_sel:[0,0,0] op_sel_hi:[1,1,1]
  v_fma_mix_f32 v199, v115, v179, v183 op_sel:[1,1,1] op_sel_hi:[1,1,1]
  v_cvt_pk_bf16_f32 v200, v192, v193
  v_cvt_pk_bf16_f32 v201, v194, v195
  s_waitcnt lgkmcnt(8)
  v_mfma_f32_32x32x16_bf16 v[64:79], v[204:207], v[172:175], v[64:79]
  ds_read_b64_tr_b16 v[156:157], v211 offset:32768
  ds_read_b64_tr_b16 v[158:159], v211 offset:33792
  v_cvt_pk_bf16_f32 v202, v196, v197
  v_cvt_pk_bf16_f32 v203, v198, v199
  buffer_load_dwordx4 v[88:91], v5, s[8:11], s55 offen offset:2048 sc1
  s_waitcnt lgkmcnt(8)
  v_mfma_f32_32x32x16_bf16 v[16:31], v[200:203], v[144:147], v[16:31]
  ds_read_b64_tr_b16 v[160:161], v208 offset:36864
  ds_read_b64_tr_b16 v[162:163], v208 offset:37888
  ds_read_b128 v[176:179], v14 offset:1600
  s_waitcnt lgkmcnt(7)
  s_waitcnt vmcnt(9)
  v_fma_mix_f32 v192, v116, v184, v188 op_sel:[0,0,0] op_sel_hi:[1,1,1]
  v_fma_mix_f32 v193, v116, v184, v188 op_sel:[1,1,1] op_sel_hi:[1,1,1]
  v_fma_mix_f32 v194, v117, v185, v189 op_sel:[0,0,0] op_sel_hi:[1,1,1]
  v_mfma_f32_32x32x16_bf16 v[32:47], v[200:203], v[148:151], v[32:47]
  ds_read_b64_tr_b16 v[164:165], v209 offset:36864
  ds_read_b64_tr_b16 v[166:167], v209 offset:37888
  ds_read_b128 v[180:183], v14 offset:320
  v_fma_mix_f32 v195, v117, v185, v189 op_sel:[1,1,1] op_sel_hi:[1,1,1]
  v_fma_mix_f32 v196, v118, v186, v190 op_sel:[0,0,0] op_sel_hi:[1,1,1]
  v_fma_mix_f32 v197, v118, v186, v190 op_sel:[1,1,1] op_sel_hi:[1,1,1]
  s_waitcnt lgkmcnt(8)
  v_mfma_f32_32x32x16_bf16 v[48:63], v[200:203], v[152:155], v[48:63]
  ds_read_b64_tr_b16 v[168:169], v210 offset:36864
  ds_read_b64_tr_b16 v[170:171], v210 offset:37888
  v_fma_mix_f32 v198, v119, v187, v191 op_sel:[0,0,0] op_sel_hi:[1,1,1]
  v_fma_mix_f32 v199, v119, v187, v191 op_sel:[1,1,1] op_sel_hi:[1,1,1]
  v_cvt_pk_bf16_f32 v204, v192, v193
  v_cvt_pk_bf16_f32 v205, v194, v195
  s_waitcnt lgkmcnt(8)
  v_mfma_f32_32x32x16_bf16 v[64:79], v[200:203], v[156:159], v[64:79]
  ds_read_b64_tr_b16 v[172:173], v211 offset:36864
  ds_read_b64_tr_b16 v[174:175], v211 offset:37888
  v_cvt_pk_bf16_f32 v206, v196, v197
  v_cvt_pk_bf16_f32 v207, v198, v199
  buffer_load_dwordx4 v[92:95], v5, s[8:11], s55 offen offset:3072 sc1
  s_waitcnt lgkmcnt(8)
  v_mfma_f32_32x32x16_bf16 v[16:31], v[204:207], v[160:163], v[16:31]
  ds_read_b64_tr_b16 v[144:145], v208 offset:40960
  ds_read_b64_tr_b16 v[146:147], v208 offset:41984
  ds_read_b128 v[184:187], v14 offset:1632
  s_waitcnt lgkmcnt(7)
  s_waitcnt vmcnt(9)
  v_fma_mix_f32 v192, v120, v176, v180 op_sel:[0,0,0] op_sel_hi:[1,1,1]
  v_fma_mix_f32 v193, v120, v176, v180 op_sel:[1,1,1] op_sel_hi:[1,1,1]
  v_fma_mix_f32 v194, v121, v177, v181 op_sel:[0,0,0] op_sel_hi:[1,1,1]
  v_mfma_f32_32x32x16_bf16 v[32:47], v[204:207], v[164:167], v[32:47]
  ds_read_b64_tr_b16 v[148:149], v209 offset:40960
  ds_read_b64_tr_b16 v[150:151], v209 offset:41984
  ds_read_b128 v[188:191], v14 offset:352
  v_fma_mix_f32 v195, v121, v177, v181 op_sel:[1,1,1] op_sel_hi:[1,1,1]
  v_fma_mix_f32 v196, v122, v178, v182 op_sel:[0,0,0] op_sel_hi:[1,1,1]
  v_fma_mix_f32 v197, v122, v178, v182 op_sel:[1,1,1] op_sel_hi:[1,1,1]
  s_waitcnt lgkmcnt(8)
  v_mfma_f32_32x32x16_bf16 v[48:63], v[204:207], v[168:171], v[48:63]
  ds_read_b64_tr_b16 v[152:153], v210 offset:40960
  ds_read_b64_tr_b16 v[154:155], v210 offset:41984
  v_fma_mix_f32 v198, v123, v179, v183 op_sel:[0,0,0] op_sel_hi:[1,1,1]
  v_fma_mix_f32 v199, v123, v179, v183 op_sel:[1,1,1] op_sel_hi:[1,1,1]
  v_cvt_pk_bf16_f32 v200, v192, v193
  v_cvt_pk_bf16_f32 v201, v194, v195
  s_waitcnt lgkmcnt(8)
  v_mfma_f32_32x32x16_bf16 v[64:79], v[204:207], v[172:175], v[64:79]
  ds_read_b64_tr_b16 v[156:157], v211 offset:40960
  ds_read_b64_tr_b16 v[158:159], v211 offset:41984
  v_cvt_pk_bf16_f32 v202, v196, v197
  v_cvt_pk_bf16_f32 v203, v198, v199
  s_add_u32 s55, s54, 20480
  buffer_load_dwordx4 v[96:99], v5, s[8:11], s55 offen offset:0 sc1
  s_waitcnt lgkmcnt(8)
  v_mfma_f32_32x32x16_bf16 v[16:31], v[200:203], v[144:147], v[16:31]
  ds_read_b64_tr_b16 v[160:161], v208 offset:45056
  ds_read_b64_tr_b16 v[162:163], v208 offset:46080
  ds_read_b128 v[176:179], v14 offset:1664
  s_waitcnt lgkmcnt(7)
  s_waitcnt vmcnt(9)
  v_fma_mix_f32 v192, v124, v184, v188 op_sel:[0,0,0] op_sel_hi:[1,1,1]
  v_fma_mix_f32 v193, v124, v184, v188 op_sel:[1,1,1] op_sel_hi:[1,1,1]
  v_fma_mix_f32 v194, v125, v185, v189 op_sel:[0,0,0] op_sel_hi:[1,1,1]
  v_mfma_f32_32x32x16_bf16 v[32:47], v[200:203], v[148:151], v[32:47]
  ds_read_b64_tr_b16 v[164:165], v209 offset:45056
  ds_read_b64_tr_b16 v[166:167], v209 offset:46080
  ds_read_b128 v[180:183], v14 offset:384
  v_fma_mix_f32 v195, v125, v185, v189 op_sel:[1,1,1] op_sel_hi:[1,1,1]
  v_fma_mix_f32 v196, v126, v186, v190 op_sel:[0,0,0] op_sel_hi:[1,1,1]
  v_fma_mix_f32 v197, v126, v186, v190 op_sel:[1,1,1] op_sel_hi:[1,1,1]
  s_waitcnt lgkmcnt(8)
  v_mfma_f32_32x32x16_bf16 v[48:63], v[200:203], v[152:155], v[48:63]
  ds_read_b64_tr_b16 v[168:169], v210 offset:45056
  ds_read_b64_tr_b16 v[170:171], v210 offset:46080
  v_fma_mix_f32 v198, v127, v187, v191 op_sel:[0,0,0] op_sel_hi:[1,1,1]
  v_fma_mix_f32 v199, v127, v187, v191 op_sel:[1,1,1] op_sel_hi:[1,1,1]
  v_cvt_pk_bf16_f32 v204, v192, v193
  v_cvt_pk_bf16_f32 v205, v194, v195
  s_waitcnt lgkmcnt(8)
  v_mfma_f32_32x32x16_bf16 v[64:79], v[200:203], v[156:159], v[64:79]
  ds_read_b64_tr_b16 v[172:173], v211 offset:45056
  ds_read_b64_tr_b16 v[174:175], v211 offset:46080
  v_cvt_pk_bf16_f32 v206, v196, v197
  v_cvt_pk_bf16_f32 v207, v198, v199
  buffer_load_dwordx4 v[100:103], v5, s[8:11], s55 offen offset:1024 sc1
  s_waitcnt lgkmcnt(8)
  v_mfma_f32_32x32x16_bf16 v[16:31], v[204:207], v[160:163], v[16:31]
  ds_read_b64_tr_b16 v[144:145], v208 offset:49152
  ds_read_b64_tr_b16 v[146:147], v208 offset:50176
  ds_read_b128 v[184:187], v14 offset:1696
  s_waitcnt lgkmcnt(7)
  s_waitcnt vmcnt(9)
  v_fma_mix_f32 v192, v128, v176, v180 op_sel:[0,0,0] op_sel_hi:[1,1,1]
  v_fma_mix_f32 v193, v128, v176, v180 op_sel:[1,1,1] op_sel_hi:[1,1,1]
  v_fma_mix_f32 v194, v129, v177, v181 op_sel:[0,0,0] op_sel_hi:[1,1,1]
  v_mfma_f32_32x32x16_bf16 v[32:47], v[204:207], v[164:167], v[32:47]
  ds_read_b64_tr_b16 v[148:149], v209 offset:49152
  ds_read_b64_tr_b16 v[150:151], v209 offset:50176
  ds_read_b128 v[188:191], v14 offset:416
  v_fma_mix_f32 v195, v129, v177, v181 op_sel:[1,1,1] op_sel_hi:[1,1,1]
  v_fma_mix_f32 v196, v130, v178, v182 op_sel:[0,0,0] op_sel_hi:[1,1,1]
  v_fma_mix_f32 v197, v130, v178, v182 op_sel:[1,1,1] op_sel_hi:[1,1,1]
  s_waitcnt lgkmcnt(8)
  v_mfma_f32_32x32x16_bf16 v[48:63], v[204:207], v[168:171], v[48:63]
  ds_read_b64_tr_b16 v[152:153], v210 offset:49152
  ds_read_b64_tr_b16 v[154:155], v210 offset:50176
  v_fma_mix_f32 v198, v131, v179, v183 op_sel:[0,0,0] op_sel_hi:[1,1,1]
  v_fma_mix_f32 v199, v131, v179, v183 op_sel:[1,1,1] op_sel_hi:[1,1,1]
  v_cvt_pk_bf16_f32 v200, v192, v193
  v_cvt_pk_bf16_f32 v201, v194, v195
  s_waitcnt lgkmcnt(8)
  v_mfma_f32_32x32x16_bf16 v[64:79], v[204:207], v[172:175], v[64:79]
  ds_read_b64_tr_b16 v[156:157], v211 offset:49152
  ds_read_b64_tr_b16 v[158:159], v211 offset:50176
  v_cvt_pk_bf16_f32 v202, v196, v197
  v_cvt_pk_bf16_f32 v203, v198, v199
  buffer_load_dwordx4 v[104:107], v5, s[8:11], s55 offen offset:2048 sc1
  s_waitcnt lgkmcnt(8)
  v_mfma_f32_32x32x16_bf16 v[16:31], v[200:203], v[144:147], v[16:31]
  ds_read_b64_tr_b16 v[160:161], v208 offset:53248
  ds_read_b64_tr_b16 v[162:163], v208 offset:54272
  ds_read_b128 v[176:179], v14 offset:1728
  s_waitcnt lgkmcnt(7)
  s_waitcnt vmcnt(9)
  v_fma_mix_f32 v192, v132, v184, v188 op_sel:[0,0,0] op_sel_hi:[1,1,1]
  v_fma_mix_f32 v193, v132, v184, v188 op_sel:[1,1,1] op_sel_hi:[1,1,1]
  v_fma_mix_f32 v194, v133, v185, v189 op_sel:[0,0,0] op_sel_hi:[1,1,1]
  v_mfma_f32_32x32x16_bf16 v[32:47], v[200:203], v[148:151], v[32:47]
  ds_read_b64_tr_b16 v[164:165], v209 offset:53248
  ds_read_b64_tr_b16 v[166:167], v209 offset:54272
  ds_read_b128 v[180:183], v14 offset:448
  v_fma_mix_f32 v195, v133, v185, v189 op_sel:[1,1,1] op_sel_hi:[1,1,1]
  v_fma_mix_f32 v196, v134, v186, v190 op_sel:[0,0,0] op_sel_hi:[1,1,1]
  v_fma_mix_f32 v197, v134, v186, v190 op_sel:[1,1,1] op_sel_hi:[1,1,1]
  s_waitcnt lgkmcnt(8)
  v_mfma_f32_32x32x16_bf16 v[48:63], v[200:203], v[152:155], v[48:63]
  ds_read_b64_tr_b16 v[168:169], v210 offset:53248
  ds_read_b64_tr_b16 v[170:171], v210 offset:54272
  v_fma_mix_f32 v198, v135, v187, v191 op_sel:[0,0,0] op_sel_hi:[1,1,1]
  v_fma_mix_f32 v199, v135, v187, v191 op_sel:[1,1,1] op_sel_hi:[1,1,1]
  v_cvt_pk_bf16_f32 v204, v192, v193
  v_cvt_pk_bf16_f32 v205, v194, v195
  s_waitcnt lgkmcnt(8)
  v_mfma_f32_32x32x16_bf16 v[64:79], v[200:203], v[156:159], v[64:79]
  ds_read_b64_tr_b16 v[172:173], v211 offset:53248
  ds_read_b64_tr_b16 v[174:175], v211 offset:54272
  v_cvt_pk_bf16_f32 v206, v196, v197
  v_cvt_pk_bf16_f32 v207, v198, v199
  buffer_load_dwordx4 v[108:111], v5, s[8:11], s55 offen offset:3072 sc1
  s_waitcnt lgkmcnt(8)
  v_mfma_f32_32x32x16_bf16 v[16:31], v[204:207], v[160:163], v[16:31]
  ds_read_b64_tr_b16 v[144:145], v208 offset:57344
  ds_read_b64_tr_b16 v[146:147], v208 offset:58368
  ds_read_b128 v[184:187], v14 offset:1760
  s_waitcnt lgkmcnt(7)
  s_waitcnt vmcnt(9)
  v_fma_mix_f32 v192, v136, v176, v180 op_sel:[0,0,0] op_sel_hi:[1,1,1]
  v_fma_mix_f32 v193, v136, v176, v180 op_sel:[1,1,1] op_sel_hi:[1,1,1]
  v_fma_mix_f32 v194, v137, v177, v181 op_sel:[0,0,0] op_sel_hi:[1,1,1]
  v_mfma_f32_32x32x16_bf16 v[32:47], v[204:207], v[164:167], v[32:47]
  ds_read_b64_tr_b16 v[148:149], v209 offset:57344
  ds_read_b64_tr_b16 v[150:151], v209 offset:58368
  ds_read_b128 v[188:191], v14 offset:480
  v_fma_mix_f32 v195, v137, v177, v181 op_sel:[1,1,1] op_sel_hi:[1,1,1]
  v_fma_mix_f32 v196, v138, v178, v182 op_sel:[0,0,0] op_sel_hi:[1,1,1]
  v_fma_mix_f32 v197, v138, v178, v182 op_sel:[1,1,1] op_sel_hi:[1,1,1]
  s_waitcnt lgkmcnt(8)
  v_mfma_f32_32x32x16_bf16 v[48:63], v[204:207], v[168:171], v[48:63]
  ds_read_b64_tr_b16 v[152:153], v210 offset:57344
  ds_read_b64_tr_b16 v[154:155], v210 offset:58368
  v_fma_mix_f32 v198, v139, v179, v183 op_sel:[0,0,0] op_sel_hi:[1,1,1]
  v_fma_mix_f32 v199, v139, v179, v183 op_sel:[1,1,1] op_sel_hi:[1,1,1]
  v_cvt_pk_bf16_f32 v200, v192, v193
  v_cvt_pk_bf16_f32 v201, v194, v195
  s_waitcnt lgkmcnt(8)
  v_mfma_f32_32x32x16_bf16 v[64:79], v[204:207], v[172:175], v[64:79]
  ds_read_b64_tr_b16 v[156:157], v211 offset:57344
  ds_read_b64_tr_b16 v[158:159], v211 offset:58368
  v_cvt_pk_bf16_f32 v202, v196, v197
  v_cvt_pk_bf16_f32 v203, v198, v199
  s_add_u32 s55, s54, 24576
  buffer_load_dwordx4 v[112:115], v5, s[8:11], s55 offen offset:0 sc1
  s_waitcnt lgkmcnt(8)
  v_mfma_f32_32x32x16_bf16 v[16:31], v[200:203], v[144:147], v[16:31]
  ds_read_b64_tr_b16 v[160:161], v208 offset:61440
  ds_read_b64_tr_b16 v[162:163], v208 offset:62464
  ds_read_b128 v[176:179], v14 offset:1792
  s_waitcnt lgkmcnt(7)
  s_waitcnt vmcnt(9)
  v_fma_mix_f32 v192, v140, v184, v188 op_sel:[0,0,0] op_sel_hi:[1,1,1]
  v_fma_mix_f32 v193, v140, v184, v188 op_sel:[1,1,1] op_sel_hi:[1,1,1]
  v_fma_mix_f32 v194, v141, v185, v189 op_sel:[0,0,0] op_sel_hi:[1,1,1]
  v_mfma_f32_32x32x16_bf16 v[32:47], v[200:203], v[148:151], v[32:47]
  ds_read_b64_tr_b16 v[164:165], v209 offset:61440
  ds_read_b64_tr_b16 v[166:167], v209 offset:62464
  ds_read_b128 v[180:183], v14 offset:512
  v_fma_mix_f32 v195, v141, v185, v189 op_sel:[1,1,1] op_sel_hi:[1,1,1]
  v_fma_mix_f32 v196, v142, v186, v190 op_sel:[0,0,0] op_sel_hi:[1,1,1]
  v_fma_mix_f32 v197, v142, v186, v190 op_sel:[1,1,1] op_sel_hi:[1,1,1]
  s_waitcnt lgkmcnt(8)
  v_mfma_f32_32x32x16_bf16 v[48:63], v[200:203], v[152:155], v[48:63]
  ds_read_b64_tr_b16 v[168:169], v210 offset:61440
  ds_read_b64_tr_b16 v[170:171], v210 offset:62464
  v_fma_mix_f32 v198, v143, v187, v191 op_sel:[0,0,0] op_sel_hi:[1,1,1]
  v_fma_mix_f32 v199, v143, v187, v191 op_sel:[1,1,1] op_sel_hi:[1,1,1]
  v_cvt_pk_bf16_f32 v204, v192, v193
  v_cvt_pk_bf16_f32 v205, v194, v195
  s_waitcnt lgkmcnt(8)
  v_mfma_f32_32x32x16_bf16 v[64:79], v[200:203], v[156:159], v[64:79]
  ds_read_b64_tr_b16 v[172:173], v211 offset:61440
  ds_read_b64_tr_b16 v[174:175], v211 offset:62464
  v_cvt_pk_bf16_f32 v206, v196, v197
  v_cvt_pk_bf16_f32 v207, v198, v199
  buffer_load_dwordx4 v[116:119], v5, s[8:11], s55 offen offset:1024 sc1
  s_waitcnt lgkmcnt(8)
  v_mfma_f32_32x32x16_bf16 v[16:31], v[204:207], v[160:163], v[16:31]
  ds_read_b64_tr_b16 v[144:145], v212 offset:0
  ds_read_b64_tr_b16 v[146:147], v212 offset:1024
  ds_read_b128 v[184:187], v14 offset:1824
  s_waitcnt lgkmcnt(7)
  s_waitcnt vmcnt(9)
  v_fma_mix_f32 v192, v80, v176, v180 op_sel:[0,0,0] op_sel_hi:[1,1,1]
  v_fma_mix_f32 v193, v80, v176, v180 op_sel:[1,1,1] op_sel_hi:[1,1,1]
  v_fma_mix_f32 v194, v81, v177, v181 op_sel:[0,0,0] op_sel_hi:[1,1,1]
  v_mfma_f32_32x32x16_bf16 v[32:47], v[204:207], v[164:167], v[32:47]
  ds_read_b64_tr_b16 v[148:149], v213 offset:0
  ds_read_b64_tr_b16 v[150:151], v213 offset:1024
  ds_read_b128 v[188:191], v14 offset:544
  v_fma_mix_f32 v195, v81, v177, v181 op_sel:[1,1,1] op_sel_hi:[1,1,1]
  v_fma_mix_f32 v196, v82, v178, v182 op_sel:[0,0,0] op_sel_hi:[1,1,1]
  v_fma_mix_f32 v197, v82, v178, v182 op_sel:[1,1,1] op_sel_hi:[1,1,1]
  s_waitcnt lgkmcnt(8)
  v_mfma_f32_32x32x16_bf16 v[48:63], v[204:207], v[168:171], v[48:63]
  ds_read_b64_tr_b16 v[152:153], v214 offset:0
  ds_read_b64_tr_b16 v[154:155], v214 offset:1024
  v_fma_mix_f32 v198, v83, v179, v183 op_sel:[0,0,0] op_sel_hi:[1,1,1]
  v_fma_mix_f32 v199, v83, v179, v183 op_sel:[1,1,1] op_sel_hi:[1,1,1]
  v_cvt_pk_bf16_f32 v200, v192, v193
  v_cvt_pk_bf16_f32 v201, v194, v195
  s_waitcnt lgkmcnt(8)
  v_mfma_f32_32x32x16_bf16 v[64:79], v[204:207], v[172:175], v[64:79]
  ds_read_b64_tr_b16 v[156:157], v215 offset:0
  ds_read_b64_tr_b16 v[158:159], v215 offset:1024
  v_cvt_pk_bf16_f32 v202, v196, v197
  v_cvt_pk_bf16_f32 v203, v198, v199
  buffer_load_dwordx4 v[120:123], v5, s[8:11], s55 offen offset:2048 sc1
  s_waitcnt lgkmcnt(8)
  v_mfma_f32_32x32x16_bf16 v[16:31], v[200:203], v[144:147], v[16:31]
  ds_read_b64_tr_b16 v[160:161], v212 offset:4096
  ds_read_b64_tr_b16 v[162:163], v212 offset:5120
  ds_read_b128 v[176:179], v14 offset:1856
  s_waitcnt lgkmcnt(7)
  s_waitcnt vmcnt(9)
  v_fma_mix_f32 v192, v84, v184, v188 op_sel:[0,0,0] op_sel_hi:[1,1,1]
  v_fma_mix_f32 v193, v84, v184, v188 op_sel:[1,1,1] op_sel_hi:[1,1,1]
  v_fma_mix_f32 v194, v85, v185, v189 op_sel:[0,0,0] op_sel_hi:[1,1,1]
  v_mfma_f32_32x32x16_bf16 v[32:47], v[200:203], v[148:151], v[32:47]
  ds_read_b64_tr_b16 v[164:165], v213 offset:4096
  ds_read_b64_tr_b16 v[166:167], v213 offset:5120
  ds_read_b128 v[180:183], v14 offset:576
  v_fma_mix_f32 v195, v85, v185, v189 op_sel:[1,1,1] op_sel_hi:[1,1,1]
  v_fma_mix_f32 v196, v86, v186, v190 op_sel:[0,0,0] op_sel_hi:[1,1,1]
  v_fma_mix_f32 v197, v86, v186, v190 op_sel:[1,1,1] op_sel_hi:[1,1,1]
  s_waitcnt lgkmcnt(8)
  v_mfma_f32_32x32x16_bf16 v[48:63], v[200:203], v[152:155], v[48:63]
  ds_read_b64_tr_b16 v[168:169], v214 offset:4096
  ds_read_b64_tr_b16 v[170:171], v214 offset:5120
  v_fma_mix_f32 v198, v87, v187, v191 op_sel:[0,0,0] op_sel_hi:[1,1,1]
  v_fma_mix_f32 v199, v87, v187, v191 op_sel:[1,1,1] op_sel_hi:[1,1,1]
  v_cvt_pk_bf16_f32 v204, v192, v193
  v_cvt_pk_bf16_f32 v205, v194, v195
  s_waitcnt lgkmcnt(8)
  v_mfma_f32_32x32x16_bf16 v[64:79], v[200:203], v[156:159], v[64:79]
  ds_read_b64_tr_b16 v[172:173], v215 offset:4096
  ds_read_b64_tr_b16 v[174:175], v215 offset:5120
  v_cvt_pk_bf16_f32 v206, v196, v197
  v_cvt_pk_bf16_f32 v207, v198, v199
  buffer_load_dwordx4 v[124:127], v5, s[8:11], s55 offen offset:3072 sc1
  s_waitcnt lgkmcnt(8)
  v_mfma_f32_32x32x16_bf16 v[16:31], v[204:207], v[160:163], v[16:31]
  ds_read_b64_tr_b16 v[144:145], v212 offset:8192
  ds_read_b64_tr_b16 v[146:147], v212 offset:9216
  ds_read_b128 v[184:187], v14 offset:1888
  s_waitcnt lgkmcnt(7)
  s_waitcnt vmcnt(9)
  v_fma_mix_f32 v192, v88, v176, v180 op_sel:[0,0,0] op_sel_hi:[1,1,1]
  v_fma_mix_f32 v193, v88, v176, v180 op_sel:[1,1,1] op_sel_hi:[1,1,1]
  v_fma_mix_f32 v194, v89, v177, v181 op_sel:[0,0,0] op_sel_hi:[1,1,1]
  v_mfma_f32_32x32x16_bf16 v[32:47], v[204:207], v[164:167], v[32:47]
  ds_read_b64_tr_b16 v[148:149], v213 offset:8192
  ds_read_b64_tr_b16 v[150:151], v213 offset:9216
  ds_read_b128 v[188:191], v14 offset:608
  v_fma_mix_f32 v195, v89, v177, v181 op_sel:[1,1,1] op_sel_hi:[1,1,1]
  v_fma_mix_f32 v196, v90, v178, v182 op_sel:[0,0,0] op_sel_hi:[1,1,1]
  v_fma_mix_f32 v197, v90, v178, v182 op_sel:[1,1,1] op_sel_hi:[1,1,1]
  s_waitcnt lgkmcnt(8)
  v_mfma_f32_32x32x16_bf16 v[48:63], v[204:207], v[168:171], v[48:63]
  ds_read_b64_tr_b16 v[152:153], v214 offset:8192
  ds_read_b64_tr_b16 v[154:155], v214 offset:9216
  v_fma_mix_f32 v198, v91, v179, v183 op_sel:[0,0,0] op_sel_hi:[1,1,1]
  v_fma_mix_f32 v199, v91, v179, v183 op_sel:[1,1,1] op_sel_hi:[1,1,1]
  v_cvt_pk_bf16_f32 v200, v192, v193
  v_cvt_pk_bf16_f32 v201, v194, v195
  s_waitcnt lgkmcnt(8)
  v_mfma_f32_32x32x16_bf16 v[64:79], v[204:207], v[172:175], v[64:79]
  ds_read_b64_tr_b16 v[156:157], v215 offset:8192
  ds_read_b64_tr_b16 v[158:159], v215 offset:9216
  v_cvt_pk_bf16_f32 v202, v196, v197
  v_cvt_pk_bf16_f32 v203, v198, v199
  s_add_u32 s55, s54, 28672
  buffer_load_dwordx4 v[128:131], v5, s[8:11], s55 offen offset:0 sc1
  s_waitcnt lgkmcnt(8)
  v_mfma_f32_32x32x16_bf16 v[16:31], v[200:203], v[144:147], v[16:31]
  ds_read_b64_tr_b16 v[160:161], v212 offset:12288
  ds_read_b64_tr_b16 v[162:163], v212 offset:13312
  ds_read_b128 v[176:179], v14 offset:1920
  s_waitcnt lgkmcnt(7)
  s_waitcnt vmcnt(9)
  v_fma_mix_f32 v192, v92, v184, v188 op_sel:[0,0,0] op_sel_hi:[1,1,1]
  v_fma_mix_f32 v193, v92, v184, v188 op_sel:[1,1,1] op_sel_hi:[1,1,1]
  v_fma_mix_f32 v194, v93, v185, v189 op_sel:[0,0,0] op_sel_hi:[1,1,1]
  v_mfma_f32_32x32x16_bf16 v[32:47], v[200:203], v[148:151], v[32:47]
  ds_read_b64_tr_b16 v[164:165], v213 offset:12288
  ds_read_b64_tr_b16 v[166:167], v213 offset:13312
  ds_read_b128 v[180:183], v14 offset:640
  v_fma_mix_f32 v195, v93, v185, v189 op_sel:[1,1,1] op_sel_hi:[1,1,1]
  v_fma_mix_f32 v196, v94, v186, v190 op_sel:[0,0,0] op_sel_hi:[1,1,1]
  v_fma_mix_f32 v197, v94, v186, v190 op_sel:[1,1,1] op_sel_hi:[1,1,1]
  s_waitcnt lgkmcnt(8)
  v_mfma_f32_32x32x16_bf16 v[48:63], v[200:203], v[152:155], v[48:63]
  ds_read_b64_tr_b16 v[168:169], v214 offset:12288
  ds_read_b64_tr_b16 v[170:171], v214 offset:13312
  v_fma_mix_f32 v198, v95, v187, v191 op_sel:[0,0,0] op_sel_hi:[1,1,1]
  v_fma_mix_f32 v199, v95, v187, v191 op_sel:[1,1,1] op_sel_hi:[1,1,1]
  v_cvt_pk_bf16_f32 v204, v192, v193
  v_cvt_pk_bf16_f32 v205, v194, v195
  s_waitcnt lgkmcnt(8)
  v_mfma_f32_32x32x16_bf16 v[64:79], v[200:203], v[156:159], v[64:79]
  ds_read_b64_tr_b16 v[172:173], v215 offset:12288
  ds_read_b64_tr_b16 v[174:175], v215 offset:13312
  v_cvt_pk_bf16_f32 v206, v196, v197
  v_cvt_pk_bf16_f32 v207, v198, v199
  buffer_load_dwordx4 v[132:135], v5, s[8:11], s55 offen offset:1024 sc1
  s_waitcnt lgkmcnt(8)
  v_mfma_f32_32x32x16_bf16 v[16:31], v[204:207], v[160:163], v[16:31]
  ds_read_b64_tr_b16 v[144:145], v212 offset:16384
  ds_read_b64_tr_b16 v[146:147], v212 offset:17408
  ds_read_b128 v[184:187], v14 offset:1952
  s_waitcnt lgkmcnt(7)
  s_waitcnt vmcnt(9)
  v_fma_mix_f32 v192, v96, v176, v180 op_sel:[0,0,0] op_sel_hi:[1,1,1]
  v_fma_mix_f32 v193, v96, v176, v180 op_sel:[1,1,1] op_sel_hi:[1,1,1]
  v_fma_mix_f32 v194, v97, v177, v181 op_sel:[0,0,0] op_sel_hi:[1,1,1]
  v_mfma_f32_32x32x16_bf16 v[32:47], v[204:207], v[164:167], v[32:47]
  ds_read_b64_tr_b16 v[148:149], v213 offset:16384
  ds_read_b64_tr_b16 v[150:151], v213 offset:17408
  ds_read_b128 v[188:191], v14 offset:672
  v_fma_mix_f32 v195, v97, v177, v181 op_sel:[1,1,1] op_sel_hi:[1,1,1]
  v_fma_mix_f32 v196, v98, v178, v182 op_sel:[0,0,0] op_sel_hi:[1,1,1]
  v_fma_mix_f32 v197, v98, v178, v182 op_sel:[1,1,1] op_sel_hi:[1,1,1]
  s_waitcnt lgkmcnt(8)
  v_mfma_f32_32x32x16_bf16 v[48:63], v[204:207], v[168:171], v[48:63]
  ds_read_b64_tr_b16 v[152:153], v214 offset:16384
  ds_read_b64_tr_b16 v[154:155], v214 offset:17408
  v_fma_mix_f32 v198, v99, v179, v183 op_sel:[0,0,0] op_sel_hi:[1,1,1]
  v_fma_mix_f32 v199, v99, v179, v183 op_sel:[1,1,1] op_sel_hi:[1,1,1]
  v_cvt_pk_bf16_f32 v200, v192, v193
  v_cvt_pk_bf16_f32 v201, v194, v195
  s_waitcnt lgkmcnt(8)
  v_mfma_f32_32x32x16_bf16 v[64:79], v[204:207], v[172:175], v[64:79]
  ds_read_b64_tr_b16 v[156:157], v215 offset:16384
  ds_read_b64_tr_b16 v[158:159], v215 offset:17408
  v_cvt_pk_bf16_f32 v202, v196, v197
  v_cvt_pk_bf16_f32 v203, v198, v199
  buffer_load_dwordx4 v[136:139], v5, s[8:11], s55 offen offset:2048 sc1
  s_waitcnt lgkmcnt(8)
  v_mfma_f32_32x32x16_bf16 v[16:31], v[200:203], v[144:147], v[16:31]
  ds_read_b64_tr_b16 v[160:161], v212 offset:20480
  ds_read_b64_tr_b16 v[162:163], v212 offset:21504
  ds_read_b128 v[176:179], v14 offset:1984
  s_waitcnt lgkmcnt(7)
  s_waitcnt vmcnt(9)
  v_fma_mix_f32 v192, v100, v184, v188 op_sel:[0,0,0] op_sel_hi:[1,1,1]
  v_fma_mix_f32 v193, v100, v184, v188 op_sel:[1,1,1] op_sel_hi:[1,1,1]
  v_fma_mix_f32 v194, v101, v185, v189 op_sel:[0,0,0] op_sel_hi:[1,1,1]
  v_mfma_f32_32x32x16_bf16 v[32:47], v[200:203], v[148:151], v[32:47]
  ds_read_b64_tr_b16 v[164:165], v213 offset:20480
  ds_read_b64_tr_b16 v[166:167], v213 offset:21504
  ds_read_b128 v[180:183], v14 offset:704
  v_fma_mix_f32 v195, v101, v185, v189 op_sel:[1,1,1] op_sel_hi:[1,1,1]
  v_fma_mix_f32 v196, v102, v186, v190 op_sel:[0,0,0] op_sel_hi:[1,1,1]
  v_fma_mix_f32 v197, v102, v186, v190 op_sel:[1,1,1] op_sel_hi:[1,1,1]
  s_waitcnt lgkmcnt(8)
  v_mfma_f32_32x32x16_bf16 v[48:63], v[200:203], v[152:155], v[48:63]
  ds_read_b64_tr_b16 v[168:169], v214 offset:20480
  ds_read_b64_tr_b16 v[170:171], v214 offset:21504
  v_fma_mix_f32 v198, v103, v187, v191 op_sel:[0,0,0] op_sel_hi:[1,1,1]
  v_fma_mix_f32 v199, v103, v187, v191 op_sel:[1,1,1] op_sel_hi:[1,1,1]
  v_cvt_pk_bf16_f32 v204, v192, v193
  v_cvt_pk_bf16_f32 v205, v194, v195
  s_waitcnt lgkmcnt(8)
  v_mfma_f32_32x32x16_bf16 v[64:79], v[200:203], v[156:159], v[64:79]
  ds_read_b64_tr_b16 v[172:173], v215 offset:20480
  ds_read_b64_tr_b16 v[174:175], v215 offset:21504
  v_cvt_pk_bf16_f32 v206, v196, v197
  v_cvt_pk_bf16_f32 v207, v198, v199
  buffer_load_dwordx4 v[140:143], v5, s[8:11], s55 offen offset:3072 sc1
  s_waitcnt lgkmcnt(8)
  v_mfma_f32_32x32x16_bf16 v[16:31], v[204:207], v[160:163], v[16:31]
  ds_read_b64_tr_b16 v[144:145], v212 offset:24576
  ds_read_b64_tr_b16 v[146:147], v212 offset:25600
  ds_read_b128 v[184:187], v14 offset:2016
  s_waitcnt lgkmcnt(7)
  s_waitcnt vmcnt(9)
  v_fma_mix_f32 v192, v104, v176, v180 op_sel:[0,0,0] op_sel_hi:[1,1,1]
  v_fma_mix_f32 v193, v104, v176, v180 op_sel:[1,1,1] op_sel_hi:[1,1,1]
  v_fma_mix_f32 v194, v105, v177, v181 op_sel:[0,0,0] op_sel_hi:[1,1,1]
  v_mfma_f32_32x32x16_bf16 v[32:47], v[204:207], v[164:167], v[32:47]
  ds_read_b64_tr_b16 v[148:149], v213 offset:24576
  ds_read_b64_tr_b16 v[150:151], v213 offset:25600
  ds_read_b128 v[188:191], v14 offset:736
  v_fma_mix_f32 v195, v105, v177, v181 op_sel:[1,1,1] op_sel_hi:[1,1,1]
  v_fma_mix_f32 v196, v106, v178, v182 op_sel:[0,0,0] op_sel_hi:[1,1,1]
  v_fma_mix_f32 v197, v106, v178, v182 op_sel:[1,1,1] op_sel_hi:[1,1,1]
  s_waitcnt lgkmcnt(8)
  v_mfma_f32_32x32x16_bf16 v[48:63], v[204:207], v[168:171], v[48:63]
  ds_read_b64_tr_b16 v[152:153], v214 offset:24576
  ds_read_b64_tr_b16 v[154:155], v214 offset:25600
  v_fma_mix_f32 v198, v107, v179, v183 op_sel:[0,0,0] op_sel_hi:[1,1,1]
  v_fma_mix_f32 v199, v107, v179, v183 op_sel:[1,1,1] op_sel_hi:[1,1,1]
  v_cvt_pk_bf16_f32 v200, v192, v193
  v_cvt_pk_bf16_f32 v201, v194, v195
  s_waitcnt lgkmcnt(8)
  v_mfma_f32_32x32x16_bf16 v[64:79], v[204:207], v[172:175], v[64:79]
  ds_read_b64_tr_b16 v[156:157], v215 offset:24576
  ds_read_b64_tr_b16 v[158:159], v215 offset:25600
  v_cvt_pk_bf16_f32 v202, v196, v197
  v_cvt_pk_bf16_f32 v203, v198, v199
  s_add_u32 s55, s54, 32768
  buffer_load_dwordx4 v[80:83], v5, s[8:11], s55 offen offset:0 sc1
  s_waitcnt lgkmcnt(8)
  v_mfma_f32_32x32x16_bf16 v[16:31], v[200:203], v[144:147], v[16:31]
  ds_read_b64_tr_b16 v[160:161], v212 offset:28672
  ds_read_b64_tr_b16 v[162:163], v212 offset:29696
  ds_read_b128 v[176:179], v14 offset:2048
  s_waitcnt lgkmcnt(7)
  s_waitcnt vmcnt(9)
  v_fma_mix_f32 v192, v108, v184, v188 op_sel:[0,0,0] op_sel_hi:[1,1,1]
  v_fma_mix_f32 v193, v108, v184, v188 op_sel:[1,1,1] op_sel_hi:[1,1,1]
  v_fma_mix_f32 v194, v109, v185, v189 op_sel:[0,0,0] op_sel_hi:[1,1,1]
  v_mfma_f32_32x32x16_bf16 v[32:47], v[200:203], v[148:151], v[32:47]
  ds_read_b64_tr_b16 v[164:165], v213 offset:28672
  ds_read_b64_tr_b16 v[166:167], v213 offset:29696
  ds_read_b128 v[180:183], v14 offset:768
  v_fma_mix_f32 v195, v109, v185, v189 op_sel:[1,1,1] op_sel_hi:[1,1,1]
  v_fma_mix_f32 v196, v110, v186, v190 op_sel:[0,0,0] op_sel_hi:[1,1,1]
  v_fma_mix_f32 v197, v110, v186, v190 op_sel:[1,1,1] op_sel_hi:[1,1,1]
  s_waitcnt lgkmcnt(8)
  v_mfma_f32_32x32x16_bf16 v[48:63], v[200:203], v[152:155], v[48:63]
  ds_read_b64_tr_b16 v[168:169], v214 offset:28672
  ds_read_b64_tr_b16 v[170:171], v214 offset:29696
  v_fma_mix_f32 v198, v111, v187, v191 op_sel:[0,0,0] op_sel_hi:[1,1,1]
  v_fma_mix_f32 v199, v111, v187, v191 op_sel:[1,1,1] op_sel_hi:[1,1,1]
  v_cvt_pk_bf16_f32 v204, v192, v193
  v_cvt_pk_bf16_f32 v205, v194, v195
  s_waitcnt lgkmcnt(8)
  v_mfma_f32_32x32x16_bf16 v[64:79], v[200:203], v[156:159], v[64:79]
  ds_read_b64_tr_b16 v[172:173], v215 offset:28672
  ds_read_b64_tr_b16 v[174:175], v215 offset:29696
  v_cvt_pk_bf16_f32 v206, v196, v197
  v_cvt_pk_bf16_f32 v207, v198, v199
  buffer_load_dwordx4 v[84:87], v5, s[8:11], s55 offen offset:1024 sc1
  s_waitcnt lgkmcnt(8)
  v_mfma_f32_32x32x16_bf16 v[16:31], v[204:207], v[160:163], v[16:31]
  ds_read_b64_tr_b16 v[144:145], v212 offset:32768
  ds_read_b64_tr_b16 v[146:147], v212 offset:33792
  ds_read_b128 v[184:187], v14 offset:2080
  s_waitcnt lgkmcnt(7)
  s_waitcnt vmcnt(9)
  v_fma_mix_f32 v192, v112, v176, v180 op_sel:[0,0,0] op_sel_hi:[1,1,1]
  v_fma_mix_f32 v193, v112, v176, v180 op_sel:[1,1,1] op_sel_hi:[1,1,1]
  v_fma_mix_f32 v194, v113, v177, v181 op_sel:[0,0,0] op_sel_hi:[1,1,1]
  v_mfma_f32_32x32x16_bf16 v[32:47], v[204:207], v[164:167], v[32:47]
  ds_read_b64_tr_b16 v[148:149], v213 offset:32768
  ds_read_b64_tr_b16 v[150:151], v213 offset:33792
  ds_read_b128 v[188:191], v14 offset:800
  v_fma_mix_f32 v195, v113, v177, v181 op_sel:[1,1,1] op_sel_hi:[1,1,1]
  v_fma_mix_f32 v196, v114, v178, v182 op_sel:[0,0,0] op_sel_hi:[1,1,1]
  v_fma_mix_f32 v197, v114, v178, v182 op_sel:[1,1,1] op_sel_hi:[1,1,1]
  s_waitcnt lgkmcnt(8)
  v_mfma_f32_32x32x16_bf16 v[48:63], v[204:207], v[168:171], v[48:63]
  ds_read_b64_tr_b16 v[152:153], v214 offset:32768
  ds_read_b64_tr_b16 v[154:155], v214 offset:33792
  v_fma_mix_f32 v198, v115, v179, v183 op_sel:[0,0,0] op_sel_hi:[1,1,1]
  v_fma_mix_f32 v199, v115, v179, v183 op_sel:[1,1,1] op_sel_hi:[1,1,1]
  v_cvt_pk_bf16_f32 v200, v192, v193
  v_cvt_pk_bf16_f32 v201, v194, v195
  s_waitcnt lgkmcnt(8)
  v_mfma_f32_32x32x16_bf16 v[64:79], v[204:207], v[172:175], v[64:79]
  ds_read_b64_tr_b16 v[156:157], v215 offset:32768
  ds_read_b64_tr_b16 v[158:159], v215 offset:33792
  v_cvt_pk_bf16_f32 v202, v196, v197
  v_cvt_pk_bf16_f32 v203, v198, v199
  buffer_load_dwordx4 v[88:91], v5, s[8:11], s55 offen offset:2048 sc1
  s_waitcnt lgkmcnt(8)
  v_mfma_f32_32x32x16_bf16 v[16:31], v[200:203], v[144:147], v[16:31]
  ds_read_b64_tr_b16 v[160:161], v212 offset:36864
  ds_read_b64_tr_b16 v[162:163], v212 offset:37888
  ds_read_b128 v[176:179], v14 offset:2112
  s_waitcnt lgkmcnt(7)
  s_waitcnt vmcnt(9)
  v_fma_mix_f32 v192, v116, v184, v188 op_sel:[0,0,0] op_sel_hi:[1,1,1]
  v_fma_mix_f32 v193, v116, v184, v188 op_sel:[1,1,1] op_sel_hi:[1,1,1]
  v_fma_mix_f32 v194, v117, v185, v189 op_sel:[0,0,0] op_sel_hi:[1,1,1]
  v_mfma_f32_32x32x16_bf16 v[32:47], v[200:203], v[148:151], v[32:47]
  ds_read_b64_tr_b16 v[164:165], v213 offset:36864
  ds_read_b64_tr_b16 v[166:167], v213 offset:37888
  ds_read_b128 v[180:183], v14 offset:832
  v_fma_mix_f32 v195, v117, v185, v189 op_sel:[1,1,1] op_sel_hi:[1,1,1]
  v_fma_mix_f32 v196, v118, v186, v190 op_sel:[0,0,0] op_sel_hi:[1,1,1]
  v_fma_mix_f32 v197, v118, v186, v190 op_sel:[1,1,1] op_sel_hi:[1,1,1]
  s_waitcnt lgkmcnt(8)
  v_mfma_f32_32x32x16_bf16 v[48:63], v[200:203], v[152:155], v[48:63]
  ds_read_b64_tr_b16 v[168:169], v214 offset:36864
  ds_read_b64_tr_b16 v[170:171], v214 offset:37888
  v_fma_mix_f32 v198, v119, v187, v191 op_sel:[0,0,0] op_sel_hi:[1,1,1]
  v_fma_mix_f32 v199, v119, v187, v191 op_sel:[1,1,1] op_sel_hi:[1,1,1]
  v_cvt_pk_bf16_f32 v204, v192, v193
  v_cvt_pk_bf16_f32 v205, v194, v195
  s_waitcnt lgkmcnt(8)
  v_mfma_f32_32x32x16_bf16 v[64:79], v[200:203], v[156:159], v[64:79]
  ds_read_b64_tr_b16 v[172:173], v215 offset:36864
  ds_read_b64_tr_b16 v[174:175], v215 offset:37888
  v_cvt_pk_bf16_f32 v206, v196, v197
  v_cvt_pk_bf16_f32 v207, v198, v199
  buffer_load_dwordx4 v[92:95], v5, s[8:11], s55 offen offset:3072 sc1
  s_waitcnt lgkmcnt(8)
  v_mfma_f32_32x32x16_bf16 v[16:31], v[204:207], v[160:163], v[16:31]
  ds_read_b64_tr_b16 v[144:145], v212 offset:40960
  ds_read_b64_tr_b16 v[146:147], v212 offset:41984
  ds_read_b128 v[184:187], v14 offset:2144
  s_waitcnt lgkmcnt(7)
  s_waitcnt vmcnt(9)
  v_fma_mix_f32 v192, v120, v176, v180 op_sel:[0,0,0] op_sel_hi:[1,1,1]
  v_fma_mix_f32 v193, v120, v176, v180 op_sel:[1,1,1] op_sel_hi:[1,1,1]
  v_fma_mix_f32 v194, v121, v177, v181 op_sel:[0,0,0] op_sel_hi:[1,1,1]
  v_mfma_f32_32x32x16_bf16 v[32:47], v[204:207], v[164:167], v[32:47]
  ds_read_b64_tr_b16 v[148:149], v213 offset:40960
  ds_read_b64_tr_b16 v[150:151], v213 offset:41984
  ds_read_b128 v[188:191], v14 offset:864
  v_fma_mix_f32 v195, v121, v177, v181 op_sel:[1,1,1] op_sel_hi:[1,1,1]
  v_fma_mix_f32 v196, v122, v178, v182 op_sel:[0,0,0] op_sel_hi:[1,1,1]
  v_fma_mix_f32 v197, v122, v178, v182 op_sel:[1,1,1] op_sel_hi:[1,1,1]
  s_waitcnt lgkmcnt(8)
  v_mfma_f32_32x32x16_bf16 v[48:63], v[204:207], v[168:171], v[48:63]
  ds_read_b64_tr_b16 v[152:153], v214 offset:40960
  ds_read_b64_tr_b16 v[154:155], v214 offset:41984
  v_fma_mix_f32 v198, v123, v179, v183 op_sel:[0,0,0] op_sel_hi:[1,1,1]
  v_fma_mix_f32 v199, v123, v179, v183 op_sel:[1,1,1] op_sel_hi:[1,1,1]
  v_cvt_pk_bf16_f32 v200, v192, v193
  v_cvt_pk_bf16_f32 v201, v194, v195
  s_waitcnt lgkmcnt(8)
  v_mfma_f32_32x32x16_bf16 v[64:79], v[204:207], v[172:175], v[64:79]
  ds_read_b64_tr_b16 v[156:157], v215 offset:40960
  ds_read_b64_tr_b16 v[158:159], v215 offset:41984
  v_cvt_pk_bf16_f32 v202, v196, v197
  v_cvt_pk_bf16_f32 v203, v198, v199
  s_add_u32 s55, s54, 36864
  buffer_load_dwordx4 v[96:99], v5, s[8:11], s55 offen offset:0 sc1
  s_waitcnt lgkmcnt(8)
  v_mfma_f32_32x32x16_bf16 v[16:31], v[200:203], v[144:147], v[16:31]
  ds_read_b64_tr_b16 v[160:161], v212 offset:45056
  ds_read_b64_tr_b16 v[162:163], v212 offset:46080
  ds_read_b128 v[176:179], v14 offset:2176
  s_waitcnt lgkmcnt(7)
  s_waitcnt vmcnt(9)
  v_fma_mix_f32 v192, v124, v184, v188 op_sel:[0,0,0] op_sel_hi:[1,1,1]
  v_fma_mix_f32 v193, v124, v184, v188 op_sel:[1,1,1] op_sel_hi:[1,1,1]
  v_fma_mix_f32 v194, v125, v185, v189 op_sel:[0,0,0] op_sel_hi:[1,1,1]
  v_mfma_f32_32x32x16_bf16 v[32:47], v[200:203], v[148:151], v[32:47]
  ds_read_b64_tr_b16 v[164:165], v213 offset:45056
  ds_read_b64_tr_b16 v[166:167], v213 offset:46080
  ds_read_b128 v[180:183], v14 offset:896
  v_fma_mix_f32 v195, v125, v185, v189 op_sel:[1,1,1] op_sel_hi:[1,1,1]
  v_fma_mix_f32 v196, v126, v186, v190 op_sel:[0,0,0] op_sel_hi:[1,1,1]
  v_fma_mix_f32 v197, v126, v186, v190 op_sel:[1,1,1] op_sel_hi:[1,1,1]
  s_waitcnt lgkmcnt(8)
  v_mfma_f32_32x32x16_bf16 v[48:63], v[200:203], v[152:155], v[48:63]
  ds_read_b64_tr_b16 v[168:169], v214 offset:45056
  ds_read_b64_tr_b16 v[170:171], v214 offset:46080
  v_fma_mix_f32 v198, v127, v187, v191 op_sel:[0,0,0] op_sel_hi:[1,1,1]
  v_fma_mix_f32 v199, v127, v187, v191 op_sel:[1,1,1] op_sel_hi:[1,1,1]
  v_cvt_pk_bf16_f32 v204, v192, v193
  v_cvt_pk_bf16_f32 v205, v194, v195
  s_waitcnt lgkmcnt(8)
  v_mfma_f32_32x32x16_bf16 v[64:79], v[200:203], v[156:159], v[64:79]
  ds_read_b64_tr_b16 v[172:173], v215 offset:45056
  ds_read_b64_tr_b16 v[174:175], v215 offset:46080
  v_cvt_pk_bf16_f32 v206, v196, v197
  v_cvt_pk_bf16_f32 v207, v198, v199
  buffer_load_dwordx4 v[100:103], v5, s[8:11], s55 offen offset:1024 sc1
  s_waitcnt lgkmcnt(8)
  v_mfma_f32_32x32x16_bf16 v[16:31], v[204:207], v[160:163], v[16:31]
  ds_read_b64_tr_b16 v[144:145], v212 offset:49152
  ds_read_b64_tr_b16 v[146:147], v212 offset:50176
  ds_read_b128 v[184:187], v14 offset:2208
  s_waitcnt lgkmcnt(7)
  s_waitcnt vmcnt(9)
  v_fma_mix_f32 v192, v128, v176, v180 op_sel:[0,0,0] op_sel_hi:[1,1,1]
  v_fma_mix_f32 v193, v128, v176, v180 op_sel:[1,1,1] op_sel_hi:[1,1,1]
  v_fma_mix_f32 v194, v129, v177, v181 op_sel:[0,0,0] op_sel_hi:[1,1,1]
  v_mfma_f32_32x32x16_bf16 v[32:47], v[204:207], v[164:167], v[32:47]
  ds_read_b64_tr_b16 v[148:149], v213 offset:49152
  ds_read_b64_tr_b16 v[150:151], v213 offset:50176
  ds_read_b128 v[188:191], v14 offset:928
  v_fma_mix_f32 v195, v129, v177, v181 op_sel:[1,1,1] op_sel_hi:[1,1,1]
  v_fma_mix_f32 v196, v130, v178, v182 op_sel:[0,0,0] op_sel_hi:[1,1,1]
  v_fma_mix_f32 v197, v130, v178, v182 op_sel:[1,1,1] op_sel_hi:[1,1,1]
  s_waitcnt lgkmcnt(8)
  v_mfma_f32_32x32x16_bf16 v[48:63], v[204:207], v[168:171], v[48:63]
  ds_read_b64_tr_b16 v[152:153], v214 offset:49152
  ds_read_b64_tr_b16 v[154:155], v214 offset:50176
  v_fma_mix_f32 v198, v131, v179, v183 op_sel:[0,0,0] op_sel_hi:[1,1,1]
  v_fma_mix_f32 v199, v131, v179, v183 op_sel:[1,1,1] op_sel_hi:[1,1,1]
  v_cvt_pk_bf16_f32 v200, v192, v193
  v_cvt_pk_bf16_f32 v201, v194, v195
  s_waitcnt lgkmcnt(8)
  v_mfma_f32_32x32x16_bf16 v[64:79], v[204:207], v[172:175], v[64:79]
  ds_read_b64_tr_b16 v[156:157], v215 offset:49152
  ds_read_b64_tr_b16 v[158:159], v215 offset:50176
  v_cvt_pk_bf16_f32 v202, v196, v197
  v_cvt_pk_bf16_f32 v203, v198, v199
  buffer_load_dwordx4 v[104:107], v5, s[8:11], s55 offen offset:2048 sc1
  s_waitcnt lgkmcnt(8)
  v_mfma_f32_32x32x16_bf16 v[16:31], v[200:203], v[144:147], v[16:31]
  ds_read_b64_tr_b16 v[160:161], v212 offset:53248
  ds_read_b64_tr_b16 v[162:163], v212 offset:54272
  ds_read_b128 v[176:179], v14 offset:2240
  s_waitcnt lgkmcnt(7)
  s_waitcnt vmcnt(9)
  v_fma_mix_f32 v192, v132, v184, v188 op_sel:[0,0,0] op_sel_hi:[1,1,1]
  v_fma_mix_f32 v193, v132, v184, v188 op_sel:[1,1,1] op_sel_hi:[1,1,1]
  v_fma_mix_f32 v194, v133, v185, v189 op_sel:[0,0,0] op_sel_hi:[1,1,1]
  v_mfma_f32_32x32x16_bf16 v[32:47], v[200:203], v[148:151], v[32:47]
  ds_read_b64_tr_b16 v[164:165], v213 offset:53248
  ds_read_b64_tr_b16 v[166:167], v213 offset:54272
  ds_read_b128 v[180:183], v14 offset:960
  v_fma_mix_f32 v195, v133, v185, v189 op_sel:[1,1,1] op_sel_hi:[1,1,1]
  v_fma_mix_f32 v196, v134, v186, v190 op_sel:[0,0,0] op_sel_hi:[1,1,1]
  v_fma_mix_f32 v197, v134, v186, v190 op_sel:[1,1,1] op_sel_hi:[1,1,1]
  s_waitcnt lgkmcnt(8)
  v_mfma_f32_32x32x16_bf16 v[48:63], v[200:203], v[152:155], v[48:63]
  ds_read_b64_tr_b16 v[168:169], v214 offset:53248
  ds_read_b64_tr_b16 v[170:171], v214 offset:54272
  v_fma_mix_f32 v198, v135, v187, v191 op_sel:[0,0,0] op_sel_hi:[1,1,1]
  v_fma_mix_f32 v199, v135, v187, v191 op_sel:[1,1,1] op_sel_hi:[1,1,1]
  v_cvt_pk_bf16_f32 v204, v192, v193
  v_cvt_pk_bf16_f32 v205, v194, v195
  s_waitcnt lgkmcnt(8)
  v_mfma_f32_32x32x16_bf16 v[64:79], v[200:203], v[156:159], v[64:79]
  ds_read_b64_tr_b16 v[172:173], v215 offset:53248
  ds_read_b64_tr_b16 v[174:175], v215 offset:54272
  v_cvt_pk_bf16_f32 v206, v196, v197
  v_cvt_pk_bf16_f32 v207, v198, v199
  buffer_load_dwordx4 v[108:111], v5, s[8:11], s55 offen offset:3072 sc1
  s_waitcnt lgkmcnt(8)
  v_mfma_f32_32x32x16_bf16 v[16:31], v[204:207], v[160:163], v[16:31]
  ds_read_b64_tr_b16 v[144:145], v212 offset:57344
  ds_read_b64_tr_b16 v[146:147], v212 offset:58368
  ds_read_b128 v[184:187], v14 offset:2272
  s_waitcnt lgkmcnt(7)
  s_waitcnt vmcnt(9)
  v_fma_mix_f32 v192, v136, v176, v180 op_sel:[0,0,0] op_sel_hi:[1,1,1]
  v_fma_mix_f32 v193, v136, v176, v180 op_sel:[1,1,1] op_sel_hi:[1,1,1]
  v_fma_mix_f32 v194, v137, v177, v181 op_sel:[0,0,0] op_sel_hi:[1,1,1]
  v_mfma_f32_32x32x16_bf16 v[32:47], v[204:207], v[164:167], v[32:47]
  ds_read_b64_tr_b16 v[148:149], v213 offset:57344
  ds_read_b64_tr_b16 v[150:151], v213 offset:58368
  ds_read_b128 v[188:191], v14 offset:992
  v_fma_mix_f32 v195, v137, v177, v181 op_sel:[1,1,1] op_sel_hi:[1,1,1]
  v_fma_mix_f32 v196, v138, v178, v182 op_sel:[0,0,0] op_sel_hi:[1,1,1]
  v_fma_mix_f32 v197, v138, v178, v182 op_sel:[1,1,1] op_sel_hi:[1,1,1]
  s_waitcnt lgkmcnt(8)
  v_mfma_f32_32x32x16_bf16 v[48:63], v[204:207], v[168:171], v[48:63]
  ds_read_b64_tr_b16 v[152:153], v214 offset:57344
  ds_read_b64_tr_b16 v[154:155], v214 offset:58368
  v_fma_mix_f32 v198, v139, v179, v183 op_sel:[0,0,0] op_sel_hi:[1,1,1]
  v_fma_mix_f32 v199, v139, v179, v183 op_sel:[1,1,1] op_sel_hi:[1,1,1]
  v_cvt_pk_bf16_f32 v200, v192, v193
  v_cvt_pk_bf16_f32 v201, v194, v195
  s_waitcnt lgkmcnt(8)
  v_mfma_f32_32x32x16_bf16 v[64:79], v[204:207], v[172:175], v[64:79]
  ds_read_b64_tr_b16 v[156:157], v215 offset:57344
  ds_read_b64_tr_b16 v[158:159], v215 offset:58368
  v_cvt_pk_bf16_f32 v202, v196, v197
  v_cvt_pk_bf16_f32 v203, v198, v199
  s_waitcnt lgkmcnt(8)
  s_nop 0
  v_mfma_f32_32x32x16_bf16 v[16:31], v[200:203], v[144:147], v[16:31]
  ds_read_b64_tr_b16 v[160:161], v212 offset:61440
  ds_read_b64_tr_b16 v[162:163], v212 offset:62464
  ds_read_b128 v[176:179], v14 offset:2304
  s_waitcnt lgkmcnt(7)
  s_waitcnt vmcnt(8)
  v_fma_mix_f32 v192, v140, v184, v188 op_sel:[0,0,0] op_sel_hi:[1,1,1]
  v_fma_mix_f32 v193, v140, v184, v188 op_sel:[1,1,1] op_sel_hi:[1,1,1]
  v_fma_mix_f32 v194, v141, v185, v189 op_sel:[0,0,0] op_sel_hi:[1,1,1]
  v_mfma_f32_32x32x16_bf16 v[32:47], v[200:203], v[148:151], v[32:47]
  ds_read_b64_tr_b16 v[164:165], v213 offset:61440
  ds_read_b64_tr_b16 v[166:167], v213 offset:62464
  ds_read_b128 v[180:183], v14 offset:1024
  v_fma_mix_f32 v195, v141, v185, v189 op_sel:[1,1,1] op_sel_hi:[1,1,1]
  v_fma_mix_f32 v196, v142, v186, v190 op_sel:[0,0,0] op_sel_hi:[1,1,1]
  v_fma_mix_f32 v197, v142, v186, v190 op_sel:[1,1,1] op_sel_hi:[1,1,1]
  s_waitcnt lgkmcnt(8)
  v_mfma_f32_32x32x16_bf16 v[48:63], v[200:203], v[152:155], v[48:63]
  ds_read_b64_tr_b16 v[168:169], v214 offset:61440
  ds_read_b64_tr_b16 v[170:171], v214 offset:62464
  v_fma_mix_f32 v198, v143, v187, v191 op_sel:[0,0,0] op_sel_hi:[1,1,1]
  v_fma_mix_f32 v199, v143, v187, v191 op_sel:[1,1,1] op_sel_hi:[1,1,1]
  v_cvt_pk_bf16_f32 v204, v192, v193
  v_cvt_pk_bf16_f32 v205, v194, v195
  s_waitcnt lgkmcnt(8)
  v_mfma_f32_32x32x16_bf16 v[64:79], v[200:203], v[156:159], v[64:79]
  ds_read_b64_tr_b16 v[172:173], v215 offset:61440
  ds_read_b64_tr_b16 v[174:175], v215 offset:62464
  v_cvt_pk_bf16_f32 v206, v196, v197
  v_cvt_pk_bf16_f32 v207, v198, v199
  s_waitcnt lgkmcnt(8)
  s_nop 0
  v_mfma_f32_32x32x16_bf16 v[16:31], v[204:207], v[160:163], v[16:31]
  ds_read_b64_tr_b16 v[144:145], v216 offset:0
  ds_read_b64_tr_b16 v[146:147], v216 offset:1024
  ds_read_b128 v[184:187], v14 offset:2336
  s_waitcnt lgkmcnt(7)
  s_waitcnt vmcnt(7)
  v_fma_mix_f32 v192, v80, v176, v180 op_sel:[0,0,0] op_sel_hi:[1,1,1]
  v_fma_mix_f32 v193, v80, v176, v180 op_sel:[1,1,1] op_sel_hi:[1,1,1]
  v_fma_mix_f32 v194, v81, v177, v181 op_sel:[0,0,0] op_sel_hi:[1,1,1]
  v_mfma_f32_32x32x16_bf16 v[32:47], v[204:207], v[164:167], v[32:47]
  ds_read_b64_tr_b16 v[148:149], v217 offset:0
  ds_read_b64_tr_b16 v[150:151], v217 offset:1024
  ds_read_b128 v[188:191], v14 offset:1056
  v_fma_mix_f32 v195, v81, v177, v181 op_sel:[1,1,1] op_sel_hi:[1,1,1]
  v_fma_mix_f32 v196, v82, v178, v182 op_sel:[0,0,0] op_sel_hi:[1,1,1]
  v_fma_mix_f32 v197, v82, v178, v182 op_sel:[1,1,1] op_sel_hi:[1,1,1]
  s_waitcnt lgkmcnt(8)
  v_mfma_f32_32x32x16_bf16 v[48:63], v[204:207], v[168:171], v[48:63]
  ds_read_b64_tr_b16 v[152:153], v218 offset:0
  ds_read_b64_tr_b16 v[154:155], v218 offset:1024
  v_fma_mix_f32 v198, v83, v179, v183 op_sel:[0,0,0] op_sel_hi:[1,1,1]
  v_fma_mix_f32 v199, v83, v179, v183 op_sel:[1,1,1] op_sel_hi:[1,1,1]
  v_cvt_pk_bf16_f32 v200, v192, v193
  v_cvt_pk_bf16_f32 v201, v194, v195
  s_waitcnt lgkmcnt(8)
  v_mfma_f32_32x32x16_bf16 v[64:79], v[204:207], v[172:175], v[64:79]
  ds_read_b64_tr_b16 v[156:157], v219 offset:0
  ds_read_b64_tr_b16 v[158:159], v219 offset:1024
  v_cvt_pk_bf16_f32 v202, v196, v197
  v_cvt_pk_bf16_f32 v203, v198, v199
  s_waitcnt lgkmcnt(8)
  s_nop 0
  v_mfma_f32_32x32x16_bf16 v[16:31], v[200:203], v[144:147], v[16:31]
  ds_read_b64_tr_b16 v[160:161], v216 offset:4096
  ds_read_b64_tr_b16 v[162:163], v216 offset:5120
  ds_read_b128 v[176:179], v14 offset:2368
  s_waitcnt lgkmcnt(7)
  s_waitcnt vmcnt(6)
  v_fma_mix_f32 v192, v84, v184, v188 op_sel:[0,0,0] op_sel_hi:[1,1,1]
  v_fma_mix_f32 v193, v84, v184, v188 op_sel:[1,1,1] op_sel_hi:[1,1,1]
  v_fma_mix_f32 v194, v85, v185, v189 op_sel:[0,0,0] op_sel_hi:[1,1,1]
  v_mfma_f32_32x32x16_bf16 v[32:47], v[200:203], v[148:151], v[32:47]
  ds_read_b64_tr_b16 v[164:165], v217 offset:4096
  ds_read_b64_tr_b16 v[166:167], v217 offset:5120
  ds_read_b128 v[180:183], v14 offset:1088
  v_fma_mix_f32 v195, v85, v185, v189 op_sel:[1,1,1] op_sel_hi:[1,1,1]
  v_fma_mix_f32 v196, v86, v186, v190 op_sel:[0,0,0] op_sel_hi:[1,1,1]
  v_fma_mix_f32 v197, v86, v186, v190 op_sel:[1,1,1] op_sel_hi:[1,1,1]
  s_waitcnt lgkmcnt(8)
  v_mfma_f32_32x32x16_bf16 v[48:63], v[200:203], v[152:155], v[48:63]
  ds_read_b64_tr_b16 v[168:169], v218 offset:4096
  ds_read_b64_tr_b16 v[170:171], v218 offset:5120
  v_fma_mix_f32 v198, v87, v187, v191 op_sel:[0,0,0] op_sel_hi:[1,1,1]
  v_fma_mix_f32 v199, v87, v187, v191 op_sel:[1,1,1] op_sel_hi:[1,1,1]
  v_cvt_pk_bf16_f32 v204, v192, v193
  v_cvt_pk_bf16_f32 v205, v194, v195
  s_waitcnt lgkmcnt(8)
  v_mfma_f32_32x32x16_bf16 v[64:79], v[200:203], v[156:159], v[64:79]
  ds_read_b64_tr_b16 v[172:173], v219 offset:4096
  ds_read_b64_tr_b16 v[174:175], v219 offset:5120
  v_cvt_pk_bf16_f32 v206, v196, v197
  v_cvt_pk_bf16_f32 v207, v198, v199
  s_waitcnt lgkmcnt(8)
  s_nop 0
  v_mfma_f32_32x32x16_bf16 v[16:31], v[204:207], v[160:163], v[16:31]
  ds_read_b64_tr_b16 v[144:145], v216 offset:8192
  ds_read_b64_tr_b16 v[146:147], v216 offset:9216
  ds_read_b128 v[184:187], v14 offset:2400
  s_waitcnt lgkmcnt(7)
  s_waitcnt vmcnt(5)
  v_fma_mix_f32 v192, v88, v176, v180 op_sel:[0,0,0] op_sel_hi:[1,1,1]
  v_fma_mix_f32 v193, v88, v176, v180 op_sel:[1,1,1] op_sel_hi:[1,1,1]
  v_fma_mix_f32 v194, v89, v177, v181 op_sel:[0,0,0] op_sel_hi:[1,1,1]
  v_mfma_f32_32x32x16_bf16 v[32:47], v[204:207], v[164:167], v[32:47]
  ds_read_b64_tr_b16 v[148:149], v217 offset:8192
  ds_read_b64_tr_b16 v[150:151], v217 offset:9216
  ds_read_b128 v[188:191], v14 offset:1120
  v_fma_mix_f32 v195, v89, v177, v181 op_sel:[1,1,1] op_sel_hi:[1,1,1]
  v_fma_mix_f32 v196, v90, v178, v182 op_sel:[0,0,0] op_sel_hi:[1,1,1]
  v_fma_mix_f32 v197, v90, v178, v182 op_sel:[1,1,1] op_sel_hi:[1,1,1]
  s_waitcnt lgkmcnt(8)
  v_mfma_f32_32x32x16_bf16 v[48:63], v[204:207], v[168:171], v[48:63]
  ds_read_b64_tr_b16 v[152:153], v218 offset:8192
  ds_read_b64_tr_b16 v[154:155], v218 offset:9216
  v_fma_mix_f32 v198, v91, v179, v183 op_sel:[0,0,0] op_sel_hi:[1,1,1]
  v_fma_mix_f32 v199, v91, v179, v183 op_sel:[1,1,1] op_sel_hi:[1,1,1]
  v_cvt_pk_bf16_f32 v200, v192, v193
  v_cvt_pk_bf16_f32 v201, v194, v195
  s_waitcnt lgkmcnt(8)
  v_mfma_f32_32x32x16_bf16 v[64:79], v[204:207], v[172:175], v[64:79]
  ds_read_b64_tr_b16 v[156:157], v219 offset:8192
  ds_read_b64_tr_b16 v[158:159], v219 offset:9216
  v_cvt_pk_bf16_f32 v202, v196, v197
  v_cvt_pk_bf16_f32 v203, v198, v199
  s_waitcnt lgkmcnt(8)
  s_nop 0
  v_mfma_f32_32x32x16_bf16 v[16:31], v[200:203], v[144:147], v[16:31]
  s_barrier
  ds_read_b64_tr_b16 v[160:161], v208 offset:0
  ds_read_b64_tr_b16 v[162:163], v208 offset:1024
  ds_read_b128 v[176:179], v14 offset:2432
  s_waitcnt lgkmcnt(7)
  s_waitcnt vmcnt(4)
  v_fma_mix_f32 v192, v92, v184, v188 op_sel:[0,0,0] op_sel_hi:[1,1,1]
  v_fma_mix_f32 v193, v92, v184, v188 op_sel:[1,1,1] op_sel_hi:[1,1,1]
  v_fma_mix_f32 v194, v93, v185, v189 op_sel:[0,0,0] op_sel_hi:[1,1,1]
  v_mfma_f32_32x32x16_bf16 v[32:47], v[200:203], v[148:151], v[32:47]
  ds_read_b64_tr_b16 v[164:165], v209 offset:0
  ds_read_b64_tr_b16 v[166:167], v209 offset:1024
  ds_read_b128 v[180:183], v14 offset:1152
  v_fma_mix_f32 v195, v93, v185, v189 op_sel:[1,1,1] op_sel_hi:[1,1,1]
  v_fma_mix_f32 v196, v94, v186, v190 op_sel:[0,0,0] op_sel_hi:[1,1,1]
  v_fma_mix_f32 v197, v94, v186, v190 op_sel:[1,1,1] op_sel_hi:[1,1,1]
  s_waitcnt lgkmcnt(8)
  v_mfma_f32_32x32x16_bf16 v[48:63], v[200:203], v[152:155], v[48:63]
  ds_read_b64_tr_b16 v[168:169], v210 offset:0
  ds_read_b64_tr_b16 v[170:171], v210 offset:1024
  v_fma_mix_f32 v198, v95, v187, v191 op_sel:[0,0,0] op_sel_hi:[1,1,1]
  v_fma_mix_f32 v199, v95, v187, v191 op_sel:[1,1,1] op_sel_hi:[1,1,1]
  v_cvt_pk_bf16_f32 v204, v192, v193
  v_cvt_pk_bf16_f32 v205, v194, v195
  s_waitcnt lgkmcnt(8)
  v_mfma_f32_32x32x16_bf16 v[64:79], v[200:203], v[156:159], v[64:79]
  ds_read_b64_tr_b16 v[172:173], v211 offset:0
  ds_read_b64_tr_b16 v[174:175], v211 offset:1024
  v_cvt_pk_bf16_f32 v206, v196, v197
  v_cvt_pk_bf16_f32 v207, v198, v199
  s_waitcnt lgkmcnt(8)
  s_nop 0
  v_mfma_f32_32x32x16_bf16 v[16:31], v[204:207], v[160:163], v[16:31]
  ds_read_b64_tr_b16 v[144:145], v208 offset:4096
  ds_read_b64_tr_b16 v[146:147], v208 offset:5120
  ds_read_b128 v[184:187], v14 offset:2464
  s_waitcnt lgkmcnt(7)
  s_waitcnt vmcnt(3)
  v_fma_mix_f32 v192, v96, v176, v180 op_sel:[0,0,0] op_sel_hi:[1,1,1]
  v_fma_mix_f32 v193, v96, v176, v180 op_sel:[1,1,1] op_sel_hi:[1,1,1]
  v_fma_mix_f32 v194, v97, v177, v181 op_sel:[0,0,0] op_sel_hi:[1,1,1]
  v_mfma_f32_32x32x16_bf16 v[32:47], v[204:207], v[164:167], v[32:47]
  ds_read_b64_tr_b16 v[148:149], v209 offset:4096
  ds_read_b64_tr_b16 v[150:151], v209 offset:5120
  ds_read_b128 v[188:191], v14 offset:1184
  v_fma_mix_f32 v195, v97, v177, v181 op_sel:[1,1,1] op_sel_hi:[1,1,1]
  v_fma_mix_f32 v196, v98, v178, v182 op_sel:[0,0,0] op_sel_hi:[1,1,1]
  v_fma_mix_f32 v197, v98, v178, v182 op_sel:[1,1,1] op_sel_hi:[1,1,1]
  s_waitcnt lgkmcnt(8)
  v_mfma_f32_32x32x16_bf16 v[48:63], v[204:207], v[168:171], v[48:63]
  ds_read_b64_tr_b16 v[152:153], v210 offset:4096
  ds_read_b64_tr_b16 v[154:155], v210 offset:5120
  v_fma_mix_f32 v198, v99, v179, v183 op_sel:[0,0,0] op_sel_hi:[1,1,1]
  v_fma_mix_f32 v199, v99, v179, v183 op_sel:[1,1,1] op_sel_hi:[1,1,1]
  v_cvt_pk_bf16_f32 v200, v192, v193
  v_cvt_pk_bf16_f32 v201, v194, v195
  s_waitcnt lgkmcnt(8)
  v_mfma_f32_32x32x16_bf16 v[64:79], v[204:207], v[172:175], v[64:79]
  ds_read_b64_tr_b16 v[156:157], v211 offset:4096
  ds_read_b64_tr_b16 v[158:159], v211 offset:5120
  v_cvt_pk_bf16_f32 v202, v196, v197
  v_cvt_pk_bf16_f32 v203, v198, v199
  s_waitcnt lgkmcnt(8)
  s_nop 0
  v_mfma_f32_32x32x16_bf16 v[16:31], v[200:203], v[144:147], v[16:31]
  ds_read_b64_tr_b16 v[160:161], v208 offset:8192
  ds_read_b64_tr_b16 v[162:163], v208 offset:9216
  ds_read_b128 v[176:179], v14 offset:2496
  s_waitcnt lgkmcnt(7)
  s_waitcnt vmcnt(2)
  v_fma_mix_f32 v192, v100, v184, v188 op_sel:[0,0,0] op_sel_hi:[1,1,1]
  v_fma_mix_f32 v193, v100, v184, v188 op_sel:[1,1,1] op_sel_hi:[1,1,1]
  v_fma_mix_f32 v194, v101, v185, v189 op_sel:[0,0,0] op_sel_hi:[1,1,1]
  v_mfma_f32_32x32x16_bf16 v[32:47], v[200:203], v[148:151], v[32:47]
  ds_read_b64_tr_b16 v[164:165], v209 offset:8192
  ds_read_b64_tr_b16 v[166:167], v209 offset:9216
  ds_read_b128 v[180:183], v14 offset:1216
  v_fma_mix_f32 v195, v101, v185, v189 op_sel:[1,1,1] op_sel_hi:[1,1,1]
  v_fma_mix_f32 v196, v102, v186, v190 op_sel:[0,0,0] op_sel_hi:[1,1,1]
  v_fma_mix_f32 v197, v102, v186, v190 op_sel:[1,1,1] op_sel_hi:[1,1,1]
  s_waitcnt lgkmcnt(8)
  v_mfma_f32_32x32x16_bf16 v[48:63], v[200:203], v[152:155], v[48:63]
  ds_read_b64_tr_b16 v[168:169], v210 offset:8192
  ds_read_b64_tr_b16 v[170:171], v210 offset:9216
  v_fma_mix_f32 v198, v103, v187, v191 op_sel:[0,0,0] op_sel_hi:[1,1,1]
  v_fma_mix_f32 v199, v103, v187, v191 op_sel:[1,1,1] op_sel_hi:[1,1,1]
  v_cvt_pk_bf16_f32 v204, v192, v193
  v_cvt_pk_bf16_f32 v205, v194, v195
  s_waitcnt lgkmcnt(8)
  v_mfma_f32_32x32x16_bf16 v[64:79], v[200:203], v[156:159], v[64:79]
  ds_read_b64_tr_b16 v[172:173], v211 offset:8192
  ds_read_b64_tr_b16 v[174:175], v211 offset:9216
  v_cvt_pk_bf16_f32 v206, v196, v197
  v_cvt_pk_bf16_f32 v207, v198, v199
  s_waitcnt lgkmcnt(8)
  s_nop 0
  v_mfma_f32_32x32x16_bf16 v[16:31], v[204:207], v[160:163], v[16:31]
  ds_read_b64_tr_b16 v[144:145], v208 offset:12288
  ds_read_b64_tr_b16 v[146:147], v208 offset:13312
  ds_read_b128 v[184:187], v14 offset:2528
  s_waitcnt lgkmcnt(7)
  s_waitcnt vmcnt(1)
  v_fma_mix_f32 v192, v104, v176, v180 op_sel:[0,0,0] op_sel_hi:[1,1,1]
  v_fma_mix_f32 v193, v104, v176, v180 op_sel:[1,1,1] op_sel_hi:[1,1,1]
  v_fma_mix_f32 v194, v105, v177, v181 op_sel:[0,0,0] op_sel_hi:[1,1,1]
  v_mfma_f32_32x32x16_bf16 v[32:47], v[204:207], v[164:167], v[32:47]
  ds_read_b64_tr_b16 v[148:149], v209 offset:12288
  ds_read_b64_tr_b16 v[150:151], v209 offset:13312
  ds_read_b128 v[188:191], v14 offset:1248
  v_fma_mix_f32 v195, v105, v177, v181 op_sel:[1,1,1] op_sel_hi:[1,1,1]
  v_fma_mix_f32 v196, v106, v178, v182 op_sel:[0,0,0] op_sel_hi:[1,1,1]
  v_fma_mix_f32 v197, v106, v178, v182 op_sel:[1,1,1] op_sel_hi:[1,1,1]
  s_waitcnt lgkmcnt(8)
  v_mfma_f32_32x32x16_bf16 v[48:63], v[204:207], v[168:171], v[48:63]
  ds_read_b64_tr_b16 v[152:153], v210 offset:12288
  ds_read_b64_tr_b16 v[154:155], v210 offset:13312
  v_fma_mix_f32 v198, v107, v179, v183 op_sel:[0,0,0] op_sel_hi:[1,1,1]
  v_fma_mix_f32 v199, v107, v179, v183 op_sel:[1,1,1] op_sel_hi:[1,1,1]
  v_cvt_pk_bf16_f32 v200, v192, v193
  v_cvt_pk_bf16_f32 v201, v194, v195
  s_waitcnt lgkmcnt(8)
  v_mfma_f32_32x32x16_bf16 v[64:79], v[204:207], v[172:175], v[64:79]
  ds_read_b64_tr_b16 v[156:157], v211 offset:12288
  ds_read_b64_tr_b16 v[158:159], v211 offset:13312
  v_cvt_pk_bf16_f32 v202, v196, v197
  v_cvt_pk_bf16_f32 v203, v198, v199
  s_waitcnt lgkmcnt(8)
  s_nop 0
  v_mfma_f32_32x32x16_bf16 v[16:31], v[200:203], v[144:147], v[16:31]
  ds_read_b64_tr_b16 v[160:161], v208 offset:16384
  ds_read_b64_tr_b16 v[162:163], v208 offset:17408
  s_waitcnt lgkmcnt(6)
  s_waitcnt vmcnt(0)
  v_fma_mix_f32 v192, v108, v184, v188 op_sel:[0,0,0] op_sel_hi:[1,1,1]
  v_fma_mix_f32 v193, v108, v184, v188 op_sel:[1,1,1] op_sel_hi:[1,1,1]
  v_fma_mix_f32 v194, v109, v185, v189 op_sel:[0,0,0] op_sel_hi:[1,1,1]
  v_mfma_f32_32x32x16_bf16 v[32:47], v[200:203], v[148:151], v[32:47]
  ds_read_b64_tr_b16 v[164:165], v209 offset:16384
  ds_read_b64_tr_b16 v[166:167], v209 offset:17408
  v_fma_mix_f32 v195, v109, v185, v189 op_sel:[1,1,1] op_sel_hi:[1,1,1]
  v_fma_mix_f32 v196, v110, v186, v190 op_sel:[0,0,0] op_sel_hi:[1,1,1]
  v_fma_mix_f32 v197, v110, v186, v190 op_sel:[1,1,1] op_sel_hi:[1,1,1]
  s_waitcnt lgkmcnt(6)
  v_mfma_f32_32x32x16_bf16 v[48:63], v[200:203], v[152:155], v[48:63]
  ds_read_b64_tr_b16 v[168:169], v210 offset:16384
  ds_read_b64_tr_b16 v[170:171], v210 offset:17408
  v_fma_mix_f32 v198, v111, v187, v191 op_sel:[0,0,0] op_sel_hi:[1,1,1]
  v_fma_mix_f32 v199, v111, v187, v191 op_sel:[1,1,1] op_sel_hi:[1,1,1]
  v_cvt_pk_bf16_f32 v204, v192, v193
  v_cvt_pk_bf16_f32 v205, v194, v195
  s_waitcnt lgkmcnt(6)
  v_mfma_f32_32x32x16_bf16 v[64:79], v[200:203], v[156:159], v[64:79]
  ds_read_b64_tr_b16 v[172:173], v211 offset:16384
  ds_read_b64_tr_b16 v[174:175], v211 offset:17408
  v_cvt_pk_bf16_f32 v206, v196, v197
  v_cvt_pk_bf16_f32 v207, v198, v199
  s_waitcnt lgkmcnt(6)
  s_nop 0
  v_mfma_f32_32x32x16_bf16 v[16:31], v[204:207], v[160:163], v[16:31]
  s_waitcnt lgkmcnt(4)
  v_mfma_f32_32x32x16_bf16 v[32:47], v[204:207], v[164:167], v[32:47]
  s_waitcnt lgkmcnt(2)
  v_mfma_f32_32x32x16_bf16 v[48:63], v[204:207], v[168:171], v[48:63]
  s_waitcnt lgkmcnt(0)
  v_mfma_f32_32x32x16_bf16 v[64:79], v[204:207], v[172:175], v[64:79]
  s_nop 5
  v_cvt_pk_bf16_f32 v80, v16, v17
  v_cvt_pk_bf16_f32 v81, v18, v19
  v_cvt_pk_bf16_f32 v82, v20, v21
  v_cvt_pk_bf16_f32 v83, v22, v23
  buffer_store_dwordx4 v[80:83], v220, s[8:11], s58 offen offset:0 sc0 sc1
  v_cvt_pk_bf16_f32 v84, v24, v25
  v_cvt_pk_bf16_f32 v85, v26, v27
  v_cvt_pk_bf16_f32 v86, v28, v29
  v_cvt_pk_bf16_f32 v87, v30, v31
  buffer_store_dwordx4 v[84:87], v220, s[8:11], s58 offen offset:640 sc0 sc1
  v_cvt_pk_bf16_f32 v88, v32, v33
  v_cvt_pk_bf16_f32 v89, v34, v35
  v_cvt_pk_bf16_f32 v90, v36, v37
  v_cvt_pk_bf16_f32 v91, v38, v39
  buffer_store_dwordx4 v[88:91], v221, s[8:11], s58 offen offset:0 sc0 sc1
  v_cvt_pk_bf16_f32 v92, v40, v41
  v_cvt_pk_bf16_f32 v93, v42, v43
  v_cvt_pk_bf16_f32 v94, v44, v45
  v_cvt_pk_bf16_f32 v95, v46, v47
  buffer_store_dwordx4 v[92:95], v221, s[8:11], s58 offen offset:640 sc0 sc1
  v_cvt_pk_bf16_f32 v96, v48, v49
  v_cvt_pk_bf16_f32 v97, v50, v51
  v_cvt_pk_bf16_f32 v98, v52, v53
  v_cvt_pk_bf16_f32 v99, v54, v55
  buffer_store_dwordx4 v[96:99], v222, s[8:11], s58 offen offset:0 sc0 sc1
  v_cvt_pk_bf16_f32 v100, v56, v57
  v_cvt_pk_bf16_f32 v101, v58, v59
  v_cvt_pk_bf16_f32 v102, v60, v61
  v_cvt_pk_bf16_f32 v103, v62, v63
  buffer_store_dwordx4 v[100:103], v222, s[8:11], s58 offen offset:640 sc0 sc1
  v_cvt_pk_bf16_f32 v104, v64, v65
  v_cvt_pk_bf16_f32 v105, v66, v67
  v_cvt_pk_bf16_f32 v106, v68, v69
  v_cvt_pk_bf16_f32 v107, v70, v71
  buffer_store_dwordx4 v[104:107], v223, s[8:11], s58 offen offset:0 sc0 sc1
  v_cvt_pk_bf16_f32 v108, v72, v73
  v_cvt_pk_bf16_f32 v109, v74, v75
  v_cvt_pk_bf16_f32 v110, v76, v77
  v_cvt_pk_bf16_f32 v111, v78, v79
  buffer_store_dwordx4 v[108:111], v223, s[8:11], s58 offen offset:640 sc0 sc1
  s_branch adaLN_cond__mha_block__glu_gated_glu__prompt_p1done5
adaLN_cond__mha_block__glu_gated_glu__prompt_qidle13:
  s_barrier
  s_barrier
  s_barrier
  s_branch adaLN_cond__mha_block__glu_gated_glu__prompt_p1done5
adaLN_cond__mha_block__glu_gated_glu__prompt_prod014:
  s_cmp_lt_u32 s12, 6
  s_cbranch_scc1 adaLN_cond__mha_block__glu_gated_glu__prompt_lnw15
  s_cmp_eq_u32 s12, 7
  s_cbranch_scc1 adaLN_cond__mha_block__glu_gated_glu__prompt_w719
  s_mov_b32 s44, s18
  s_mov_b32 s45, s19
  s_mov_b32 s46, 0x258000
  s_mov_b32 s47, 0x20000
  v_lshlrev_b32 v146, 7, v1
  s_add_u32 s50, s2, 0
  s_lshl_b32 s50, s50, 13
  buffer_load_dword v150, v146, s[44:47], s50 offen
  s_add_u32 s50, s2, 256
  s_lshl_b32 s50, s50, 13
  buffer_load_dword v151, v146, s[44:47], s50 offen
  s_cmp_ge_u32 s14, 8
  s_cbranch_scc1 adaLN_cond__mha_block__glu_gated_glu__prompt_nopc21
  s_getpc_b64 s[48:49]
adaLN_cond__mha_block__glu_gated_glu__prompt_pc20:
  s_sub_u32 s48, s48, adaLN_cond__mha_block__glu_gated_glu__prompt_pc20-adaLN_cond__mha_block__glu_gated_glu__prompt_kernel
  s_subb_u32 s49, s49, 0
  s_lshl_b32 s50, s14, 13
  v_lshlrev_b32 v144, 7, v1
  v_add_u32 v144, s50, v144
  s_mov_b32 s50, CODE_END-adaLN_cond__mha_block__glu_gated_glu__prompt_kernel-4
  v_min_u32 v144, s50, v144
  global_load_dword v148, v144, s[48:49]
adaLN_cond__mha_block__glu_gated_glu__prompt_nopc21:
  s_waitcnt vmcnt(0)
  s_mov_b32 s44, s36
  s_mov_b32 s45, s37
  s_mov_b32 s46, 0x100
  s_mov_b32 s47, 0x20000
  v_mov_b32 v60, 0
  s_mov_b32 s50, 0
adaLN_cond__mha_block__glu_gated_glu__prompt_rdy22:
  buffer_load_dword v61, v60, s[44:47], 0 offen offset:4 sc1
  s_waitcnt vmcnt(0)
  v_readfirstlane_b32 s51, v61
  s_nop 3
  s_cmp_lg_u32 s51, 0
  s_cbranch_scc1 adaLN_cond__mha_block__glu_gated_glu__prompt_rdyd23
  s_add_u32 s50, s50, 1
  s_cmp_ge_u32 s50, 200000
  s_cbranch_scc1 adaLN_cond__mha_block__glu_gated_glu__prompt_rdyd23
  s_sleep 6
  s_branch adaLN_cond__mha_block__glu_gated_glu__prompt_rdy22
adaLN_cond__mha_block__glu_gated_glu__prompt_rdyd23:
  s_branch adaLN_cond__mha_block__glu_gated_glu__prompt_pj16
adaLN_cond__mha_block__glu_gated_glu__prompt_w719:
  v_lshlrev_b32 v146, 21, v1
  buffer_load_dword v150, v146, s[8:11], 0 offen sc1
  s_mov_b32 s44, s20
  s_mov_b32 s45, s21
  s_mov_b32 s46, 0xc8000
  s_mov_b32 s47, 0x20000
  buffer_load_dword v151, v146, s[44:47], 0 offen
  s_mov_b32 s44, s24
  s_mov_b32 s45, s25
  s_mov_b32 s46, 0x1e0000
  s_mov_b32 s47, 0x20000
  buffer_load_dword v152, v146, s[44:47], 0 offen
  s_mov_b32 s44, s26
  s_mov_b32 s45, s27
  s_mov_b32 s46, 0x1e0000
  s_mov_b32 s47, 0x20000
  buffer_load_dword v153, v146, s[44:47], 0 offen
  s_mov_b32 s44, s28
  s_mov_b32 s45, s29
  s_mov_b32 s46, 0x1e0000
  s_mov_b32 s47, 0x20000
  buffer_load_dword v154, v146, s[44:47], 0 offen
  s_branch adaLN_cond__mha_block__glu_gated_glu__prompt_pj16
adaLN_cond__mha_block__glu_gated_glu__prompt_lnw15:
  s_mov_b32 s40, s16
  s_mov_b32 s41, s17
  s_mov_b32 s42, 0x280000
  s_mov_b32 s43, 0x20000
  v_lshrrev_b32 v3, 4, v1
  v_and_b32 v4, 15, v1
  s_lshl_b32 s52, s2, 3
  s_sub_u32 s53, s12, 4
  s_lshl_b32 s53, s53, 2
  s_add_u32 s52, s52, s53
  v_add_u32 v6, s52, v3
  s_movk_i32 s54, 1280
  v_mul_u32_u24 v6, s54, v6
  v_lshl_add_u32 v6, v4, 4, v6
  buffer_load_dwordx4 v[8:11], v6, s[40:43], 0 offen offset:0 nt
  buffer_load_dwordx4 v[12:15], v6, s[40:43], 0 offen offset:256 nt
  buffer_load_dwordx4 v[16:19], v6, s[40:43], 0 offen offset:512 nt
  buffer_load_dwordx4 v[20:23], v6, s[40:43], 0 offen offset:768 nt
  buffer_load_dwordx4 v[24:27], v6, s[40:43], 0 offen offset:1024 nt
  v_mov_b32 v128, 0
  v_mov_b32 v129, 0
  v_mov_b32 v132, 0
  v_mov_b32 v133, 0
  s_waitcnt vmcnt(4)
  v_lshlrev_b32 v48, 16, v8
  v_and_b32 v49, 0xffff0000, v8
  v_lshlrev_b32 v50, 16, v9
  v_and_b32 v51, 0xffff0000, v9
  v_lshlrev_b32 v52, 16, v10
  v_and_b32 v53, 0xffff0000, v10
  v_lshlrev_b32 v54, 16, v11
  v_and_b32 v55, 0xffff0000, v11
  v_pk_add_f32 v[128:129], v[128:129], v[48:49]
  v_pk_add_f32 v[128:129], v[128:129], v[50:51]
  v_pk_add_f32 v[128:129], v[128:129], v[52:53]
  v_pk_add_f32 v[128:129], v[128:129], v[54:55]
  s_waitcnt vmcnt(3)
  v_lshlrev_b32 v56, 16, v12
  v_and_b32 v57, 0xffff0000, v12
  v_lshlrev_b32 v58, 16, v13
  v_and_b32 v59, 0xffff0000, v13
  v_lshlrev_b32 v60, 16, v14
  v_and_b32 v61, 0xffff0000, v14
  v_lshlrev_b32 v62, 16, v15
  v_and_b32 v63, 0xffff0000, v15
  v_pk_add_f32 v[128:129], v[128:129], v[56:57]
  v_pk_add_f32 v[128:129], v[128:129], v[58:59]
  v_pk_add_f32 v[128:129], v[128:129], v[60:61]
  v_pk_add_f32 v[128:129], v[128:129], v[62:63]
  s_waitcnt vmcnt(2)
  v_lshlrev_b32 v64, 16, v16
  v_and_b32 v65, 0xffff0000, v16
  v_lshlrev_b32 v66, 16, v17
  v_and_b32 v67, 0xffff0000, v17
  v_lshlrev_b32 v68, 16, v18
  v_and_b32 v69, 0xffff0000, v18
  v_lshlrev_b32 v70, 16, v19
  v_and_b32 v71, 0xffff0000, v19
  v_pk_add_f32 v[128:129], v[128:129], v[64:65]
  v_pk_add_f32 v[128:129], v[128:129], v[66:67]
  v_pk_add_f32 v[128:129], v[128:129], v[68:69]
  v_pk_add_f32 v[128:129], v[128:129], v[70:71]
  s_waitcnt vmcnt(1)
  v_lshlrev_b32 v72, 16, v20
  v_and_b32 v73, 0xffff0000, v20
  v_lshlrev_b32 v74, 16, v21
  v_and_b32 v75, 0xffff0000, v21
  v_lshlrev_b32 v76, 16, v22
  v_and_b32 v77, 0xffff0000, v22
  v_lshlrev_b32 v78, 16, v23
  v_and_b32 v79, 0xffff0000, v23
  v_pk_add_f32 v[128:129], v[128:129], v[72:73]
  v_pk_add_f32 v[128:129], v[128:129], v[74:75]
  v_pk_add_f32 v[128:129], v[128:129], v[76:77]
  v_pk_add_f32 v[128:129], v[128:129], v[78:79]
  s_waitcnt vmcnt(0)
  v_lshlrev_b32 v80, 16, v24
  v_and_b32 v81, 0xffff0000, v24
  v_lshlrev_b32 v82, 16, v25
  v_and_b32 v83, 0xffff0000, v25
  v_lshlrev_b32 v84, 16, v26
  v_and_b32 v85, 0xffff0000, v26
  v_lshlrev_b32 v86, 16, v27
  v_and_b32 v87, 0xffff0000, v27
  v_pk_add_f32 v[128:129], v[128:129], v[80:81]
  v_pk_add_f32 v[128:129], v[128:129], v[82:83]
  v_pk_add_f32 v[128:129], v[128:129], v[84:85]
  v_pk_add_f32 v[128:129], v[128:129], v[86:87]
  v_add_f32 v128, v128, v129
  s_nop 1
  v_add_f32_dpp v128, v128, v128 quad_perm:[1,0,3,2] row_mask:0xf bank_mask:0xf
  s_nop 1
  v_add_f32_dpp v128, v128, v128 quad_perm:[2,3,0,1] row_mask:0xf bank_mask:0xf
  s_nop 1
  v_add_f32_dpp v128, v128, v128 row_half_mirror row_mask:0xf bank_mask:0xf
  s_nop 1
  v_add_f32_dpp v128, v128, v128 row_mirror row_mask:0xf bank_mask:0xf
  v_mul_f32 v130, 0xbacccccd, v128
  v_mov_b32 v131, v130
  v_pk_add_f32 v[48:49], v[48:49], v[130:131]
  v_pk_add_f32 v[50:51], v[50:51], v[130:131]
  v_pk_add_f32 v[52:53], v[52:53], v[130:131]
  v_pk_add_f32 v[54:55], v[54:55], v[130:131]
  v_pk_add_f32 v[56:57], v[56:57], v[130:131]
  v_pk_add_f32 v[58:59], v[58:59], v[130:131]
  v_pk_add_f32 v[60:61], v[60:61], v[130:131]
  v_pk_add_f32 v[62:63], v[62:63], v[130:131]
  v_pk_add_f32 v[64:65], v[64:65], v[130:131]
  v_pk_add_f32 v[66:67], v[66:67], v[130:131]
  v_pk_add_f32 v[68:69], v[68:69], v[130:131]
  v_pk_add_f32 v[70:71], v[70:71], v[130:131]
  v_pk_add_f32 v[72:73], v[72:73], v[130:131]
  v_pk_add_f32 v[74:75], v[74:75], v[130:131]
  v_pk_add_f32 v[76:77], v[76:77], v[130:131]
  v_pk_add_f32 v[78:79], v[78:79], v[130:131]
  v_pk_add_f32 v[80:81], v[80:81], v[130:131]
  v_pk_add_f32 v[82:83], v[82:83], v[130:131]
  v_pk_add_f32 v[84:85], v[84:85], v[130:131]
  v_pk_add_f32 v[86:87], v[86:87], v[130:131]
  v_pk_fma_f32 v[132:133], v[48:49], v[48:49], v[132:133]
  v_pk_fma_f32 v[132:133], v[50:51], v[50:51], v[132:133]
  v_pk_fma_f32 v[132:133], v[52:53], v[52:53], v[132:133]
  v_pk_fma_f32 v[132:133], v[54:55], v[54:55], v[132:133]
  v_pk_fma_f32 v[132:133], v[56:57], v[56:57], v[132:133]
  v_pk_fma_f32 v[132:133], v[58:59], v[58:59], v[132:133]
  v_pk_fma_f32 v[132:133], v[60:61], v[60:61], v[132:133]
  v_pk_fma_f32 v[132:133], v[62:63], v[62:63], v[132:133]
  v_pk_fma_f32 v[132:133], v[64:65], v[64:65], v[132:133]
  v_pk_fma_f32 v[132:133], v[66:67], v[66:67], v[132:133]
  v_pk_fma_f32 v[132:133], v[68:69], v[68:69], v[132:133]
  v_pk_fma_f32 v[132:133], v[70:71], v[70:71], v[132:133]
  v_pk_fma_f32 v[132:133], v[72:73], v[72:73], v[132:133]
  v_pk_fma_f32 v[132:133], v[74:75], v[74:75], v[132:133]
  v_pk_fma_f32 v[132:133], v[76:77], v[76:77], v[132:133]
  v_pk_fma_f32 v[132:133], v[78:79], v[78:79], v[132:133]
  v_pk_fma_f32 v[132:133], v[80:81], v[80:81], v[132:133]
  v_pk_fma_f32 v[132:133], v[82:83], v[82:83], v[132:133]
  v_pk_fma_f32 v[132:133], v[84:85], v[84:85], v[132:133]
  v_pk_fma_f32 v[132:133], v[86:87], v[86:87], v[132:133]
  v_add_f32 v132, v132, v133
  s_nop 1
  v_add_f32_dpp v132, v132, v132 quad_perm:[1,0,3,2] row_mask:0xf bank_mask:0xf
  s_nop 1
  v_add_f32_dpp v132, v132, v132 quad_perm:[2,3,0,1] row_mask:0xf bank_mask:0xf
  s_nop 1
  v_add_f32_dpp v132, v132, v132 row_half_mirror row_mask:0xf bank_mask:0xf
  s_nop 1
  v_add_f32_dpp v132, v132, v132 row_mirror row_mask:0xf bank_mask:0xf
  v_mov_b32 v134, 0x3727c5ac
  v_mov_b32 v135, 0x3acccccd
  v_fmac_f32 v134, v132, v135
  v_mov_b32 v137, v134
  v_rsq_f32 v134, v134
  s_nop 0
  v_mov_b32 v135, v134
  v_mul_f32 v137, v137, v134
  v_sub_f32 v136, 0, v130
  v_add_u32 v138, s52, v3
  v_lshlrev_b32 v138, 3, v138
  s_mov_b32 s53, 110592
  v_cmp_eq_u32 vcc, 0, v4
  s_nop 3
  s_and_saveexec_b64 s[54:55], vcc
  buffer_store_dwordx2 v[136:137], v138, s[8:11], s53 offen sc0 sc1
  s_mov_b64 exec, s[54:55]
  s_lshr_b32 s53, s52, 5
  s_mul_i32 s53, s53, 40960
  s_and_b32 s52, s52, 31
  s_lshl_b32 s52, s52, 4
  s_add_u32 s52, s52, s53
  s_add_u32 s52, s52, 126976
  v_lshlrev_b32 v6, 9, v4
  v_lshl_add_u32 v6, v3, 4, v6
  v_pk_mul_f32 v[48:49], v[48:49], v[134:135]
  v_pk_mul_f32 v[50:51], v[50:51], v[134:135]
  v_pk_mul_f32 v[52:53], v[52:53], v[134:135]
  v_pk_mul_f32 v[54:55], v[54:55], v[134:135]
  v_cvt_pk_f16_f32 v8, v48, v49
  v_cvt_pk_f16_f32 v9, v50, v51
  v_cvt_pk_f16_f32 v10, v52, v53
  v_cvt_pk_f16_f32 v11, v54, v55
  buffer_store_dwordx4 v[8:11], v6, s[8:11], s52 offen sc0 sc1
  s_add_u32 s52, s52, 8192
  v_pk_mul_f32 v[56:57], v[56:57], v[134:135]
  v_pk_mul_f32 v[58:59], v[58:59], v[134:135]
  v_pk_mul_f32 v[60:61], v[60:61], v[134:135]
  v_pk_mul_f32 v[62:63], v[62:63], v[134:135]
  v_cvt_pk_f16_f32 v12, v56, v57
  v_cvt_pk_f16_f32 v13, v58, v59
  v_cvt_pk_f16_f32 v14, v60, v61
  v_cvt_pk_f16_f32 v15, v62, v63
  buffer_store_dwordx4 v[12:15], v6, s[8:11], s52 offen sc0 sc1
  s_add_u32 s52, s52, 8192
  v_pk_mul_f32 v[64:65], v[64:65], v[134:135]
  v_pk_mul_f32 v[66:67], v[66:67], v[134:135]
  v_pk_mul_f32 v[68:69], v[68:69], v[134:135]
  v_pk_mul_f32 v[70:71], v[70:71], v[134:135]
  v_cvt_pk_f16_f32 v16, v64, v65
  v_cvt_pk_f16_f32 v17, v66, v67
  v_cvt_pk_f16_f32 v18, v68, v69
  v_cvt_pk_f16_f32 v19, v70, v71
  buffer_store_dwordx4 v[16:19], v6, s[8:11], s52 offen sc0 sc1
  s_add_u32 s52, s52, 8192
  v_pk_mul_f32 v[72:73], v[72:73], v[134:135]
  v_pk_mul_f32 v[74:75], v[74:75], v[134:135]
  v_pk_mul_f32 v[76:77], v[76:77], v[134:135]
  v_pk_mul_f32 v[78:79], v[78:79], v[134:135]
  v_cvt_pk_f16_f32 v20, v72, v73
  v_cvt_pk_f16_f32 v21, v74, v75
  v_cvt_pk_f16_f32 v22, v76, v77
  v_cvt_pk_f16_f32 v23, v78, v79
  buffer_store_dwordx4 v[20:23], v6, s[8:11], s52 offen sc0 sc1
  s_add_u32 s52, s52, 8192
  v_pk_mul_f32 v[80:81], v[80:81], v[134:135]
  v_pk_mul_f32 v[82:83], v[82:83], v[134:135]
  v_pk_mul_f32 v[84:85], v[84:85], v[134:135]
  v_pk_mul_f32 v[86:87], v[86:87], v[134:135]
  v_cvt_pk_f16_f32 v24, v80, v81
  v_cvt_pk_f16_f32 v25, v82, v83
  v_cvt_pk_f16_f32 v26, v84, v85
  v_cvt_pk_f16_f32 v27, v86, v87
  buffer_store_dwordx4 v[24:27], v6, s[8:11], s52 offen sc0 sc1
  s_add_u32 s52, s52, 8192
  s_waitcnt vmcnt(0)
adaLN_cond__mha_block__glu_gated_glu__prompt_pj16:
  s_barrier
  s_cmp_eq_u32 s4, 15
  s_cbranch_scc1 adaLN_cond__mha_block__glu_gated_glu__prompt_nt218
  s_mov_b32 s40, s18
  s_mov_b32 s41, s19
  s_mov_b32 s42, 0x258000
  s_mov_b32 s43, 0x20000
  v_lshrrev_b32 v141, 4, v1
  v_bfe_u32 v142, v1, 2, 2
  v_xor_b32 v142, v142, v141
  v_lshlrev_b32 v142, 6, v142
  v_and_b32 v143, 3, v1
  v_lshl_add_u32 v142, v143, 4, v142
  s_movk_i32 s52, 3840
  v_mad_u32_u24 v140, v141, s52, v142
  s_lshl_b32 s58, s4, 8
  s_sub_u32 s59, s12, 4
  s_add_u32 s59, s59, 0
  s_mul_i32 s60, s15, 9
  s_add_u32 s59, s59, s60
  s_mov_b32 s62, 35
adaLN_cond__mha_block__glu_gated_glu__prompt_wrot24:
  s_cmp_ge_u32 s59, 140
  s_cselect_b32 s60, 140, 0
  s_sub_u32 s59, s59, s60
  s_lshl_b32 m0, s59, 10
  s_mul_i32 s60, s59, 15360
  s_add_u32 s60, s60, s58
  buffer_load_dwordx4 v140, s[40:43], s60 offen lds
  s_waitcnt vmcnt(40)
  s_add_u32 s59, s59, 4
  s_sub_u32 s62, s62, 1
  s_cmp_lg_u32 s62, 0
  s_cbranch_scc1 adaLN_cond__mha_block__glu_gated_glu__prompt_wrot24
adaLN_cond__mha_block__glu_gated_glu__prompt_nt218:
  s_waitcnt vmcnt(0)
  s_barrier
  s_barrier
  s_barrier
  s_cmp_eq_u32 s4, 15
  s_cbranch_scc1 adaLN_cond__mha_block__glu_gated_glu__prompt_nt17
  s_mov_b32 s40, s18
  s_mov_b32 s41, s19
  s_mov_b32 s42, 0x258000
  s_mov_b32 s43, 0x20000
  v_lshrrev_b32 v141, 4, v1
  v_bfe_u32 v142, v1, 2, 2
  v_xor_b32 v142, v142, v141
  v_lshlrev_b32 v142, 6, v142
  v_and_b32 v143, 3, v1
  v_lshl_add_u32 v142, v143, 4, v142
  s_movk_i32 s52, 3840
  v_mad_u32_u24 v140, v141, s52, v142
  s_lshl_b32 s58, s4, 8
  s_sub_u32 s59, s12, 4
  s_mul_i32 s59, s59, 5
  s_add_u32 s59, s59, 140
  s_mul_i32 s60, s59, 15360
  s_add_u32 s60, s60, s58
  s_lshl_b32 s61, s59, 10
  s_sub_u32 s61, s61, 143360
  s_mov_b32 s62, 5
adaLN_cond__mha_block__glu_gated_glu__prompt_wdma25:
  s_mov_b32 m0, s61
  s_add_u32 s61, s61, 1024
  buffer_load_dwordx4 v140, s[40:43], s60 offen lds
  s_add_u32 s60, s60, 15360
  s_sub_u32 s62, s62, 1
  s_cmp_lg_u32 s62, 0
  s_cbranch_scc1 adaLN_cond__mha_block__glu_gated_glu__prompt_wdma25
adaLN_cond__mha_block__glu_gated_glu__prompt_nt17:
  s_waitcnt vmcnt(0)
  s_cmp_lt_u32 s2, 80
  s_cbranch_scc1 adaLN_cond__mha_block__glu_gated_glu__prompt_nomr26
  s_cmp_ge_u32 s2, 240
  s_cbranch_scc1 adaLN_cond__mha_block__glu_gated_glu__prompt_nomr26
  s_sub_u32 s53, s2, 80
  s_mul_i32 s52, s53, 26215
  s_lshr_b32 s52, s52, 20
  s_mul_i32 s54, s52, 40
  s_sub_u32 s53, s53, s54
  s_add_u32 s53, s53, 20
  s_sub_u32 s68, s12, 4
  s_mov_b32 s40, s32
  s_mov_b32 s41, s33
  s_mov_b32 s42, 0x4b0000
  s_mov_b32 s43, 0x20000
  s_mov_b32 s44, s30
  s_mov_b32 s45, s31
  s_mov_b32 s46, 0x500
  s_mov_b32 s47, 0x20000
  v_lshrrev_b32 v3, 3, v1
  v_and_b32 v4, 7, v1
  s_mul_i32 s54, s52, 160
  s_mul_i32 s55, s68, 40
  s_add_u32 s54, s54, s55
  v_add_u32 v5, s54, v3
  s_movk_i32 s55, 7680
  v_mul_u32_u24 v6, s55, v5
  s_lshl_b32 s56, s53, 7
  v_lshlrev_b32 v7, 4, v4
  v_add3_u32 v6, v6, v7, s56
  v_lshlrev_b32 v8, 1, v5
  s_mov_b32 s57, 0
  buffer_load_dwordx4 v[60:63], v6, s[40:43], s57 offen nt
  s_mov_b32 s57, 61440
  buffer_load_dwordx4 v[64:67], v6, s[40:43], s57 offen nt
  s_mov_b32 s57, 122880
  buffer_load_dwordx4 v[68:71], v6, s[40:43], s57 offen nt
  s_mov_b32 s57, 184320
  buffer_load_dwordx4 v[72:75], v6, s[40:43], s57 offen nt
  s_mov_b32 s57, 245760
  buffer_load_dwordx4 v[76:79], v6, s[40:43], s57 offen nt
  buffer_load_ushort v80, v8, s[44:47], 0 offen offset:0
  buffer_load_ushort v81, v8, s[44:47], 0 offen offset:16
  buffer_load_ushort v82, v8, s[44:47], 0 offen offset:32
  buffer_load_ushort v83, v8, s[44:47], 0 offen offset:48
  buffer_load_ushort v84, v8, s[44:47], 0 offen offset:64
adaLN_cond__mha_block__glu_gated_glu__prompt_nomr26:
  s_barrier
  s_waitcnt vmcnt(0)
  s_cmp_lt_u32 s2, 80
  s_cbranch_scc1 adaLN_cond__mha_block__glu_gated_glu__prompt_nomf27
  s_cmp_ge_u32 s2, 240
  s_cbranch_scc1 adaLN_cond__mha_block__glu_gated_glu__prompt_nomf27
  v_mov_b32 v28, 0
  v_mov_b32 v29, 0
  v_mov_b32 v30, 0
  v_mov_b32 v31, 0
  v_mov_b32 v32, 0
  v_mov_b32 v33, 0
  v_mov_b32 v34, 0
  v_mov_b32 v35, 0
  s_mov_b32 s48, 0xbfb8aa3b
  v_lshlrev_b32 v80, 16, v80
  v_mul_f32 v36, s48, v80
  v_exp_f32 v36, v36
  v_lshlrev_b32 v81, 16, v81
  v_mul_f32 v37, s48, v81
  v_exp_f32 v37, v37
  v_lshlrev_b32 v82, 16, v82
  v_mul_f32 v38, s48, v82
  v_exp_f32 v38, v38
  v_lshlrev_b32 v83, 16, v83
  v_mul_f32 v39, s48, v83
  v_exp_f32 v39, v39
  v_lshlrev_b32 v84, 16, v84
  v_mul_f32 v40, s48, v84
  v_exp_f32 v40, v40
  v_add_f32 v36, 1.0, v36
  v_add_f32 v37, 1.0, v37
  v_add_f32 v38, 1.0, v38
  v_add_f32 v39, 1.0, v39
  v_add_f32 v40, 1.0, v40
  v_rcp_f32 v36, v36
  v_rcp_f32 v37, v37
  v_rcp_f32 v38, v38
  v_rcp_f32 v39, v39
  v_rcp_f32 v40, v40
  v_mul_f32 v80, v80, v36
  v_mul_f32 v81, v81, v37
  v_mul_f32 v82, v82, v38
  v_mul_f32 v83, v83, v39
  v_mul_f32 v84, v84, v40
  v_lshlrev_b32 v44, 16, v60
  v_and_b32 v45, 0xffff0000, v60
  v_fmac_f32 v28, v80, v44
  v_fmac_f32 v29, v80, v45
  v_lshlrev_b32 v44, 16, v61
  v_and_b32 v45, 0xffff0000, v61
  v_fmac_f32 v30, v80, v44
  v_fmac_f32 v31, v80, v45
  v_lshlrev_b32 v44, 16, v62
  v_and_b32 v45, 0xffff0000, v62
  v_fmac_f32 v32, v80, v44
  v_fmac_f32 v33, v80, v45
  v_lshlrev_b32 v44, 16, v63
  v_and_b32 v45, 0xffff0000, v63
  v_fmac_f32 v34, v80, v44
  v_fmac_f32 v35, v80, v45
  v_lshlrev_b32 v44, 16, v64
  v_and_b32 v45, 0xffff0000, v64
  v_fmac_f32 v28, v81, v44
  v_fmac_f32 v29, v81, v45
  v_lshlrev_b32 v44, 16, v65
  v_and_b32 v45, 0xffff0000, v65
  v_fmac_f32 v30, v81, v44
  v_fmac_f32 v31, v81, v45
  v_lshlrev_b32 v44, 16, v66
  v_and_b32 v45, 0xffff0000, v66
  v_fmac_f32 v32, v81, v44
  v_fmac_f32 v33, v81, v45
  v_lshlrev_b32 v44, 16, v67
  v_and_b32 v45, 0xffff0000, v67
  v_fmac_f32 v34, v81, v44
  v_fmac_f32 v35, v81, v45
  v_lshlrev_b32 v44, 16, v68
  v_and_b32 v45, 0xffff0000, v68
  v_fmac_f32 v28, v82, v44
  v_fmac_f32 v29, v82, v45
  v_lshlrev_b32 v44, 16, v69
  v_and_b32 v45, 0xffff0000, v69
  v_fmac_f32 v30, v82, v44
  v_fmac_f32 v31, v82, v45
  v_lshlrev_b32 v44, 16, v70
  v_and_b32 v45, 0xffff0000, v70
  v_fmac_f32 v32, v82, v44
  v_fmac_f32 v33, v82, v45
  v_lshlrev_b32 v44, 16, v71
  v_and_b32 v45, 0xffff0000, v71
  v_fmac_f32 v34, v82, v44
  v_fmac_f32 v35, v82, v45
  v_lshlrev_b32 v44, 16, v72
  v_and_b32 v45, 0xffff0000, v72
  v_fmac_f32 v28, v83, v44
  v_fmac_f32 v29, v83, v45
  v_lshlrev_b32 v44, 16, v73
  v_and_b32 v45, 0xffff0000, v73
  v_fmac_f32 v30, v83, v44
  v_fmac_f32 v31, v83, v45
  v_lshlrev_b32 v44, 16, v74
  v_and_b32 v45, 0xffff0000, v74
  v_fmac_f32 v32, v83, v44
  v_fmac_f32 v33, v83, v45
  v_lshlrev_b32 v44, 16, v75
  v_and_b32 v45, 0xffff0000, v75
  v_fmac_f32 v34, v83, v44
  v_fmac_f32 v35, v83, v45
  v_lshlrev_b32 v44, 16, v76
  v_and_b32 v45, 0xffff0000, v76
  v_fmac_f32 v28, v84, v44
  v_fmac_f32 v29, v84, v45
  v_lshlrev_b32 v44, 16, v77
  v_and_b32 v45, 0xffff0000, v77
  v_fmac_f32 v30, v84, v44
  v_fmac_f32 v31, v84, v45
  v_lshlrev_b32 v44, 16, v78
  v_and_b32 v45, 0xffff0000, v78
  v_fmac_f32 v32, v84, v44
  v_fmac_f32 v33, v84, v45
  v_lshlrev_b32 v44, 16, v79
  v_and_b32 v45, 0xffff0000, v79
  v_fmac_f32 v34, v84, v44
  v_fmac_f32 v35, v84, v45
  v_and_b32 v44, 8, v1
  v_cmp_ne_u32 vcc, 0, v44
  s_nop 1
  v_cndmask_b32 v36, v32, v28, vcc
  v_cndmask_b32 v40, v28, v32, vcc
  v_cndmask_b32 v37, v33, v29, vcc
  v_cndmask_b32 v41, v29, v33, vcc
  v_cndmask_b32 v38, v34, v30, vcc
  v_cndmask_b32 v42, v30, v34, vcc
  v_cndmask_b32 v39, v35, v31, vcc
  v_cndmask_b32 v43, v31, v35, vcc
  v_add_f32_dpp v40, v36, v40 row_ror:8 row_mask:0xf bank_mask:0xf
  v_add_f32_dpp v41, v37, v41 row_ror:8 row_mask:0xf bank_mask:0xf
  v_add_f32_dpp v42, v38, v42 row_ror:8 row_mask:0xf bank_mask:0xf
  v_add_f32_dpp v43, v39, v43 row_ror:8 row_mask:0xf bank_mask:0xf
  s_nop 0
  v_permlane16_swap_b32 v40, v42
  v_permlane16_swap_b32 v41, v43
  v_add_f32 v40, v40, v42
  v_add_f32 v41, v41, v43
  s_nop 1
  v_permlane32_swap_b32 v40, v41
  v_add_f32 v40, v40, v41
  v_and_b32 v44, 7, v1
  v_lshlrev_b32 v44, 3, v44
  v_bfe_u32 v45, v1, 3, 1
  v_lshl_add_u32 v44, v45, 2, v44
  v_bfe_u32 v45, v1, 4, 1
  v_lshl_add_u32 v44, v45, 1, v44
  v_lshrrev_b32 v45, 5, v1
  v_add_u32 v44, v44, v45
  s_sub_u32 s49, s2, 80
  s_mul_i32 s50, s49, 26215
  s_lshr_b32 s50, s50, 20
  s_mul_i32 s50, s50, 40
  s_sub_u32 s49, s49, s50
  s_add_u32 s49, s49, 20
  s_lshl_b32 s49, s49, 8
  s_add_u32 s49, s49, 50176
  v_lshlrev_b32 v44, 2, v44
  buffer_atomic_add_f32 v40, v44, s[8:11], s49 offen
adaLN_cond__mha_block__glu_gated_glu__prompt_nomf27:
  s_branch adaLN_cond__mha_block__glu_gated_glu__prompt_p1done5
adaLN_cond__mha_block__glu_gated_glu__prompt_p1done5:
  s_cmp_ge_u32 s12, 4
  s_cbranch_scc1 adaLN_cond__mha_block__glu_gated_glu__prompt_s12w28
  s_waitcnt vmcnt(0)
  v_mov_b32 v2, 162624
  v_mov_b32 v3, 1
  s_mov_b64 exec, 1
  ds_add_rtn_u32 v4, v2, v3
  s_waitcnt lgkmcnt(0)
  s_mov_b64 exec, -1
  v_readfirstlane_b32 s53, v4
  s_nop 3
  s_cmp_lg_u32 s53, 3
  s_cbranch_scc1 adaLN_cond__mha_block__glu_gated_glu__prompt_s12w28
  v_mov_b32 v8, 0x3f803f80
  v_mov_b32 v9, 0x3f803f80
  v_mov_b32 v10, 0x3f803f80
  v_mov_b32 v11, 0x3f803f80
  v_mov_b32 v12, 0
  v_mov_b32 v13, 0
  v_mov_b32 v14, 0
  v_mov_b32 v15, 0
  v_min_u32 v5, 7, v1
  v_mul_u32_u24 v5, 0x280, v5
  v_add_u32 v5, 90112, v5
  ds_write_b128 v5, v[8:11]
  ds_write_b128 v5, v[12:15] offset:16
  v_mov_b32 v5, 95232
  ds_write_b32 v5, v12
  s_waitcnt lgkmcnt(0)
  s_cmp_eq_u32 s4, 15
  s_cbranch_scc1 adaLN_cond__mha_block__glu_gated_glu__prompt_s12w28
  s_add_u32 s52, s4, 0
  s_add_u32 s53, s4, 108
  s_lshl_b32 s48, s52, 8
  s_add_u32 s48, s48, 0
  v_mov_b32 v2, 0
  v_mov_b32 v3, 1
  s_mov_b64 exec, 1
  buffer_atomic_add v3, v2, s[8:11], s48 offen sc0 sc1
  s_waitcnt vmcnt(0)
  s_mov_b64 exec, -1
  v_readfirstlane_b32 s49, v3
  s_nop 3
  s_cmp_lg_u32 s49, 15
  s_cbranch_scc1 adaLN_cond__mha_block__glu_gated_glu__prompt_arr30
  s_lshl_b32 s48, s53, 8
  s_add_u32 s48, s48, 0
  v_lshlrev_b32 v2, 8, v1
  v_mov_b32 v3, 1
  s_mov_b32 exec_lo, 0x1
  s_mov_b32 exec_hi, 0
  buffer_store_dword v3, v2, s[8:11], s48 offen sc0 sc1
  s_mov_b64 exec, -1
adaLN_cond__mha_block__glu_gated_glu__prompt_arr30:
adaLN_cond__mha_block__glu_gated_glu__prompt_s12w28:
  s_lshl_b32 s63, s2, 3
  s_add_u32 s63, s63, s12
  s_lshl_b32 s68, s12, 12
  s_add_u32 s68, s68, 97280
  s_mov_b32 s69, 0
  s_cmp_ge_u32 s63, 1640
  s_cbranch_scc1 adaLN_cond__mha_block__glu_gated_glu__prompt_sjno31
  s_cmp_lt_u32 s63, 480
  s_cbranch_scc1 adaLN_cond__mha_block__glu_gated_glu__prompt_sj33
  s_cmp_lt_u32 s63, 960
  s_cbranch_scc1 adaLN_cond__mha_block__glu_gated_glu__prompt_sj34
  s_cmp_lt_u32 s63, 1160
  s_cbranch_scc1 adaLN_cond__mha_block__glu_gated_glu__prompt_sj35
  s_branch adaLN_cond__mha_block__glu_gated_glu__prompt_sj36
adaLN_cond__mha_block__glu_gated_glu__prompt_sj33:
  s_mov_b32 s44, s24
  s_mov_b32 s45, s25
  s_mov_b32 s46, 0x1e0000
  s_mov_b32 s47, 0x20000
  s_sub_u32 s54, s63, 0
  s_mul_i32 s55, s54, 87382
  s_lshr_b32 s55, s55, 20
  s_mul_i32 s56, s55, 12
  s_sub_u32 s54, s54, s56
  s_lshl_b32 s56, s54, 2
  s_add_u32 s56, s56, 0
  s_mul_i32 s57, s56, 349526
  s_lshr_b32 s57, s57, 20
  s_mul_i32 s64, s57, 3
  s_sub_u32 s56, s56, s64
  s_mul_i32 s57, s57, 40
  s_add_u32 s57, s57, s55
  s_mul_i32 s57, s57, 6
  s_add_u32 s57, s57, s56
  s_lshl_b32 s57, s57, 10
  s_add_u32 s64, s57, 2748416
  s_lshl_b32 s56, s54, 2
  s_add_u32 s56, s56, 1
  s_mul_i32 s57, s56, 349526
  s_lshr_b32 s57, s57, 20
  s_mul_i32 s65, s57, 3
  s_sub_u32 s56, s56, s65
  s_mul_i32 s57, s57, 40
  s_add_u32 s57, s57, s55
  s_mul_i32 s57, s57, 6
  s_add_u32 s57, s57, s56
  s_lshl_b32 s57, s57, 10
  s_add_u32 s65, s57, 2748416
  s_lshl_b32 s56, s54, 2
  s_add_u32 s56, s56, 2
  s_mul_i32 s57, s56, 349526
  s_lshr_b32 s57, s57, 20
  s_mul_i32 s66, s57, 3
  s_sub_u32 s56, s56, s66
  s_mul_i32 s57, s57, 40
  s_add_u32 s57, s57, s55
  s_mul_i32 s57, s57, 6
  s_add_u32 s57, s57, s56
  s_lshl_b32 s57, s57, 10
  s_add_u32 s66, s57, 2748416
  s_lshl_b32 s56, s54, 2
  s_add_u32 s56, s56, 3
  s_mul_i32 s57, s56, 349526
  s_lshr_b32 s57, s57, 20
  s_mul_i32 s67, s57, 3
  s_sub_u32 s56, s56, s67
  s_mul_i32 s57, s57, 40
  s_add_u32 s57, s57, s55
  s_mul_i32 s57, s57, 6
  s_add_u32 s57, s57, s56
  s_lshl_b32 s57, s57, 10
  s_add_u32 s67, s57, 2748416
  s_mov_b32 s69, 1
  s_lshl_b32 s55, s55, 4
  s_lshl_b32 s54, s54, 8
  v_lshrrev_b32 v8, 4, v1
  v_and_b32 v9, 15, v1
  v_lshl_add_u32 v9, v9, 4, s54
  v_add_u32 v226, s55, v8
  v_add_u32 v226, 0, v226
  v_add_u32 v227, s55, v8
  v_add_u32 v227, 4, v227
  v_add_u32 v228, s55, v8
  v_add_u32 v228, 8, v228
  v_add_u32 v229, s55, v8
  v_add_u32 v229, 12, v229
  s_movk_i32 s56, 3072
  v_mad_u32_u24 v226, v226, s56, v9
  v_mad_u32_u24 v227, v227, s56, v9
  v_mad_u32_u24 v228, v228, s56, v9
  v_mad_u32_u24 v229, v229, s56, v9
  v_and_b32 v8, 31, v1
  v_lshrrev_b32 v9, 1, v8
  v_add_u32 v9, s55, v9
  v_and_b32 v8, 1, v8
  v_lshlrev_b32 v8, 7, v8
  v_add_u32 v8, s54, v8
  v_mad_u32_u24 v10, v9, s56, v8
  s_branch adaLN_cond__mha_block__glu_gated_glu__prompt_sjgo32
adaLN_cond__mha_block__glu_gated_glu__prompt_sj34:
  s_mov_b32 s44, s26
  s_mov_b32 s45, s27
  s_mov_b32 s46, 0x1e0000
  s_mov_b32 s47, 0x20000
  s_sub_u32 s54, s63, 480
  s_mul_i32 s55, s54, 87382
  s_lshr_b32 s55, s55, 20
  s_mul_i32 s56, s55, 12
  s_sub_u32 s54, s54, s56
  s_lshl_b32 s56, s54, 2
  s_add_u32 s56, s56, 0
  s_mul_i32 s57, s56, 349526
  s_lshr_b32 s57, s57, 20
  s_mul_i32 s64, s57, 3
  s_sub_u32 s56, s56, s64
  s_mul_i32 s57, s57, 40
  s_add_u32 s57, s57, s55
  s_mul_i32 s57, s57, 6
  s_add_u32 s57, s57, s56
  s_lshl_b32 s57, s57, 10
  s_add_u32 s64, s57, 2751488
  s_lshl_b32 s56, s54, 2
  s_add_u32 s56, s56, 1
  s_mul_i32 s57, s56, 349526
  s_lshr_b32 s57, s57, 20
  s_mul_i32 s65, s57, 3
  s_sub_u32 s56, s56, s65
  s_mul_i32 s57, s57, 40
  s_add_u32 s57, s57, s55
  s_mul_i32 s57, s57, 6
  s_add_u32 s57, s57, s56
  s_lshl_b32 s57, s57, 10
  s_add_u32 s65, s57, 2751488
  s_lshl_b32 s56, s54, 2
  s_add_u32 s56, s56, 2
  s_mul_i32 s57, s56, 349526
  s_lshr_b32 s57, s57, 20
  s_mul_i32 s66, s57, 3
  s_sub_u32 s56, s56, s66
  s_mul_i32 s57, s57, 40
  s_add_u32 s57, s57, s55
  s_mul_i32 s57, s57, 6
  s_add_u32 s57, s57, s56
  s_lshl_b32 s57, s57, 10
  s_add_u32 s66, s57, 2751488
  s_lshl_b32 s56, s54, 2
  s_add_u32 s56, s56, 3
  s_mul_i32 s57, s56, 349526
  s_lshr_b32 s57, s57, 20
  s_mul_i32 s67, s57, 3
  s_sub_u32 s56, s56, s67
  s_mul_i32 s57, s57, 40
  s_add_u32 s57, s57, s55
  s_mul_i32 s57, s57, 6
  s_add_u32 s57, s57, s56
  s_lshl_b32 s57, s57, 10
  s_add_u32 s67, s57, 2751488
  s_mov_b32 s69, 1
  s_lshl_b32 s55, s55, 4
  s_lshl_b32 s54, s54, 8
  v_lshrrev_b32 v8, 4, v1
  v_and_b32 v9, 15, v1
  v_lshl_add_u32 v9, v9, 4, s54
  v_add_u32 v226, s55, v8
  v_add_u32 v226, 0, v226
  v_add_u32 v227, s55, v8
  v_add_u32 v227, 4, v227
  v_add_u32 v228, s55, v8
  v_add_u32 v228, 8, v228
  v_add_u32 v229, s55, v8
  v_add_u32 v229, 12, v229
  s_movk_i32 s56, 3072
  v_mad_u32_u24 v226, v226, s56, v9
  v_mad_u32_u24 v227, v227, s56, v9
  v_mad_u32_u24 v228, v228, s56, v9
  v_mad_u32_u24 v229, v229, s56, v9
  v_and_b32 v8, 31, v1
  v_lshrrev_b32 v9, 1, v8
  v_add_u32 v9, s55, v9
  v_and_b32 v8, 1, v8
  v_lshlrev_b32 v8, 7, v8
  v_add_u32 v8, s54, v8
  v_mad_u32_u24 v10, v9, s56, v8
  s_branch adaLN_cond__mha_block__glu_gated_glu__prompt_sjgo32
adaLN_cond__mha_block__glu_gated_glu__prompt_sj35:
  s_mov_b32 s44, s20
  s_mov_b32 s45, s21
  s_mov_b32 s46, 0xc8000
  s_mov_b32 s47, 0x20000
  s_sub_u32 s54, s63, 960
  s_mul_i32 s55, s54, 104858
  s_lshr_b32 s55, s55, 20
  s_mul_i32 s56, s55, 10
  s_sub_u32 s54, s54, s56
  s_lshl_b32 s56, s54, 2
  s_add_u32 s56, s56, 0
  s_mul_i32 s57, s56, 209716
  s_lshr_b32 s57, s57, 20
  s_mul_i32 s64, s57, 5
  s_sub_u32 s56, s56, s64
  s_mul_i32 s57, s57, 20
  s_add_u32 s57, s57, s55
  s_mul_i32 s57, s57, 5
  s_add_u32 s57, s57, s56
  s_lshl_b32 s57, s57, 10
  s_add_u32 s64, s57, 6680576
  s_lshl_b32 s56, s54, 2
  s_add_u32 s56, s56, 1
  s_mul_i32 s57, s56, 209716
  s_lshr_b32 s57, s57, 20
  s_mul_i32 s65, s57, 5
  s_sub_u32 s56, s56, s65
  s_mul_i32 s57, s57, 20
  s_add_u32 s57, s57, s55
  s_mul_i32 s57, s57, 5
  s_add_u32 s57, s57, s56
  s_lshl_b32 s57, s57, 10
  s_add_u32 s65, s57, 6680576
  s_lshl_b32 s56, s54, 2
  s_add_u32 s56, s56, 2
  s_mul_i32 s57, s56, 209716
  s_lshr_b32 s57, s57, 20
  s_mul_i32 s66, s57, 5
  s_sub_u32 s56, s56, s66
  s_mul_i32 s57, s57, 20
  s_add_u32 s57, s57, s55
  s_mul_i32 s57, s57, 5
  s_add_u32 s57, s57, s56
  s_lshl_b32 s57, s57, 10
  s_add_u32 s66, s57, 6680576
  s_lshl_b32 s56, s54, 2
  s_add_u32 s56, s56, 3
  s_mul_i32 s57, s56, 209716
  s_lshr_b32 s57, s57, 20
  s_mul_i32 s67, s57, 5
  s_sub_u32 s56, s56, s67
  s_mul_i32 s57, s57, 20
  s_add_u32 s57, s57, s55
  s_mul_i32 s57, s57, 5
  s_add_u32 s57, s57, s56
  s_lshl_b32 s57, s57, 10
  s_add_u32 s67, s57, 6680576
  s_mov_b32 s69, 2
  s_lshl_b32 s55, s55, 5
  s_lshl_b32 s54, s54, 7
  v_lshrrev_b32 v8, 3, v1
  v_and_b32 v9, 7, v1
  v_lshl_add_u32 v9, v9, 4, s54
  v_add_u32 v226, s55, v8
  v_add_u32 v226, 0, v226
  v_add_u32 v227, s55, v8
  v_add_u32 v227, 8, v227
  v_add_u32 v228, s55, v8
  v_add_u32 v228, 16, v228
  v_add_u32 v229, s55, v8
  v_add_u32 v229, 24, v229
  s_movk_i32 s56, 1639
  v_mul_u32_u24 v10, s56, v226
  v_lshrrev_b32 v10, 16, v10
  v_mul_u32_u24 v10, 40, v10
  v_sub_u32 v10, v226, v10
  v_mov_b32 v11, 0
  v_cmp_le_u32 vcc, 16, v10
  s_nop 1
  v_cndmask_b32_e64 v11, v11, 4, vcc
  v_cmp_le_u32 vcc, 32, v10
  s_nop 1
  v_cndmask_b32_e64 v11, v11, -16, vcc
  v_cmp_le_u32 vcc, 36, v10
  s_nop 1
  v_cndmask_b32_e64 v11, v11, 0, vcc
  v_add_u32 v226, v226, v11
  v_mul_u32_u24 v10, s56, v227
  v_lshrrev_b32 v10, 16, v10
  v_mul_u32_u24 v10, 40, v10
  v_sub_u32 v10, v227, v10
  v_mov_b32 v11, 0
  v_cmp_le_u32 vcc, 16, v10
  s_nop 1
  v_cndmask_b32_e64 v11, v11, 4, vcc
  v_cmp_le_u32 vcc, 32, v10
  s_nop 1
  v_cndmask_b32_e64 v11, v11, -16, vcc
  v_cmp_le_u32 vcc, 36, v10
  s_nop 1
  v_cndmask_b32_e64 v11, v11, 0, vcc
  v_add_u32 v227, v227, v11
  v_mul_u32_u24 v10, s56, v228
  v_lshrrev_b32 v10, 16, v10
  v_mul_u32_u24 v10, 40, v10
  v_sub_u32 v10, v228, v10
  v_mov_b32 v11, 0
  v_cmp_le_u32 vcc, 16, v10
  s_nop 1
  v_cndmask_b32_e64 v11, v11, 4, vcc
  v_cmp_le_u32 vcc, 32, v10
  s_nop 1
  v_cndmask_b32_e64 v11, v11, -16, vcc
  v_cmp_le_u32 vcc, 36, v10
  s_nop 1
  v_cndmask_b32_e64 v11, v11, 0, vcc
  v_add_u32 v228, v228, v11
  v_mul_u32_u24 v10, s56, v229
  v_lshrrev_b32 v10, 16, v10
  v_mul_u32_u24 v10, 40, v10
  v_sub_u32 v10, v229, v10
  v_mov_b32 v11, 0
  v_cmp_le_u32 vcc, 16, v10
  s_nop 1
  v_cndmask_b32_e64 v11, v11, 4, vcc
  v_cmp_le_u32 vcc, 32, v10
  s_nop 1
  v_cndmask_b32_e64 v11, v11, -16, vcc
  v_cmp_le_u32 vcc, 36, v10
  s_nop 1
  v_cndmask_b32_e64 v11, v11, 0, vcc
  v_add_u32 v229, v229, v11
  s_movk_i32 s56, 1280
  v_mad_u32_u24 v226, v226, s56, v9
  v_mad_u32_u24 v227, v227, s56, v9
  v_mad_u32_u24 v228, v228, s56, v9
  v_mad_u32_u24 v229, v229, s56, v9
  v_and_b32 v9, 31, v1
  v_add_u32 v9, s55, v9
  s_movk_i32 s57, 1639
  v_mul_u32_u24 v10, s57, v9
  v_lshrrev_b32 v10, 16, v10
  v_mul_u32_u24 v10, 40, v10
  v_sub_u32 v10, v9, v10
  v_mov_b32 v11, 0
  v_cmp_le_u32 vcc, 16, v10
  s_nop 1
  v_cndmask_b32_e64 v11, v11, 4, vcc
  v_cmp_le_u32 vcc, 32, v10
  s_nop 1
  v_cndmask_b32_e64 v11, v11, -16, vcc
  v_cmp_le_u32 vcc, 36, v10
  s_nop 1
  v_cndmask_b32_e64 v11, v11, 0, vcc
  v_add_u32 v9, v9, v11
  v_mov_b32 v8, s54
  v_mad_u32_u24 v10, v9, s56, v8
  s_branch adaLN_cond__mha_block__glu_gated_glu__prompt_sjgo32
adaLN_cond__mha_block__glu_gated_glu__prompt_sj36:
  s_mov_b32 s44, s28
  s_mov_b32 s45, s29
  s_mov_b32 s46, 0x1e0000
  s_mov_b32 s47, 0x20000
  s_sub_u32 s54, s63, 1160
  s_mul_i32 s55, s54, 104858
  s_lshr_b32 s55, s55, 20
  s_mul_i32 s56, s55, 10
  s_sub_u32 s54, s54, s56
  s_lshl_b32 s56, s54, 2
  s_add_u32 s56, s56, 0
  s_mul_i32 s57, s56, 209716
  s_lshr_b32 s57, s57, 20
  s_mul_i32 s64, s57, 5
  s_sub_u32 s56, s56, s64
  s_mul_i32 s57, s57, 48
  s_add_u32 s57, s57, s55
  s_mul_i32 s57, s57, 5
  s_add_u32 s57, s57, s56
  s_lshl_b32 s57, s57, 10
  s_add_u32 s64, s57, 7499776
  s_lshl_b32 s56, s54, 2
  s_add_u32 s56, s56, 1
  s_mul_i32 s57, s56, 209716
  s_lshr_b32 s57, s57, 20
  s_mul_i32 s65, s57, 5
  s_sub_u32 s56, s56, s65
  s_mul_i32 s57, s57, 48
  s_add_u32 s57, s57, s55
  s_mul_i32 s57, s57, 5
  s_add_u32 s57, s57, s56
  s_lshl_b32 s57, s57, 10
  s_add_u32 s65, s57, 7499776
  s_lshl_b32 s56, s54, 2
  s_add_u32 s56, s56, 2
  s_mul_i32 s57, s56, 209716
  s_lshr_b32 s57, s57, 20
  s_mul_i32 s66, s57, 5
  s_sub_u32 s56, s56, s66
  s_mul_i32 s57, s57, 48
  s_add_u32 s57, s57, s55
  s_mul_i32 s57, s57, 5
  s_add_u32 s57, s57, s56
  s_lshl_b32 s57, s57, 10
  s_add_u32 s66, s57, 7499776
  s_lshl_b32 s56, s54, 2
  s_add_u32 s56, s56, 3
  s_mul_i32 s57, s56, 209716
  s_lshr_b32 s57, s57, 20
  s_mul_i32 s67, s57, 5
  s_sub_u32 s56, s56, s67
  s_mul_i32 s57, s57, 48
  s_add_u32 s57, s57, s55
  s_mul_i32 s57, s57, 5
  s_add_u32 s57, s57, s56
  s_lshl_b32 s57, s57, 10
  s_add_u32 s67, s57, 7499776
  s_mov_b32 s69, 2
  s_lshl_b32 s55, s55, 5
  s_lshl_b32 s54, s54, 7
  v_lshrrev_b32 v8, 3, v1
  v_and_b32 v9, 7, v1
  v_lshl_add_u32 v9, v9, 4, s54
  v_add_u32 v226, s55, v8
  v_add_u32 v226, 0, v226
  v_add_u32 v227, s55, v8
  v_add_u32 v227, 8, v227
  v_add_u32 v228, s55, v8
  v_add_u32 v228, 16, v228
  v_add_u32 v229, s55, v8
  v_add_u32 v229, 24, v229
  s_movk_i32 s56, 1280
  v_mad_u32_u24 v226, v226, s56, v9
  v_mad_u32_u24 v227, v227, s56, v9
  v_mad_u32_u24 v228, v228, s56, v9
  v_mad_u32_u24 v229, v229, s56, v9
  v_and_b32 v9, 31, v1
  v_add_u32 v9, s55, v9
  v_mov_b32 v8, s54
  v_mad_u32_u24 v10, v9, s56, v8
  s_branch adaLN_cond__mha_block__glu_gated_glu__prompt_sjgo32
adaLN_cond__mha_block__glu_gated_glu__prompt_sjno31:
  s_mov_b32 s44, s38
  s_mov_b32 s45, s39
  s_mov_b32 s46, 0x1000
  s_mov_b32 s47, 0x20000
  v_mov_b32 v226, 0
  v_mov_b32 v227, 0
  v_mov_b32 v228, 0
  v_mov_b32 v229, 0
  v_mov_b32 v10, 0
adaLN_cond__mha_block__glu_gated_glu__prompt_sjgo32:
  s_mov_b32 s40, s32
  s_mov_b32 s41, s33
  s_mov_b32 s42, 0x4b0000
  s_mov_b32 s43, 0x20000
  s_mov_b32 s20, s30
  s_mov_b32 s21, s31
  s_mov_b32 s22, 0x500
  s_mov_b32 s23, 0x20000
  s_mov_b32 s100, 0
  v_mov_b32 v13, 0
  v_mov_b32 v14, 0
  v_mov_b32 v11, 0
  s_branch adaLN_cond__mha_block__glu_gated_glu__prompt_sjnm37
  s_cmp_lt_u32 s2, 96
  s_cbranch_scc1 adaLN_cond__mha_block__glu_gated_glu__prompt_sjnm37
  s_cmp_ge_u32 s12, 4
  s_cbranch_scc1 adaLN_cond__mha_block__glu_gated_glu__prompt_sjnm37
  s_sub_u32 s53, s2, 96
  s_mul_i32 s52, s53, 26215
  s_lshr_b32 s52, s52, 20
  s_mul_i32 s54, s52, 40
  s_sub_u32 s53, s53, s54
  s_add_u32 s53, s53, 20
  s_mov_b32 s100, 1
  s_lshl_b32 s101, s53, 8
  s_add_u32 s101, s101, 50176
  s_mul_i32 s54, s52, 160
  s_mul_i32 s55, s12, 40
  s_add_u32 s54, s54, s55
  v_lshrrev_b32 v8, 3, v1
  v_and_b32 v9, 7, v1
  v_add_u32 v8, s54, v8
  s_movk_i32 s55, 7680
  v_mul_u32_u24 v13, s55, v8
  s_lshl_b32 s56, s53, 7
  v_lshlrev_b32 v9, 4, v9
  v_add3_u32 v13, v13, v9, s56
  v_lshlrev_b32 v14, 1, v8
  v_min_u32 v8, 39, v1
  v_add_u32 v8, s54, v8
  v_mov_b32 v9, s56
  v_mad_u32_u24 v11, v8, s55, v9
adaLN_cond__mha_block__glu_gated_glu__prompt_sjnm37:
  s_and_b32 s48, s14, 3
  s_lshl_b32 s4, s13, 2
  s_add_u32 s4, s4, s48
  s_lshr_b32 s5, s14, 2
  s_lshr_b32 s6, s12, 2
  s_mul_i32 s48, s4, 5
  s_lshr_b32 s48, s48, 1
  s_lshl_b32 s7, s48, 9
  v_lshlrev_b32 v2, 4, v1
  s_add_u32 s48, s12, 0
  s_lshl_b32 s58, s48, 10
  v_add_u32 v3, s58, v2
  v_lshrrev_b32 v4, 9, v3
  v_mul_u32_u24 v4, 43, v4
  v_lshrrev_b32 v4, 7, v4
  v_mul_u32_u24 v5, 0x600, v4
  v_sub_u32 v5, v3, v5
  s_mov_b32 s49, 40960
  v_mad_u32_u24 v5, v4, s49, v5
  v_subrev_u32 v3, 0x3000, v3
  s_cmp_lt_u32 s48, 12
  s_cselect_b64 vcc, -1, 0
  v_cndmask_b32 v207, v3, v5, vcc
  s_mul_i32 s49, s4, 81920
  s_add_u32 s49, s49, 14708736
  s_add_u32 s50, s7, 12087296
  s_cmp_lt_u32 s48, 12
  s_cselect_b32 s52, s50, s49
  s_mov_b32 s50, 327680
  s_cselect_b32 s55, s50, 10240
  s_add_u32 s48, s12, 8
  s_lshl_b32 s59, s48, 10
  v_add_u32 v3, s59, v2
  v_lshrrev_b32 v4, 9, v3
  v_mul_u32_u24 v4, 43, v4
  v_lshrrev_b32 v4, 7, v4
  v_mul_u32_u24 v5, 0x600, v4
  v_sub_u32 v5, v3, v5
  s_mov_b32 s49, 40960
  v_mad_u32_u24 v5, v4, s49, v5
  v_subrev_u32 v3, 0x3000, v3
  s_cmp_lt_u32 s48, 12
  s_cselect_b64 vcc, -1, 0
  v_cndmask_b32 v208, v3, v5, vcc
  s_mul_i32 s49, s4, 81920
  s_add_u32 s49, s49, 14708736
  s_add_u32 s50, s7, 12087296
  s_cmp_lt_u32 s48, 12
  s_cselect_b32 s53, s50, s49
  s_mov_b32 s50, 327680
  s_cselect_b32 s56, s50, 10240
  s_add_u32 s48, s12, 16
  s_cmp_ge_u32 s48, 22
  s_cselect_b32 s49, 2, 0
  s_sub_u32 s48, s48, s49
  s_lshl_b32 s60, s48, 10
  v_add_u32 v3, s60, v2
  v_lshrrev_b32 v4, 9, v3
  v_mul_u32_u24 v4, 43, v4
  v_lshrrev_b32 v4, 7, v4
  v_mul_u32_u24 v5, 0x600, v4
  v_sub_u32 v5, v3, v5
  s_mov_b32 s49, 40960
  v_mad_u32_u24 v5, v4, s49, v5
  v_subrev_u32 v3, 0x3000, v3
  s_cmp_lt_u32 s48, 12
  s_cselect_b64 vcc, -1, 0
  v_cndmask_b32 v209, v3, v5, vcc
  s_mul_i32 s49, s4, 81920
  s_add_u32 s49, s49, 14708736
  s_add_u32 s50, s7, 12087296
  s_cmp_lt_u32 s48, 12
  s_cselect_b32 s54, s50, s49
  s_mov_b32 s50, 327680
  s_cselect_b32 s57, s50, 10240
  v_and_b32 v3, 31, v1
  v_lshrrev_b32 v4, 5, v1
  s_mul_i32 s48, s6, 6144
  v_add_u32 v200, s48, v2
  v_lshlrev_b32 v5, 4, v3
  v_lshl_add_u32 v5, v4, 3, v5
  s_add_u32 s48, s48, 1024
  v_add_u32 v201, s48, v5
  v_mul_u32_u24 v5, 0x140, v4
  v_lshl_add_u32 v5, v3, 4, v5
  s_mul_i32 s48, s6, 5120
  v_add_u32 v5, s48, v5
  v_mov_b32 v6, 77824
  v_mov_b32 v7, 77840
  v_cmp_lt_u32 vcc, 20, v3
  s_nop 1
  v_cndmask_b32 v6, v6, v7, vcc
  v_cmp_le_u32 vcc, 20, v3
  s_nop 1
  v_cndmask_b32 v202, v5, v6, vcc
  v_mov_b32 v7, 1
  v_cndmask_b32_e64 v203, v7, 0, vcc
  v_mov_b32 v140, 0
  v_mov_b32 v156, 0
  v_mov_b32 v141, 0
  v_mov_b32 v157, 0
  v_mov_b32 v142, 0
  v_mov_b32 v158, 0
  v_mov_b32 v143, 0
  v_mov_b32 v159, 0
  v_mov_b32 v144, 0
  v_mov_b32 v160, 0
  v_mov_b32 v145, 0
  v_mov_b32 v161, 0
  v_mov_b32 v146, 0
  v_mov_b32 v162, 0
  v_mov_b32 v147, 0
  v_mov_b32 v163, 0
  v_mov_b32 v148, 0
  v_mov_b32 v164, 0
  v_mov_b32 v149, 0
  v_mov_b32 v165, 0
  v_mov_b32 v150, 0
  v_mov_b32 v166, 0
  v_mov_b32 v151, 0
  v_mov_b32 v167, 0
  v_mov_b32 v152, 0
  v_mov_b32 v168, 0
  v_mov_b32 v153, 0
  v_mov_b32 v169, 0
  v_mov_b32 v154, 0
  v_mov_b32 v170, 0
  v_mov_b32 v155, 0
  v_mov_b32 v171, 0
  s_mov_b32 s15, 0
  v_mov_b32 v108, 0
  v_mov_b32 v124, 0
  v_mov_b32 v109, 0
  v_mov_b32 v125, 0
  v_mov_b32 v110, 0
  v_mov_b32 v126, 0
  v_mov_b32 v111, 0
  v_mov_b32 v127, 0
  v_mov_b32 v112, 0
  v_mov_b32 v128, 0
  v_mov_b32 v113, 0
  v_mov_b32 v129, 0
  v_mov_b32 v114, 0
  v_mov_b32 v130, 0
  v_mov_b32 v115, 0
  v_mov_b32 v131, 0
  v_mov_b32 v116, 0
  v_mov_b32 v132, 0
  v_mov_b32 v117, 0
  v_mov_b32 v133, 0
  v_mov_b32 v118, 0
  v_mov_b32 v134, 0
  v_mov_b32 v119, 0
  v_mov_b32 v135, 0
  v_mov_b32 v120, 0
  v_mov_b32 v136, 0
  v_mov_b32 v121, 0
  v_mov_b32 v137, 0
  v_mov_b32 v122, 0
  v_mov_b32 v138, 0
  v_mov_b32 v123, 0
  v_mov_b32 v139, 0
  v_mov_b32 v104, 0
  v_mov_b32 v196, 0
  v_mov_b32 v105, 0
  v_mov_b32 v197, 0
  v_mov_b32 v106, 0
  v_mov_b32 v198, 0
  v_mov_b32 v107, 0
  v_mov_b32 v199, 0
  s_cmp_lg_u32 s12, 0
  s_cbranch_scc1 adaLN_cond__mha_block__glu_gated_glu__prompt_s12p38
  s_lshr_b32 s48, s7, 9
  s_lshr_b32 s49, s48, 4
  s_add_u32 s50, s48, 2
  s_lshr_b32 s50, s50, 4
  s_mul_i32 s51, s4, 20
  s_add_u32 s52, s51, 19
  s_lshr_b32 s51, s51, 7
  s_lshr_b32 s52, s52, 7
  v_mov_b32 v5, s49
  v_mov_b32 v6, 1
  s_add_u32 s53, s50, 0
  v_mov_b32 v7, s53
  v_cmp_eq_u32 vcc, 1, v1
  s_nop 1
  v_cndmask_b32 v5, v5, v7, vcc
  s_add_u32 s53, s49, 5
  v_mov_b32 v7, s53
  v_cmp_eq_u32 vcc, 2, v1
  s_nop 1
  v_cndmask_b32 v5, v5, v7, vcc
  s_add_u32 s53, s50, 5
  v_mov_b32 v7, s53
  v_cmp_eq_u32 vcc, 3, v1
  s_nop 1
  v_cndmask_b32 v5, v5, v7, vcc
  s_add_u32 s53, s51, 10
  v_mov_b32 v7, s53
  v_cmp_eq_u32 vcc, 4, v1
  s_nop 1
  v_cndmask_b32 v5, v5, v7, vcc
  s_add_u32 s53, s52, 10
  v_mov_b32 v7, s53
  v_cmp_eq_u32 vcc, 5, v1
  s_nop 1
  v_cndmask_b32 v5, v5, v7, vcc
  v_add_u32 v5, 108, v5
  v_lshlrev_b32 v5, 8, v5
  s_mov_b32 s49, 0
  s_mov_b32 s50, 0
adaLN_cond__mha_block__glu_gated_glu__prompt_poll39:
  buffer_load_dword v4, v5, s[8:11], s49 offen sc1
  s_waitcnt vmcnt(0)
  v_cmp_lt_u32 vcc, v4, v6
  s_nop 3
  s_cmp_eq_u64 vcc, 0
  s_cbranch_scc1 adaLN_cond__mha_block__glu_gated_glu__prompt_polled40
  s_add_u32 s50, s50, 1
  s_cmp_ge_u32 s50, 200000
  s_cbranch_scc1 adaLN_cond__mha_block__glu_gated_glu__prompt_polled40
  s_sleep 2
  s_branch adaLN_cond__mha_block__glu_gated_glu__prompt_poll39
adaLN_cond__mha_block__glu_gated_glu__prompt_polled40:
adaLN_cond__mha_block__glu_gated_glu__prompt_s12p38:
  s_barrier
adaLN_cond__mha_block__glu_gated_glu__prompt_again41:
  s_mul_i32 s48, s4, 81920
  s_add_u32 s49, s48, 14708736
  s_add_u32 s50, s7, 12087296
  s_cmp_eq_u32 s55, 10240
  s_cselect_b32 s52, s49, s50
  s_cmp_eq_u32 s56, 10240
  s_cselect_b32 s53, s49, s50
  s_cmp_eq_u32 s57, 10240
  s_cselect_b32 s54, s49, s50
  s_mov_b32 s62, 0
  s_add_u32 m0, s58, s62
  s_nop 0
  buffer_load_dwordx4 v207, s[8:11], s52 offen sc1 lds
  s_add_u32 m0, s59, s62
  s_nop 0
  buffer_load_dwordx4 v208, s[8:11], s53 offen sc1 lds
  s_add_u32 m0, s60, s62
  s_nop 0
  buffer_load_dwordx4 v209, s[8:11], s54 offen sc1 lds
  s_cmp_lg_u32 s15, 0
  s_cbranch_scc1 adaLN_cond__mha_block__glu_gated_glu__prompt_hasq44
  s_lshl_b32 s48, s5, 3
  s_and_b32 s49, s12, 3
  s_lshl_b32 s49, s49, 1
  s_add_u32 s48, s48, s49
  s_mul_i32 s48, s48, 40960
  s_add_u32 s48, s48, s7
  s_add_u32 s48, s48, 9465856
  s_add_u32 s49, s48, 40960
  v_lshlrev_b32 v2, 4, v1
  v_and_b32 v3, 31, v1
  v_lshrrev_b32 v4, 5, v1
  v_lshlrev_b32 v5, 4, v3
  v_lshl_add_u32 v5, v4, 3, v5
  buffer_load_dwordx4 v[16:19], v2, s[8:11], s48 offen sc1
  buffer_load_dwordx2 v[20:21], v5, s[8:11], s48 offen offset:1024 sc1
  buffer_load_dwordx4 v[22:25], v2, s[8:11], s49 offen sc1
  buffer_load_dwordx2 v[26:27], v5, s[8:11], s49 offen offset:1024 sc1
adaLN_cond__mha_block__glu_gated_glu__prompt_hasq44:
  s_add_u32 s52, s52, s55
  s_add_u32 s53, s53, s56
  s_add_u32 s54, s54, s57
  s_mov_b32 s62, 22528
  s_add_u32 m0, s58, s62
  s_nop 0
  buffer_load_dwordx4 v207, s[8:11], s52 offen sc1 lds
  s_add_u32 m0, s59, s62
  s_nop 0
  buffer_load_dwordx4 v208, s[8:11], s53 offen sc1 lds
  s_add_u32 m0, s60, s62
  s_nop 0
  buffer_load_dwordx4 v209, s[8:11], s54 offen sc1 lds
  s_waitcnt vmcnt(3)
  s_cmp_lg_u32 s15, 0
  s_cbranch_scc1 adaLN_cond__mha_block__glu_gated_glu__prompt_hasq45
  s_bitcmp1_b32 s4, 0
  s_cbranch_scc1 adaLN_cond__mha_block__glu_gated_glu__prompt_qodd46
  v_cmp_le_u32 vcc, 32, v1
  s_nop 1
  v_cndmask_b32_e64 v20, v20, 0, vcc
  v_cndmask_b32_e64 v21, v21, 0, vcc
  v_cndmask_b32_e64 v26, v26, 0, vcc
  v_cndmask_b32_e64 v27, v27, 0, vcc
  s_branch adaLN_cond__mha_block__glu_gated_glu__prompt_qdone47
adaLN_cond__mha_block__glu_gated_glu__prompt_qodd46:
  v_cmp_gt_u32 vcc, 32, v1
  s_nop 1
  v_cndmask_b32_e64 v16, v16, 0, vcc
  v_cndmask_b32_e64 v17, v17, 0, vcc
  v_cndmask_b32_e64 v22, v22, 0, vcc
  v_cndmask_b32_e64 v23, v23, 0, vcc
adaLN_cond__mha_block__glu_gated_glu__prompt_qdone47:
adaLN_cond__mha_block__glu_gated_glu__prompt_hasq45:
  v_mov_b32 v204, v200
  v_mov_b32 v205, v201
  v_mov_b32 v206, v202
  s_barrier
  s_add_u32 s52, s52, s55
  s_add_u32 s53, s53, s56
  s_add_u32 s54, s54, s57
  s_mov_b32 s62, 45056
  s_mov_b32 s61, 22528
  s_mov_b32 s63, 2
  s_add_u32 m0, s58, s62
  s_nop 0
  buffer_load_dwordx4 v207, s[8:11], s52 offen sc1 lds
  s_add_u32 m0, s59, s62
  s_nop 0
  buffer_load_dwordx4 v208, s[8:11], s53 offen sc1 lds
  ds_read_b128 v[172:175], v204 offset:0
  ds_read_b64 v[180:181], v205 offset:0
  ds_read_b128 v[184:187], v206 offset:12288
  ds_read_b128 v[188:191], v206 offset:12928
  ds_read_b128 v[176:179], v204 offset:1536
  ds_read_b64 v[182:183], v205 offset:1536
  s_waitcnt lgkmcnt(4)
  v_mfma_f32_32x32x16_bf16 v[28:43], v[172:175], v[16:19], v[140:155]
  v_mfma_f32_32x32x16_bf16 v[60:75], v[172:175], v[22:25], v[156:171]
  v_mfma_f32_32x32x8_bf16 v[28:43], v[180:181], v[20:21], v[28:43]
  v_mfma_f32_32x32x8_bf16 v[60:75], v[180:181], v[26:27], v[60:75]
  v_mov_b32 v4, v226
  v_mov_b32 v5, v227
  v_mov_b32 v6, v228
  v_mov_b32 v7, v229
  s_mov_b32 s3, 0
  s_cmp_eq_u32 s15, 0
  s_cselect_b32 s98, 1, 0
adaLN_cond__mha_block__glu_gated_glu__prompt_aloop48:
  s_setprio 1
  s_waitcnt lgkmcnt(0)
  s_and_b32 s48, s98, 20
  s_cbranch_scc1 adaLN_cond__mha_block__glu_gated_glu__prompt_ev49
adaLN_cond__mha_block__glu_gated_glu__prompt_evb50:
  s_add_u32 m0, s60, s62
  s_nop 0
  buffer_load_dwordx4 v209, s[8:11], s54 offen sc1 lds
adaLN_cond__mha_block__glu_gated_glu__prompt_sk051:
  v_mfma_f32_32x32x16_bf16 v[44:59], v[176:179], v[16:19], v[140:155]
  ds_read_b128 v[172:175], v204 offset:3072
  ds_read_b64 v[180:181], v205 offset:3072
  v_exp_f32 v28, v28
  v_exp_f32 v29, v29
  v_exp_f32 v30, v30
  v_exp_f32 v31, v31
  v_mfma_f32_32x32x16_bf16 v[124:139], v[196:199], v[104:107], v[124:139]
  v_exp_f32 v32, v32
  v_exp_f32 v33, v33
  v_exp_f32 v34, v34
  v_exp_f32 v35, v35
  v_cvt_pk_bf16_f32 v92, v28, v29
  v_cvt_pk_bf16_f32 v93, v30, v31
  v_cvt_pk_bf16_f32 v94, v32, v33
  v_cvt_pk_bf16_f32 v95, v34, v35
  v_mfma_f32_32x32x8_bf16 v[44:59], v[182:183], v[20:21], v[44:59]
  ds_read_b128 v[192:195], v206 offset:13568
  ds_read_b128 v[196:199], v206 offset:14208
  v_exp_f32 v36, v36
  v_exp_f32 v37, v37
  v_exp_f32 v38, v38
  v_exp_f32 v39, v39
  v_mfma_f32_32x32x16_bf16 v[108:123], v[184:187], v[92:95], v[108:123]
  v_exp_f32 v40, v40
  v_exp_f32 v41, v41
  v_exp_f32 v42, v42
  v_exp_f32 v43, v43
  v_cvt_pk_bf16_f32 v96, v36, v37
  v_cvt_pk_bf16_f32 v97, v38, v39
  v_cvt_pk_bf16_f32 v98, v40, v41
  v_cvt_pk_bf16_f32 v99, v42, v43
  v_mfma_f32_32x32x16_bf16 v[76:91], v[176:179], v[22:25], v[156:171]
  v_exp_f32 v60, v60
  v_exp_f32 v61, v61
  v_exp_f32 v62, v62
  v_exp_f32 v63, v63
  v_mfma_f32_32x32x16_bf16 v[108:123], v[188:191], v[96:99], v[108:123]
  v_exp_f32 v64, v64
  v_exp_f32 v65, v65
  v_exp_f32 v66, v66
  v_exp_f32 v67, v67
  v_cvt_pk_bf16_f32 v100, v60, v61
  v_cvt_pk_bf16_f32 v101, v62, v63
  v_cvt_pk_bf16_f32 v102, v64, v65
  v_cvt_pk_bf16_f32 v103, v66, v67
  v_mfma_f32_32x32x8_bf16 v[76:91], v[182:183], v[26:27], v[76:91]
  v_exp_f32 v68, v68
  v_exp_f32 v69, v69
  v_exp_f32 v70, v70
  v_exp_f32 v71, v71
  v_mfma_f32_32x32x16_bf16 v[124:139], v[184:187], v[100:103], v[124:139]
  v_exp_f32 v72, v72
  v_exp_f32 v73, v73
  v_exp_f32 v74, v74
  v_exp_f32 v75, v75
  v_cvt_pk_bf16_f32 v104, v68, v69
  v_cvt_pk_bf16_f32 v105, v70, v71
  v_cvt_pk_bf16_f32 v106, v72, v73
  v_cvt_pk_bf16_f32 v107, v74, v75
  s_setprio 0
  s_waitcnt lgkmcnt(0)
  v_mfma_f32_32x32x16_bf16 v[28:43], v[172:175], v[16:19], v[140:155]
  ds_read_b128 v[176:179], v204 offset:4608
  ds_read_b64 v[182:183], v205 offset:4608
  v_exp_f32 v44, v44
  s_cmp_lg_u32 s3, 99
  v_exp_f32 v45, v45
  s_cselect_b32 s50, 1, 0
  v_exp_f32 v46, v46
  s_add_u32 s63, s63, s50
  v_exp_f32 v47, v47
  s_cmp_le_u32 s63, 7
  v_mfma_f32_32x32x16_bf16 v[124:139], v[188:191], v[104:107], v[124:139]
  v_exp_f32 v48, v48
  s_cselect_b32 s51, s50, 0
  v_exp_f32 v49, v49
  s_mul_i32 s48, s51, s55
  v_exp_f32 v50, v50
  s_add_u32 s52, s52, s48
  v_exp_f32 v51, v51
  s_mul_i32 s48, s51, s56
  v_cvt_pk_bf16_f32 v92, v44, v45
  v_cvt_pk_bf16_f32 v93, v46, v47
  v_cvt_pk_bf16_f32 v94, v48, v49
  v_cvt_pk_bf16_f32 v95, v50, v51
  v_mfma_f32_32x32x8_bf16 v[28:43], v[180:181], v[20:21], v[28:43]
  ds_read_b128 v[184:187], v206 offset:14848
  ds_read_b128 v[188:191], v206 offset:15488
  v_exp_f32 v52, v52
  s_add_u32 s53, s53, s48
  v_exp_f32 v53, v53
  s_mul_i32 s48, s51, s57
  v_exp_f32 v54, v54
  s_add_u32 s54, s54, s48
  v_exp_f32 v55, v55
  s_mul_i32 s48, s50, 22528
  v_mfma_f32_32x32x16_bf16 v[108:123], v[192:195], v[92:95], v[108:123]
  v_exp_f32 v56, v56
  s_add_u32 s62, s62, s48
  v_exp_f32 v57, v57
  s_cmp_ge_u32 s62, 90112
  v_exp_f32 v58, v58
  s_cselect_b32 s48, 90112, 0
  v_exp_f32 v59, v59
  s_sub_u32 s62, s62, s48
  v_cvt_pk_bf16_f32 v96, v52, v53
  v_cvt_pk_bf16_f32 v97, v54, v55
  v_cvt_pk_bf16_f32 v98, v56, v57
  v_cvt_pk_bf16_f32 v99, v58, v59
  v_mfma_f32_32x32x16_bf16 v[60:75], v[172:175], v[22:25], v[156:171]
  v_exp_f32 v76, v76
  v_exp_f32 v77, v77
  v_exp_f32 v78, v78
  v_exp_f32 v79, v79
  v_mfma_f32_32x32x16_bf16 v[108:123], v[196:199], v[96:99], v[108:123]
  v_exp_f32 v80, v80
  v_exp_f32 v81, v81
  v_exp_f32 v82, v82
  v_exp_f32 v83, v83
  v_cvt_pk_bf16_f32 v100, v76, v77
  v_cvt_pk_bf16_f32 v101, v78, v79
  v_cvt_pk_bf16_f32 v102, v80, v81
  v_cvt_pk_bf16_f32 v103, v82, v83
  v_mfma_f32_32x32x8_bf16 v[60:75], v[180:181], v[26:27], v[60:75]
  v_exp_f32 v84, v84
  v_exp_f32 v85, v85
  v_exp_f32 v86, v86
  v_exp_f32 v87, v87
  v_mfma_f32_32x32x16_bf16 v[124:139], v[192:195], v[100:103], v[124:139]
  v_exp_f32 v88, v88
  v_exp_f32 v89, v89
  v_exp_f32 v90, v90
  v_exp_f32 v91, v91
  v_cvt_pk_bf16_f32 v104, v84, v85
  v_cvt_pk_bf16_f32 v105, v86, v87
  v_cvt_pk_bf16_f32 v106, v88, v89
  v_cvt_pk_bf16_f32 v107, v90, v91
  s_setprio 3
  s_waitcnt lgkmcnt(0)
  s_waitcnt vmcnt(3)
  s_barrier
  s_and_b32 s48, s98, 24
  s_cbranch_scc1 adaLN_cond__mha_block__glu_gated_glu__prompt_ev52
adaLN_cond__mha_block__glu_gated_glu__prompt_evb53:
  v_add_u32 v204, s61, v200
  v_add_u32 v205, s61, v201
  s_add_u32 m0, s58, s62
  s_nop 0
  buffer_load_dwordx4 v207, s[8:11], s52 offen sc1 lds
adaLN_cond__mha_block__glu_gated_glu__prompt_sk254:
  v_mfma_f32_32x32x16_bf16 v[44:59], v[176:179], v[16:19], v[140:155]
  ds_read_b128 v[172:175], v204 offset:0
  ds_read_b64 v[180:181], v205 offset:0
  v_exp_f32 v28, v28
  v_exp_f32 v29, v29
  v_exp_f32 v30, v30
  v_exp_f32 v31, v31
  v_mfma_f32_32x32x16_bf16 v[124:139], v[196:199], v[104:107], v[124:139]
  v_exp_f32 v32, v32
  v_exp_f32 v33, v33
  v_exp_f32 v34, v34
  v_exp_f32 v35, v35
  v_cvt_pk_bf16_f32 v92, v28, v29
  v_cvt_pk_bf16_f32 v93, v30, v31
  v_cvt_pk_bf16_f32 v94, v32, v33
  v_cvt_pk_bf16_f32 v95, v34, v35
  v_mfma_f32_32x32x8_bf16 v[44:59], v[182:183], v[20:21], v[44:59]
  ds_read_b128 v[192:195], v206 offset:16128
  ds_read_b128 v[196:199], v206 offset:16768
  v_exp_f32 v36, v36
  v_exp_f32 v37, v37
  v_exp_f32 v38, v38
  v_exp_f32 v39, v39
  v_mfma_f32_32x32x16_bf16 v[108:123], v[184:187], v[92:95], v[108:123]
  v_exp_f32 v40, v40
  v_exp_f32 v41, v41
  v_exp_f32 v42, v42
  v_exp_f32 v43, v43
  v_cvt_pk_bf16_f32 v96, v36, v37
  v_cvt_pk_bf16_f32 v97, v38, v39
  v_cvt_pk_bf16_f32 v98, v40, v41
  v_cvt_pk_bf16_f32 v99, v42, v43
  v_mfma_f32_32x32x16_bf16 v[76:91], v[176:179], v[22:25], v[156:171]
  v_exp_f32 v60, v60
  v_exp_f32 v61, v61
  v_exp_f32 v62, v62
  v_exp_f32 v63, v63
  v_mfma_f32_32x32x16_bf16 v[108:123], v[188:191], v[96:99], v[108:123]
  v_exp_f32 v64, v64
  v_exp_f32 v65, v65
  v_exp_f32 v66, v66
  v_exp_f32 v67, v67
  v_cvt_pk_bf16_f32 v100, v60, v61
  v_cvt_pk_bf16_f32 v101, v62, v63
  v_cvt_pk_bf16_f32 v102, v64, v65
  v_cvt_pk_bf16_f32 v103, v66, v67
  v_mfma_f32_32x32x8_bf16 v[76:91], v[182:183], v[26:27], v[76:91]
  v_exp_f32 v68, v68
  v_exp_f32 v69, v69
  v_exp_f32 v70, v70
  v_exp_f32 v71, v71
  v_mfma_f32_32x32x16_bf16 v[124:139], v[184:187], v[100:103], v[124:139]
  v_exp_f32 v72, v72
  v_exp_f32 v73, v73
  v_exp_f32 v74, v74
  v_exp_f32 v75, v75
  v_cvt_pk_bf16_f32 v104, v68, v69
  v_cvt_pk_bf16_f32 v105, v70, v71
  v_cvt_pk_bf16_f32 v106, v72, v73
  v_cvt_pk_bf16_f32 v107, v74, v75
  s_setprio 2
  s_waitcnt lgkmcnt(0)
  v_mad_u32_u24 v206, v203, s61, v202
  s_add_u32 m0, s59, s62
  s_nop 0
  buffer_load_dwordx4 v208, s[8:11], s53 offen sc1 lds
adaLN_cond__mha_block__glu_gated_glu__prompt_sk355:
  s_and_b32 s48, s98, 3
  s_cbranch_scc1 adaLN_cond__mha_block__glu_gated_glu__prompt_ev56
adaLN_cond__mha_block__glu_gated_glu__prompt_evb57:
  v_mfma_f32_32x32x16_bf16 v[28:43], v[172:175], v[16:19], v[140:155]
  ds_read_b128 v[176:179], v204 offset:1536
  ds_read_b64 v[182:183], v205 offset:1536
  v_exp_f32 v44, v44
  s_add_u32 s61, s61, 22528
  v_exp_f32 v45, v45
  s_cmp_ge_u32 s61, 90112
  v_exp_f32 v46, v46
  s_cselect_b32 s48, 90112, 0
  v_exp_f32 v47, v47
  s_sub_u32 s61, s61, s48
  v_mfma_f32_32x32x16_bf16 v[124:139], v[188:191], v[104:107], v[124:139]
  v_exp_f32 v48, v48
  v_exp_f32 v49, v49
  v_exp_f32 v50, v50
  v_exp_f32 v51, v51
  v_cvt_pk_bf16_f32 v92, v44, v45
  v_cvt_pk_bf16_f32 v93, v46, v47
  v_cvt_pk_bf16_f32 v94, v48, v49
  v_cvt_pk_bf16_f32 v95, v50, v51
  v_mfma_f32_32x32x8_bf16 v[28:43], v[180:181], v[20:21], v[28:43]
  ds_read_b128 v[184:187], v206 offset:12288
  ds_read_b128 v[188:191], v206 offset:12928
  v_exp_f32 v52, v52
  v_exp_f32 v53, v53
  v_exp_f32 v54, v54
  v_exp_f32 v55, v55
  v_mfma_f32_32x32x16_bf16 v[108:123], v[192:195], v[92:95], v[108:123]
  v_exp_f32 v56, v56
  v_exp_f32 v57, v57
  v_exp_f32 v58, v58
  v_exp_f32 v59, v59
  v_cvt_pk_bf16_f32 v96, v52, v53
  v_cvt_pk_bf16_f32 v97, v54, v55
  v_cvt_pk_bf16_f32 v98, v56, v57
  v_cvt_pk_bf16_f32 v99, v58, v59
  v_mfma_f32_32x32x16_bf16 v[60:75], v[172:175], v[22:25], v[156:171]
  v_exp_f32 v76, v76
  v_exp_f32 v77, v77
  v_exp_f32 v78, v78
  v_exp_f32 v79, v79
  v_mfma_f32_32x32x16_bf16 v[108:123], v[196:199], v[96:99], v[108:123]
  v_exp_f32 v80, v80
  v_exp_f32 v81, v81
  v_exp_f32 v82, v82
  v_exp_f32 v83, v83
  v_cvt_pk_bf16_f32 v100, v76, v77
  v_cvt_pk_bf16_f32 v101, v78, v79
  v_cvt_pk_bf16_f32 v102, v80, v81
  v_cvt_pk_bf16_f32 v103, v82, v83
  v_mfma_f32_32x32x8_bf16 v[60:75], v[180:181], v[26:27], v[60:75]
  v_exp_f32 v84, v84
  v_exp_f32 v85, v85
  v_exp_f32 v86, v86
  v_exp_f32 v87, v87
  v_mfma_f32_32x32x16_bf16 v[124:139], v[192:195], v[100:103], v[124:139]
  v_exp_f32 v88, v88
  v_exp_f32 v89, v89
  v_exp_f32 v90, v90
  v_exp_f32 v91, v91
  v_cvt_pk_bf16_f32 v104, v84, v85
  v_cvt_pk_bf16_f32 v105, v86, v87
  v_cvt_pk_bf16_f32 v106, v88, v89
  v_cvt_pk_bf16_f32 v107, v90, v91
  s_lshl_b32 s98, s98, 1
  s_add_u32 s3, s3, 1
  s_cmp_lt_u32 s3, 8
  s_cbranch_scc1 adaLN_cond__mha_block__glu_gated_glu__prompt_aloop48
  s_branch adaLN_cond__mha_block__glu_gated_glu__prompt_evover58
adaLN_cond__mha_block__glu_gated_glu__prompt_ev49:
  s_cmp_lg_u32 s3, 2
  s_cbranch_scc1 adaLN_cond__mha_block__glu_gated_glu__prompt_evn59
  s_cmp_eq_u32 s69, 0
  s_cbranch_scc1 adaLN_cond__mha_block__glu_gated_glu__prompt_ssd60
  v_lshlrev_b32 v11, 4, v1
  buffer_store_dwordx4 v[212:215], v11, s[8:11], s64 offen sc0 sc1
  buffer_store_dwordx4 v[216:219], v11, s[8:11], s65 offen sc0 sc1
  buffer_store_dwordx4 v[220:223], v11, s[8:11], s66 offen sc0 sc1
  buffer_store_dwordx4 v[224:227], v11, s[8:11], s67 offen sc0 sc1
adaLN_cond__mha_block__glu_gated_glu__prompt_ssd60:
  s_branch adaLN_cond__mha_block__glu_gated_glu__prompt_evb50
adaLN_cond__mha_block__glu_gated_glu__prompt_evn59:
  s_cmp_lg_u32 s12, 0
  s_cbranch_scc1 adaLN_cond__mha_block__glu_gated_glu__prompt_cds61
  s_waitcnt vmcnt(2)
  v_readfirstlane_b32 s48, v15
  s_nop 3
  s_cmp_lg_u32 s48, 15
  s_cbranch_scc1 adaLN_cond__mha_block__glu_gated_glu__prompt_cds61n
  s_mov_b32 s48, 26624
  v_mov_b32 v2, 0
  v_mov_b32 v15, 1
  s_mov_b64 exec, 1
  buffer_atomic_add v15, v2, s[8:11], s48 offen sc0 sc1
  s_mov_b64 exec, -1
  s_branch adaLN_cond__mha_block__glu_gated_glu__prompt_cds61
adaLN_cond__mha_block__glu_gated_glu__prompt_cds61n:
  v_mov_b32 v15, 0
adaLN_cond__mha_block__glu_gated_glu__prompt_cds61:
  s_branch adaLN_cond__mha_block__glu_gated_glu__prompt_evb50
adaLN_cond__mha_block__glu_gated_glu__prompt_ev52:
  s_cmp_lg_u32 s3, 3
  s_cbranch_scc1 adaLN_cond__mha_block__glu_gated_glu__prompt_evn62
  s_cmp_lg_u32 s12, 0
  s_cbranch_scc1 adaLN_cond__mha_block__glu_gated_glu__prompt_cds63
  s_and_b32 s48, s2, 15
  s_add_u32 s48, s48, 16
  s_lshl_b32 s48, s48, 8
  s_add_u32 s48, s48, 0
  v_mov_b32 v2, 0
  v_mov_b32 v15, 1
  s_mov_b64 exec, 1
  buffer_atomic_add v15, v2, s[8:11], s48 offen sc0 sc1
  s_mov_b64 exec, -1
  s_branch adaLN_cond__mha_block__glu_gated_glu__prompt_cds63
adaLN_cond__mha_block__glu_gated_glu__prompt_cds63:
  s_branch adaLN_cond__mha_block__glu_gated_glu__prompt_evb53
adaLN_cond__mha_block__glu_gated_glu__prompt_evn62:
  s_cmp_lg_u32 s12, 0
  s_cbranch_scc1 adaLN_cond__mha_block__glu_gated_glu__prompt_cds64
  s_waitcnt vmcnt(1)
  v_readfirstlane_b32 s48, v15
  s_nop 3
  s_cmp_lg_u32 s48, 15
  s_cbranch_scc1 adaLN_cond__mha_block__glu_gated_glu__prompt_cds64n
  s_mov_b32 s48, 44032
  v_mov_b32 v2, 0
  v_mov_b32 v15, 1
  s_mov_b64 exec, 1
  buffer_store_dword v15, v2, s[8:11], s48 offen sc0 sc1
  s_mov_b64 exec, -1
  s_branch adaLN_cond__mha_block__glu_gated_glu__prompt_cds64
adaLN_cond__mha_block__glu_gated_glu__prompt_cds64n:
  v_mov_b32 v15, 0
adaLN_cond__mha_block__glu_gated_glu__prompt_cds64:
  s_branch adaLN_cond__mha_block__glu_gated_glu__prompt_evb53
adaLN_cond__mha_block__glu_gated_glu__prompt_ev56:
  s_cmp_lg_u32 s3, 0
  s_cbranch_scc1 adaLN_cond__mha_block__glu_gated_glu__prompt_evn65
  s_cmp_eq_u32 s69, 0
  s_cbranch_scc1 adaLN_cond__mha_block__glu_gated_glu__prompt_snj66
  s_add_u32 m0, s68, 0
  s_nop 0
  buffer_load_dwordx4 v4, s[44:47], 0 offen nt lds
  s_add_u32 m0, s68, 1024
  s_nop 0
  buffer_load_dwordx4 v5, s[44:47], 0 offen nt lds
  s_add_u32 m0, s68, 2048
  s_nop 0
  buffer_load_dwordx4 v6, s[44:47], 0 offen nt lds
  s_add_u32 m0, s68, 3072
  s_nop 0
  buffer_load_dwordx4 v7, s[44:47], 0 offen nt lds
adaLN_cond__mha_block__glu_gated_glu__prompt_snj66:
  s_branch adaLN_cond__mha_block__glu_gated_glu__prompt_evb57
adaLN_cond__mha_block__glu_gated_glu__prompt_evn65:
  s_cmp_eq_u32 s69, 0
  s_cbranch_scc1 adaLN_cond__mha_block__glu_gated_glu__prompt_std67
  s_waitcnt vmcnt(3)
  v_and_b32 v8, 15, v1
  v_lshrrev_b32 v8, 2, v8
  v_and_b32 v9, 3, v1
  s_cmp_eq_u32 s69, 2
  s_cbranch_scc1 adaLN_cond__mha_block__glu_gated_glu__prompt_stn68
  v_lshrrev_b32 v10, 5, v1
  v_lshl_add_u32 v10, v10, 3, v8
  v_lshlrev_b32 v10, 8, v10
  v_bfe_u32 v11, v1, 4, 1
  v_lshlrev_b32 v11, 5, v11
  v_lshl_add_u32 v11, v9, 3, v11
  v_add3_u32 v10, v10, v11, s68
  ds_read_b64_tr_b16 v[212:213], v10 offset:0
  ds_read_b64_tr_b16 v[214:215], v10 offset:1024
  ds_read_b64_tr_b16 v[216:217], v10 offset:64
  ds_read_b64_tr_b16 v[218:219], v10 offset:1088
  ds_read_b64_tr_b16 v[220:221], v10 offset:128
  ds_read_b64_tr_b16 v[222:223], v10 offset:1152
  ds_read_b64_tr_b16 v[224:225], v10 offset:192
  ds_read_b64_tr_b16 v[226:227], v10 offset:1216
  s_branch adaLN_cond__mha_block__glu_gated_glu__prompt_std67
adaLN_cond__mha_block__glu_gated_glu__prompt_stn68:
  v_lshrrev_b32 v10, 4, v1
  v_lshl_add_u32 v10, v10, 3, v8
  v_lshlrev_b32 v10, 7, v10
  v_lshl_add_u32 v10, v9, 3, v10
  v_add_u32 v10, s68, v10
  ds_read_b64_tr_b16 v[212:213], v10 offset:0
  ds_read_b64_tr_b16 v[214:215], v10 offset:512
  ds_read_b64_tr_b16 v[216:217], v10 offset:32
  ds_read_b64_tr_b16 v[218:219], v10 offset:544
  ds_read_b64_tr_b16 v[220:221], v10 offset:64
  ds_read_b64_tr_b16 v[222:223], v10 offset:576
  ds_read_b64_tr_b16 v[224:225], v10 offset:96
  ds_read_b64_tr_b16 v[226:227], v10 offset:608
adaLN_cond__mha_block__glu_gated_glu__prompt_std67:
  s_branch adaLN_cond__mha_block__glu_gated_glu__prompt_evb57
adaLN_cond__mha_block__glu_gated_glu__prompt_evover58:
  v_mfma_f32_32x32x16_bf16 v[124:139], v[196:199], v[104:107], v[124:139]
  s_setprio 0
  s_waitcnt vmcnt(0) lgkmcnt(0)
  s_barrier
  s_mul_i32 s48, s12, 3072
  v_lshlrev_b32 v2, 4, v1
  v_add_u32 v3, s48, v2
  s_cmp_eq_u32 s6, 1
  s_cbranch_scc1 adaLN_cond__mha_block__glu_gated_glu__prompt_mg169
  s_nop 3
  ds_write_b128 v3, v[124:127] offset:0
  ds_write_b128 v3, v[128:131] offset:1024
  ds_write_b128 v3, v[132:135] offset:2048
  s_branch adaLN_cond__mha_block__glu_gated_glu__prompt_msent70
adaLN_cond__mha_block__glu_gated_glu__prompt_mg169:
  ds_write_b128 v3, v[108:111] offset:0
  ds_write_b128 v3, v[112:115] offset:1024
  ds_write_b128 v3, v[116:119] offset:2048
adaLN_cond__mha_block__glu_gated_glu__prompt_msent70:
  s_waitcnt lgkmcnt(0)
  s_barrier
  s_xor_b32 s48, s12, 4
  s_mul_i32 s48, s48, 3072
  v_add_u32 v3, s48, v2
  ds_read_b128 v[212:215], v3 offset:0
  ds_read_b128 v[216:219], v3 offset:1024
  ds_read_b128 v[220:223], v3 offset:2048
  s_waitcnt lgkmcnt(0)
  s_cmp_eq_u32 s6, 1
  s_cbranch_scc1 adaLN_cond__mha_block__glu_gated_glu__prompt_mg1b71
  v_add_f32 v212, v212, v108
  v_add_f32 v213, v213, v109
  v_add_f32 v214, v214, v110
  v_add_f32 v215, v215, v111
  v_add_f32 v216, v216, v112
  v_add_f32 v217, v217, v113
  v_add_f32 v218, v218, v114
  v_add_f32 v219, v219, v115
  v_add_f32 v220, v220, v116
  v_add_f32 v221, v221, v117
  v_add_f32 v222, v222, v118
  v_add_f32 v223, v223, v119
  s_branch adaLN_cond__mha_block__glu_gated_glu__prompt_mgot72
adaLN_cond__mha_block__glu_gated_glu__prompt_mg1b71:
  v_add_f32 v212, v212, v124
  v_add_f32 v213, v213, v125
  v_add_f32 v214, v214, v126
  v_add_f32 v215, v215, v127
  v_add_f32 v216, v216, v128
  v_add_f32 v217, v217, v129
  v_add_f32 v218, v218, v130
  v_add_f32 v219, v219, v131
  v_add_f32 v220, v220, v132
  v_add_f32 v221, v221, v133
  v_add_f32 v222, v222, v134
  v_add_f32 v223, v223, v135
adaLN_cond__mha_block__glu_gated_glu__prompt_mgot72:
  v_mov_b32 v2, v220
  v_mov_b32 v224, v220
  s_nop 1
  v_permlane32_swap_b32 v2, v224
  s_cmp_lg_u32 s15, 0
  s_cbranch_scc1 adaLN_cond__mha_block__glu_gated_glu__prompt_fin42
  v_add_f32 v2, |v212|, |v213|
  v_add_f32 v2, v2, |v214|
  v_add_f32 v2, v2, |v215|
  v_add_f32 v2, v2, |v216|
  v_add_f32 v2, v2, |v217|
  v_add_f32 v2, v2, |v218|
  v_add_f32 v2, v2, |v219|
  v_add_f32 v2, v2, |v220|
  v_add_f32 v2, v2, |v221|
  v_add_f32 v2, v2, |v222|
  v_add_f32 v2, v2, |v223|
  v_mov_b32 v3, 0x17800000
  v_mov_b32 v4, 0x71800000
  v_mov_b32 v5, 0x7f800000
  v_cmp_le_f32 s[48:49], v3, v224
  v_cmp_ge_f32 s[50:51], v4, v224
  v_cmp_lt_f32 vcc, v2, v5
  s_nop 2
  s_and_b64 s[48:49], s[48:49], s[50:51]
  s_and_b64 s[48:49], s[48:49], vcc
  s_cmp_eq_u64 s[48:49], exec
  s_cbranch_scc1 adaLN_cond__mha_block__glu_gated_glu__prompt_good43
  v_mov_b32 v2, 95232
  v_mov_b32 v3, 1
  ds_write_b32 v2, v3
adaLN_cond__mha_block__glu_gated_glu__prompt_good43:
  s_waitcnt lgkmcnt(0)
  s_barrier
  v_mov_b32 v2, 95232
  ds_read_b32 v3, v2
  s_waitcnt lgkmcnt(0)
  v_readfirstlane_b32 s48, v3
  s_nop 3
  s_cmp_eq_u32 s48, 0
  s_cbranch_scc1 adaLN_cond__mha_block__glu_gated_glu__prompt_fin42
  v_mov_b32 v140, 0
  v_mov_b32 v156, 0
  v_mov_b32 v141, 0
  v_mov_b32 v157, 0
  v_mov_b32 v142, 0
  v_mov_b32 v158, 0
  v_mov_b32 v143, 0
  v_mov_b32 v159, 0
  v_mov_b32 v144, 0
  v_mov_b32 v160, 0
  v_mov_b32 v145, 0
  v_mov_b32 v161, 0
  v_mov_b32 v146, 0
  v_mov_b32 v162, 0
  v_mov_b32 v147, 0
  v_mov_b32 v163, 0
  v_mov_b32 v148, 0
  v_mov_b32 v164, 0
  v_mov_b32 v149, 0
  v_mov_b32 v165, 0
  v_mov_b32 v150, 0
  v_mov_b32 v166, 0
  v_mov_b32 v151, 0
  v_mov_b32 v167, 0
  v_mov_b32 v152, 0
  v_mov_b32 v168, 0
  v_mov_b32 v153, 0
  v_mov_b32 v169, 0
  v_mov_b32 v154, 0
  v_mov_b32 v170, 0
  v_mov_b32 v155, 0
  v_mov_b32 v171, 0
  s_mul_i32 s48, s4, 81920
  s_add_u32 s49, s48, 14708736
  s_add_u32 s50, s7, 12087296
  s_cmp_eq_u32 s55, 10240
  s_cselect_b32 s52, s49, s50
  s_cmp_eq_u32 s56, 10240
  s_cselect_b32 s53, s49, s50
  s_cmp_eq_u32 s57, 10240
  s_cselect_b32 s54, s49, s50
  s_mov_b32 s62, 0
  s_add_u32 m0, s58, s62
  s_nop 0
  buffer_load_dwordx4 v207, s[8:11], s52 offen sc1 lds
  s_add_u32 m0, s59, s62
  s_nop 0
  buffer_load_dwordx4 v208, s[8:11], s53 offen sc1 lds
  s_add_u32 m0, s60, s62
  s_nop 0
  buffer_load_dwordx4 v209, s[8:11], s54 offen sc1 lds
  s_add_u32 s52, s52, s55
  s_add_u32 s53, s53, s56
  s_add_u32 s54, s54, s57
  s_mov_b32 s62, 22528
  s_add_u32 m0, s58, s62
  s_nop 0
  buffer_load_dwordx4 v207, s[8:11], s52 offen sc1 lds
  s_add_u32 m0, s59, s62
  s_nop 0
  buffer_load_dwordx4 v208, s[8:11], s53 offen sc1 lds
  s_add_u32 m0, s60, s62
  s_nop 0
  buffer_load_dwordx4 v209, s[8:11], s54 offen sc1 lds
  s_waitcnt vmcnt(3)
  v_mov_b32 v204, v200
  v_mov_b32 v205, v201
  v_mov_b32 v206, v202
  s_barrier
  s_add_u32 s52, s52, s55
  s_add_u32 s53, s53, s56
  s_add_u32 s54, s54, s57
  s_mov_b32 s62, 45056
  s_mov_b32 s61, 22528
  s_mov_b32 s63, 2
  s_add_u32 m0, s58, s62
  s_nop 0
  buffer_load_dwordx4 v207, s[8:11], s52 offen sc1 lds
  s_add_u32 m0, s59, s62
  s_nop 0
  buffer_load_dwordx4 v208, s[8:11], s53 offen sc1 lds
  v_mov_b32 v210, 0xff800000
  v_mov_b32 v211, 0xff800000
  s_mov_b32 s3, 0
adaLN_cond__mha_block__glu_gated_glu__prompt_mloop73:
  s_add_u32 m0, s60, s62
  s_nop 0
  buffer_load_dwordx4 v209, s[8:11], s54 offen sc1 lds
  ds_read_b128 v[172:175], v204 offset:0
  ds_read_b64 v[180:181], v205 offset:0
  s_waitcnt lgkmcnt(0)
  v_mfma_f32_32x32x16_bf16 v[28:43], v[172:175], v[16:19], v[140:155]
  v_mfma_f32_32x32x16_bf16 v[60:75], v[172:175], v[22:25], v[156:171]
  v_mfma_f32_32x32x8_bf16 v[28:43], v[180:181], v[20:21], v[28:43]
  v_mfma_f32_32x32x8_bf16 v[60:75], v[180:181], v[26:27], v[60:75]
  s_nop 10
  v_max3_f32 v210, v28, v29, v210
  v_max3_f32 v210, v30, v31, v210
  v_max3_f32 v210, v32, v33, v210
  v_max3_f32 v210, v34, v35, v210
  v_max3_f32 v210, v36, v37, v210
  v_max3_f32 v210, v38, v39, v210
  v_max3_f32 v210, v40, v41, v210
  v_max3_f32 v210, v42, v43, v210
  v_max3_f32 v211, v60, v61, v211
  v_max3_f32 v211, v62, v63, v211
  v_max3_f32 v211, v64, v65, v211
  v_max3_f32 v211, v66, v67, v211
  v_max3_f32 v211, v68, v69, v211
  v_max3_f32 v211, v70, v71, v211
  v_max3_f32 v211, v72, v73, v211
  v_max3_f32 v211, v74, v75, v211
  ds_read_b128 v[172:175], v204 offset:1536
  ds_read_b64 v[180:181], v205 offset:1536
  s_waitcnt lgkmcnt(0)
  v_mfma_f32_32x32x16_bf16 v[28:43], v[172:175], v[16:19], v[140:155]
  v_mfma_f32_32x32x16_bf16 v[60:75], v[172:175], v[22:25], v[156:171]
  v_mfma_f32_32x32x8_bf16 v[28:43], v[180:181], v[20:21], v[28:43]
  v_mfma_f32_32x32x8_bf16 v[60:75], v[180:181], v[26:27], v[60:75]
  s_nop 10
  v_max3_f32 v210, v28, v29, v210
  v_max3_f32 v210, v30, v31, v210
  v_max3_f32 v210, v32, v33, v210
  s_nop 7
  v_max3_f32 v210, v34, v35, v210
  v_max3_f32 v210, v36, v37, v210
  v_max3_f32 v210, v38, v39, v210
  v_max3_f32 v210, v40, v41, v210
  v_max3_f32 v210, v42, v43, v210
  v_max3_f32 v211, v60, v61, v211
  v_max3_f32 v211, v62, v63, v211
  v_max3_f32 v211, v64, v65, v211
  v_max3_f32 v211, v66, v67, v211
  v_max3_f32 v211, v68, v69, v211
  v_max3_f32 v211, v70, v71, v211
  v_max3_f32 v211, v72, v73, v211
  v_max3_f32 v211, v74, v75, v211
  ds_read_b128 v[172:175], v204 offset:3072
  ds_read_b64 v[180:181], v205 offset:3072
  s_waitcnt lgkmcnt(0)
  v_mfma_f32_32x32x16_bf16 v[28:43], v[172:175], v[16:19], v[140:155]
  v_mfma_f32_32x32x16_bf16 v[60:75], v[172:175], v[22:25], v[156:171]
  v_mfma_f32_32x32x8_bf16 v[28:43], v[180:181], v[20:21], v[28:43]
  v_mfma_f32_32x32x8_bf16 v[60:75], v[180:181], v[26:27], v[60:75]
  s_nop 10
  v_max3_f32 v210, v28, v29, v210
  v_max3_f32 v210, v30, v31, v210
  s_nop 8
  v_max3_f32 v210, v32, v33, v210
  v_max3_f32 v210, v34, v35, v210
  v_max3_f32 v210, v36, v37, v210
  v_max3_f32 v210, v38, v39, v210
  s_nop 4
  v_max3_f32 v210, v40, v41, v210
  v_max3_f32 v210, v42, v43, v210
  v_max3_f32 v211, v60, v61, v211
  v_max3_f32 v211, v62, v63, v211
  v_max3_f32 v211, v64, v65, v211
  v_max3_f32 v211, v66, v67, v211
  v_max3_f32 v211, v68, v69, v211
  v_max3_f32 v211, v70, v71, v211
  v_max3_f32 v211, v72, v73, v211
  v_max3_f32 v211, v74, v75, v211
  ds_read_b128 v[172:175], v204 offset:4608
  ds_read_b64 v[180:181], v205 offset:4608
  s_waitcnt lgkmcnt(0)
  v_mfma_f32_32x32x16_bf16 v[28:43], v[172:175], v[16:19], v[140:155]
  v_mfma_f32_32x32x16_bf16 v[60:75], v[172:175], v[22:25], v[156:171]
  v_mfma_f32_32x32x8_bf16 v[28:43], v[180:181], v[20:21], v[28:43]
  v_mfma_f32_32x32x8_bf16 v[60:75], v[180:181], v[26:27], v[60:75]
  s_nop 10
  v_max3_f32 v210, v28, v29, v210
  s_nop 9
  v_max3_f32 v210, v30, v31, v210
  v_max3_f32 v210, v32, v33, v210
  v_max3_f32 v210, v34, v35, v210
  s_nop 6
  v_max3_f32 v210, v36, v37, v210
  v_max3_f32 v210, v38, v39, v210
  v_max3_f32 v210, v40, v41, v210
  v_max3_f32 v210, v42, v43, v210
  v_max3_f32 v211, v60, v61, v211
  s_nop 2
  v_max3_f32 v211, v62, v63, v211
  v_max3_f32 v211, v64, v65, v211
  v_max3_f32 v211, v66, v67, v211
  v_max3_f32 v211, v68, v69, v211
  v_max3_f32 v211, v70, v71, v211
  v_max3_f32 v211, v72, v73, v211
  v_max3_f32 v211, v74, v75, v211
  s_waitcnt vmcnt(3)
  s_barrier
  v_add_u32 v204, s61, v200
  v_add_u32 v205, s61, v201
  s_add_u32 s63, s63, 1
  s_cmp_le_u32 s63, 7
  s_cselect_b32 s48, s55, 0
  s_add_u32 s52, s52, s48
  s_cmp_le_u32 s63, 7
  s_cselect_b32 s48, s56, 0
  s_add_u32 s53, s53, s48
  s_cmp_le_u32 s63, 7
  s_cselect_b32 s48, s57, 0
  s_add_u32 s54, s54, s48
  s_cmp_le_u32 s63, 7
  s_add_u32 s62, s62, 22528
  s_cmp_ge_u32 s62, 90112
  s_cselect_b32 s48, 90112, 0
  s_sub_u32 s62, s62, s48
  s_add_u32 m0, s58, s62
  s_nop 0
  buffer_load_dwordx4 v207, s[8:11], s52 offen sc1 lds
  s_add_u32 m0, s59, s62
  s_nop 0
  buffer_load_dwordx4 v208, s[8:11], s53 offen sc1 lds
  s_add_u32 s61, s61, 22528
  s_cmp_ge_u32 s61, 90112
  s_cselect_b32 s48, 90112, 0
  s_sub_u32 s61, s61, s48
  s_add_u32 s3, s3, 1
  s_cmp_lt_u32 s3, 8
  s_cbranch_scc1 adaLN_cond__mha_block__glu_gated_glu__prompt_mloop73
  s_waitcnt vmcnt(0) lgkmcnt(0)
  s_barrier
  v_mov_b32 v2, v210
  s_nop 1
  v_permlane32_swap_b32 v2, v210
  v_max_f32 v210, v2, v210
  v_mov_b32 v2, v211
  s_nop 1
  v_permlane32_swap_b32 v2, v211
  v_max_f32 v211, v2, v211
  s_lshl_b32 s48, s12, 9
  v_lshlrev_b32 v2, 3, v1
  v_add_u32 v3, s48, v2
  ds_write_b64 v3, v[210:211]
  s_waitcnt lgkmcnt(0)
  s_barrier
  s_xor_b32 s48, s12, 4
  s_lshl_b32 s48, s48, 9
  v_add_u32 v3, s48, v2
  ds_read_b64 v[4:5], v3
  s_waitcnt lgkmcnt(0)
  v_max_f32 v4, v4, v210
  v_max_f32 v5, v5, v211
  v_sub_f32 v4, 0, v4
  v_sub_f32 v5, 0, v5
  v_mov_b32 v140, v4
  v_mov_b32 v156, v5
  v_mov_b32 v141, v4
  v_mov_b32 v157, v5
  v_mov_b32 v142, v4
  v_mov_b32 v158, v5
  v_mov_b32 v143, v4
  v_mov_b32 v159, v5
  v_mov_b32 v144, v4
  v_mov_b32 v160, v5
  v_mov_b32 v145, v4
  v_mov_b32 v161, v5
  v_mov_b32 v146, v4
  v_mov_b32 v162, v5
  v_mov_b32 v147, v4
  v_mov_b32 v163, v5
  v_mov_b32 v148, v4
  v_mov_b32 v164, v5
  v_mov_b32 v149, v4
  v_mov_b32 v165, v5
  v_mov_b32 v150, v4
  v_mov_b32 v166, v5
  v_mov_b32 v151, v4
  v_mov_b32 v167, v5
  v_mov_b32 v152, v4
  v_mov_b32 v168, v5
  v_mov_b32 v153, v4
  v_mov_b32 v169, v5
  v_mov_b32 v154, v4
  v_mov_b32 v170, v5
  v_mov_b32 v155, v4
  v_mov_b32 v171, v5
  s_barrier
  v_mov_b32 v108, 0
  v_mov_b32 v124, 0
  v_mov_b32 v109, 0
  v_mov_b32 v125, 0
  v_mov_b32 v110, 0
  v_mov_b32 v126, 0
  v_mov_b32 v111, 0
  v_mov_b32 v127, 0
  v_mov_b32 v112, 0
  v_mov_b32 v128, 0
  v_mov_b32 v113, 0
  v_mov_b32 v129, 0
  v_mov_b32 v114, 0
  v_mov_b32 v130, 0
  v_mov_b32 v115, 0
  v_mov_b32 v131, 0
  v_mov_b32 v116, 0
  v_mov_b32 v132, 0
  v_mov_b32 v117, 0
  v_mov_b32 v133, 0
  v_mov_b32 v118, 0
  v_mov_b32 v134, 0
  v_mov_b32 v119, 0
  v_mov_b32 v135, 0
  v_mov_b32 v120, 0
  v_mov_b32 v136, 0
  v_mov_b32 v121, 0
  v_mov_b32 v137, 0
  v_mov_b32 v122, 0
  v_mov_b32 v138, 0
  v_mov_b32 v123, 0
  v_mov_b32 v139, 0
  v_mov_b32 v104, 0
  v_mov_b32 v196, 0
  v_mov_b32 v105, 0
  v_mov_b32 v197, 0
  v_mov_b32 v106, 0
  v_mov_b32 v198, 0
  v_mov_b32 v107, 0
  v_mov_b32 v199, 0
  s_mov_b32 s15, 1
  s_branch adaLN_cond__mha_block__glu_gated_glu__prompt_again41
adaLN_cond__mha_block__glu_gated_glu__prompt_fin42:
  v_rcp_f32 v2, v224
  s_nop 0
  v_mul_f32 v212, v2, v212
  v_mul_f32 v213, v2, v213
  v_mul_f32 v214, v2, v214
  v_mul_f32 v215, v2, v215
  v_mul_f32 v216, v2, v216
  v_mul_f32 v217, v2, v217
  v_mul_f32 v218, v2, v218
  v_mul_f32 v219, v2, v219
  v_mul_f32 v220, v2, v220
  v_mul_f32 v221, v2, v221
  v_mul_f32 v222, v2, v222
  v_mul_f32 v223, v2, v223
  v_cvt_pk_bf16_f32 v92, v212, v213
  v_cvt_pk_bf16_f32 v93, v214, v215
  v_cvt_pk_bf16_f32 v94, v216, v217
  v_cvt_pk_bf16_f32 v95, v218, v219
  v_cvt_pk_bf16_f32 v96, v220, v221
  v_cvt_pk_bf16_f32 v97, v222, v223
  v_permlane32_swap_b32 v92, v94
  v_permlane32_swap_b32 v93, v95
  v_and_b32 v2, 31, v1
  v_lshrrev_b32 v3, 4, v2
  v_mul_u32_u24 v3, 0x5000, v3
  v_and_b32 v4, 15, v2
  v_lshl_add_u32 v3, v4, 4, v3
  v_lshrrev_b32 v5, 5, v1
  v_lshl_add_u32 v5, v5, 8, v3
  s_lshl_b32 s48, s5, 3
  s_and_b32 s49, s12, 3
  s_lshl_b32 s49, s49, 1
  s_add_u32 s48, s48, s49
  s_add_u32 s48, s48, s6
  s_lshl_b32 s48, s48, 1
  s_mul_i32 s48, s48, 0x5000
  s_add_u32 s48, s48, 17330176
  s_lshr_b32 s49, s4, 1
  s_mul_i32 s49, s49, 1280
  s_add_u32 s48, s48, s49
  s_and_b32 s50, s4, 1
  s_lshl_b32 s51, s50, 9
  s_add_u32 s51, s51, s48
  s_lshl_b32 s50, s50, 3
  s_add_u32 s50, s50, s48
  s_add_u32 s50, s50, 1024
  buffer_store_dwordx4 v[92:95], v5, s[8:11], s51 offen sc0 sc1
  v_cmp_gt_u32 vcc, 32, v1
  s_nop 3
  s_and_saveexec_b64 s[48:49], vcc
  buffer_store_dwordx2 v[96:97], v3, s[8:11], s50 offen sc0 sc1
  s_mov_b64 exec, s[48:49]
  s_cmp_lg_u32 s12, 0
  s_cbranch_scc1 adaLN_cond__mha_block__glu_gated_glu__prompt_nogd74
  v_mov_b32 v7, 44032
  v_mov_b32 v6, 1
  s_mov_b32 s49, 0
  s_mov_b32 s50, 0
adaLN_cond__mha_block__glu_gated_glu__prompt_poll75:
  buffer_load_dword v8, v7, s[8:11], s49 offen sc1
  s_waitcnt vmcnt(0)
  v_cmp_lt_u32 vcc, v8, v6
  s_nop 3
  s_cmp_eq_u64 vcc, 0
  s_cbranch_scc1 adaLN_cond__mha_block__glu_gated_glu__prompt_polled76
  s_add_u32 s50, s50, 1
  s_cmp_ge_u32 s50, 200000
  s_cbranch_scc1 adaLN_cond__mha_block__glu_gated_glu__prompt_polled76
  s_sleep 2
  s_branch adaLN_cond__mha_block__glu_gated_glu__prompt_poll75
adaLN_cond__mha_block__glu_gated_glu__prompt_polled76:
adaLN_cond__mha_block__glu_gated_glu__prompt_nogd74:
  s_waitcnt vmcnt(0)
  s_barrier
  s_cmp_lg_u32 s12, 0
  s_cbranch_scc1 adaLN_cond__mha_block__glu_gated_glu__prompt_s23w077
  s_add_u32 s52, s5, 32
  s_add_u32 s53, s5, 124
  s_lshl_b32 s48, s52, 8
  s_add_u32 s48, s48, 0
  v_mov_b32 v2, 0
  v_mov_b32 v3, 1
  s_mov_b64 exec, 1
  buffer_atomic_add v3, v2, s[8:11], s48 offen sc0 sc1
  s_waitcnt vmcnt(0)
  s_mov_b64 exec, -1
  v_readfirstlane_b32 s49, v3
  s_nop 3
  s_cmp_lg_u32 s49, 31
  s_cbranch_scc1 adaLN_cond__mha_block__glu_gated_glu__prompt_arr79
  s_lshl_b32 s48, s53, 8
  s_add_u32 s48, s48, 0
  v_lshlrev_b32 v2, 8, v1
  v_mov_b32 v3, 1
  s_mov_b32 exec_lo, 0x1
  s_mov_b32 exec_hi, 0
  buffer_store_dword v3, v2, s[8:11], s48 offen sc0 sc1
  s_mov_b64 exec, -1
adaLN_cond__mha_block__glu_gated_glu__prompt_arr79:
  s_lshl_b32 s48, s13, 2
  s_and_b32 s49, s14, 3
  s_add_u32 s4, s48, s49
  s_lshr_b32 s5, s14, 2
  s_and_b32 s48, s13, 1
  s_lshl_b32 s48, s48, 3
  s_and_b32 s49, s14, 7
  s_add_u32 s6, s48, s49
  s_lshr_b32 s48, s13, 1
  s_lshl_b32 s48, s48, 2
  s_lshr_b32 s49, s14, 3
  s_add_u32 s7, s48, s49
  s_lshr_b32 s52, s4, 2
  s_add_u32 s52, s52, 124
  v_mov_b32 v5, 0
  v_mov_b32 v6, 0
  s_mov_b32 s51, s52
  v_add_u32 v7, s51, v1
  v_lshlrev_b32 v7, 8, v7
  v_subrev_u32 v8, 0, v1
  v_cmp_gt_u32 vcc, 1, v8
  s_nop 1
  v_cndmask_b32 v5, v5, v7, vcc
  v_mov_b32 v7, 1
  v_cndmask_b32 v6, v6, v7, vcc
  s_mov_b32 s49, 0
  s_mov_b32 s50, 0
adaLN_cond__mha_block__glu_gated_glu__prompt_poll80:
  buffer_load_dword v4, v5, s[8:11], s49 offen sc1
  s_waitcnt vmcnt(0)
  v_cmp_lt_u32 vcc, v4, v6
  s_nop 3
  s_cmp_eq_u64 vcc, 0
  s_cbranch_scc1 adaLN_cond__mha_block__glu_gated_glu__prompt_polled81
  s_add_u32 s50, s50, 1
  s_cmp_ge_u32 s50, 200000
  s_cbranch_scc1 adaLN_cond__mha_block__glu_gated_glu__prompt_polled81
  s_sleep 2
  s_branch adaLN_cond__mha_block__glu_gated_glu__prompt_poll80
adaLN_cond__mha_block__glu_gated_glu__prompt_polled81:
  s_branch adaLN_cond__mha_block__glu_gated_glu__prompt_s23r78
adaLN_cond__mha_block__glu_gated_glu__prompt_s23w077:
  s_lshl_b32 s48, s13, 2
  s_and_b32 s49, s14, 3
  s_add_u32 s4, s48, s49
  s_lshr_b32 s5, s14, 2
  s_and_b32 s48, s13, 1
  s_lshl_b32 s48, s48, 3
  s_and_b32 s49, s14, 7
  s_add_u32 s6, s48, s49
  s_lshr_b32 s48, s13, 1
  s_lshl_b32 s48, s48, 2
  s_lshr_b32 s49, s14, 3
  s_add_u32 s7, s48, s49
  s_mul_i32 s52, s5, 102400
  s_add_u32 s52, s52, 6680576
  s_sub_u32 s53, s12, 1
  s_lshl_b32 s53, s53, 10
  s_add_u32 s52, s52, s53
  s_add_u32 s53, s53, 49152
  v_lshlrev_b32 v9, 4, v1
  s_sub_u32 s54, s12, 1
adaLN_cond__mha_block__glu_gated_glu__prompt_wop82:
  s_mov_b32 m0, s53
  s_add_u32 s53, s53, 7168
  buffer_load_dwordx4 v9, s[8:11], s52 offen sc1 lds
  s_add_u32 s52, s52, 7168
  s_add_u32 s54, s54, 7
  s_cmp_lt_u32 s54, 100
  s_cbranch_scc1 adaLN_cond__mha_block__glu_gated_glu__prompt_wop82
  s_cmp_lg_u32 s12, 7
  s_cbranch_scc1 adaLN_cond__mha_block__glu_gated_glu__prompt_nov383
  s_movk_i32 s52, 3277
  v_mul_u32_u24 v6, s52, v1
  v_lshrrev_b32 v6, 16, v6
  v_mad_i32_i24 v7, v6, -16, v1
  v_mad_i32_i24 v7, v6, -4, v7
  v_mov_b32 v8, 5120
  v_mov_b32 v10, 0
  v_cmp_eq_u32 vcc, 1, v6
  v_mov_b32 v9, 10240
  s_nop 0
  v_cndmask_b32 v8, v8, v9, vcc
  v_mov_b32 v9, 1.0
  v_cndmask_b32 v10, v10, v9, vcc
  s_mul_i32 s52, s5, 320
  s_add_u32 s52, s52, 50176
  v_lshl_add_u32 v8, v7, 4, v8
  buffer_load_dwordx4 v[12:15], v8, s[8:11], s52 offen sc1
  s_waitcnt vmcnt(0)
  v_add_f32 v12, v12, v10
  v_add_f32 v13, v13, v10
  v_add_f32 v14, v14, v10
  v_add_f32 v15, v15, v10
  v_lshlrev_b32 v9, 4, v1
  v_add_u32 v9, 151552, v9
  v_cmp_gt_u32 vcc, 40, v1
  s_nop 3
  s_and_saveexec_b64 s[52:53], vcc
  ds_write_b128 v9, v[12:15]
  s_mov_b64 exec, s[52:53]
  s_waitcnt lgkmcnt(0)
adaLN_cond__mha_block__glu_gated_glu__prompt_nov383:
  s_waitcnt vmcnt(0)
adaLN_cond__mha_block__glu_gated_glu__prompt_s23r78:
  s_barrier
  s_cmp_ge_u32 s12, 4
  s_cbranch_scc1 adaLN_cond__mha_block__glu_gated_glu__prompt_prod384
  v_and_b32 v3, 15, v1
  v_lshrrev_b32 v4, 4, v1
  v_lshlrev_b32 v5, 4, v1
  s_lshl_b32 s15, s4, 2
  s_add_u32 s15, s15, s12
  s_lshl_b32 s52, s15, 4
  v_add_u32 v6, s52, v3
  s_movk_i32 s52, 1280
  v_mul_u32_u24 v6, s52, v6
  s_mul_i32 s52, s5, 160
  v_lshl_add_u32 v6, v4, 3, v6
  v_add_u32 v6, s52, v6
  v_add_u32 v8, 0x10000, v5
  v_add_u32 v9, 0x20000, v5
  s_lshr_b32 s56, s15, 1
  s_mul_i32 s56, s56, 40960
  s_mul_i32 s57, s5, 5120
  s_add_u32 s56, s56, s57
  s_and_b32 s57, s15, 1
  s_lshl_b32 s57, s57, 8
  s_add_u32 s56, s56, s57
  s_add_u32 s59, s56, 126976
  v_lshrrev_b32 v11, 1, v4
  v_lshlrev_b32 v11, 9, v11
  v_lshl_add_u32 v11, v3, 4, v11
  v_and_b32 v12, 1, v4
  v_lshl_add_u32 v11, v12, 3, v11
  s_lshl_b32 s60, s15, 7
  s_add_u32 s60, s60, 110592
  v_lshlrev_b32 v12, 3, v3
  s_mul_i32 s53, s15, 20480
  s_add_u32 s53, s53, 17330176
  s_add_u32 s54, s53, 0
  buffer_load_dwordx4 v[40:43], v5, s[8:11], s54 offen offset:0 sc1
  buffer_load_dwordx4 v[44:47], v5, s[8:11], s54 offen offset:1024 sc1
  buffer_load_dwordx4 v[48:51], v5, s[8:11], s54 offen offset:2048 sc1
  buffer_load_dwordx4 v[52:55], v5, s[8:11], s54 offen offset:3072 sc1
  s_add_u32 s54, s53, 4096
  buffer_load_dwordx4 v[56:59], v5, s[8:11], s54 offen offset:0 sc1
  buffer_load_dwordx4 v[60:63], v5, s[8:11], s54 offen offset:1024 sc1
  buffer_load_dwordx4 v[64:67], v5, s[8:11], s54 offen offset:2048 sc1
  buffer_load_dwordx4 v[68:71], v5, s[8:11], s54 offen offset:3072 sc1
  s_add_u32 s54, s53, 8192
  buffer_load_dwordx4 v[72:75], v5, s[8:11], s54 offen offset:0 sc1
  buffer_load_dwordx4 v[76:79], v5, s[8:11], s54 offen offset:1024 sc1
  buffer_load_dwordx4 v[80:83], v5, s[8:11], s54 offen offset:2048 sc1
  buffer_load_dwordx4 v[84:87], v5, s[8:11], s54 offen offset:3072 sc1
  s_add_u32 s54, s53, 12288
  buffer_load_dwordx4 v[88:91], v5, s[8:11], s54 offen offset:0 sc1
  buffer_load_dwordx4 v[92:95], v5, s[8:11], s54 offen offset:1024 sc1
  s_add_u32 s56, s59, 0
  buffer_load_dwordx2 v[144:145], v11, s[8:11], s56 offen sc1
  s_add_u32 s56, s59, 1024
  buffer_load_dwordx2 v[146:147], v11, s[8:11], s56 offen sc1
  s_add_u32 s56, s59, 2048
  buffer_load_dwordx2 v[148:149], v11, s[8:11], s56 offen sc1
  s_add_u32 s56, s59, 3072
  buffer_load_dwordx2 v[150:151], v11, s[8:11], s56 offen sc1
  s_add_u32 s56, s59, 4096
  buffer_load_dwordx2 v[152:153], v11, s[8:11], s56 offen sc1
  buffer_load_dwordx2 v[154:155], v12, s[8:11], s60 offen sc1
  v_mov_b32 v16, 0
  v_mov_b32 v17, 0
  v_mov_b32 v18, 0
  v_mov_b32 v19, 0
  v_mov_b32 v20, 0
  v_mov_b32 v21, 0
  v_mov_b32 v22, 0
  v_mov_b32 v23, 0
  v_mov_b32 v24, 0
  v_mov_b32 v25, 0
  v_mov_b32 v26, 0
  v_mov_b32 v27, 0
  v_mov_b32 v28, 0
  v_mov_b32 v29, 0
  v_mov_b32 v30, 0
  v_mov_b32 v31, 0
  v_mov_b32 v32, 0
  v_mov_b32 v33, 0
  v_mov_b32 v34, 0
  v_mov_b32 v35, 0
  ds_read_b128 v[104:107], v5 offset:49152
  ds_read_b128 v[108:111], v5 offset:50176
  ds_read_b128 v[112:115], v5 offset:51200
  ds_read_b128 v[116:119], v5 offset:52224
  ds_read_b128 v[120:123], v5 offset:53248
  s_waitcnt vmcnt(19)
  s_waitcnt lgkmcnt(4)
  v_mfma_f32_16x16x32_bf16 v[16:19], v[104:107], v[40:43], v[16:19]
  ds_read_b128 v[124:127], v5 offset:54272
  s_waitcnt lgkmcnt(4)
  v_mfma_f32_16x16x32_bf16 v[20:23], v[108:111], v[40:43], v[20:23]
  ds_read_b128 v[128:131], v5 offset:55296
  s_waitcnt lgkmcnt(4)
  v_mfma_f32_16x16x32_bf16 v[24:27], v[112:115], v[40:43], v[24:27]
  ds_read_b128 v[132:135], v5 offset:56320
  s_waitcnt lgkmcnt(4)
  v_mfma_f32_16x16x32_bf16 v[28:31], v[116:119], v[40:43], v[28:31]
  ds_read_b128 v[136:139], v5 offset:57344
  s_waitcnt lgkmcnt(4)
  v_mfma_f32_16x16x32_bf16 v[32:35], v[120:123], v[40:43], v[32:35]
  ds_read_b128 v[140:143], v5 offset:58368
  buffer_load_dwordx4 v[96:99], v5, s[8:11], s54 offen offset:2048 sc1
  buffer_load_dwordx4 v[100:103], v5, s[8:11], s54 offen offset:3072 sc1
  s_waitcnt vmcnt(20)
  s_waitcnt lgkmcnt(4)
  v_mfma_f32_16x16x32_bf16 v[16:19], v[124:127], v[44:47], v[16:19]
  ds_read_b128 v[104:107], v5 offset:59392
  s_waitcnt lgkmcnt(4)
  v_mfma_f32_16x16x32_bf16 v[20:23], v[128:131], v[44:47], v[20:23]
  ds_read_b128 v[108:111], v5 offset:60416
  s_waitcnt lgkmcnt(4)
  v_mfma_f32_16x16x32_bf16 v[24:27], v[132:135], v[44:47], v[24:27]
  ds_read_b128 v[112:115], v5 offset:61440
  s_waitcnt lgkmcnt(4)
  v_mfma_f32_16x16x32_bf16 v[28:31], v[136:139], v[44:47], v[28:31]
  ds_read_b128 v[116:119], v5 offset:62464
  s_waitcnt lgkmcnt(4)
  v_mfma_f32_16x16x32_bf16 v[32:35], v[140:143], v[44:47], v[32:35]
  ds_read_b128 v[120:123], v5 offset:63488
  s_add_u32 s54, s53, 16384
  buffer_load_dwordx4 v[40:43], v5, s[8:11], s54 offen offset:0 sc1
  s_waitcnt vmcnt(20)
  s_waitcnt lgkmcnt(4)
  v_mfma_f32_16x16x32_bf16 v[16:19], v[104:107], v[48:51], v[16:19]
  ds_read_b128 v[124:127], v5 offset:64512
  s_waitcnt lgkmcnt(4)
  v_mfma_f32_16x16x32_bf16 v[20:23], v[108:111], v[48:51], v[20:23]
  ds_read_b128 v[128:131], v8 offset:0
  s_waitcnt lgkmcnt(4)
  v_mfma_f32_16x16x32_bf16 v[24:27], v[112:115], v[48:51], v[24:27]
  ds_read_b128 v[132:135], v8 offset:1024
  s_waitcnt lgkmcnt(4)
  v_mfma_f32_16x16x32_bf16 v[28:31], v[116:119], v[48:51], v[28:31]
  ds_read_b128 v[136:139], v8 offset:2048
  s_waitcnt lgkmcnt(4)
  v_mfma_f32_16x16x32_bf16 v[32:35], v[120:123], v[48:51], v[32:35]
  ds_read_b128 v[140:143], v8 offset:3072
  buffer_load_dwordx4 v[44:47], v5, s[8:11], s54 offen offset:1024 sc1
  s_waitcnt vmcnt(20)
  s_waitcnt lgkmcnt(4)
  v_mfma_f32_16x16x32_bf16 v[16:19], v[124:127], v[52:55], v[16:19]
  ds_read_b128 v[104:107], v8 offset:4096
  s_waitcnt lgkmcnt(4)
  v_mfma_f32_16x16x32_bf16 v[20:23], v[128:131], v[52:55], v[20:23]
  ds_read_b128 v[108:111], v8 offset:5120
  s_waitcnt lgkmcnt(4)
  v_mfma_f32_16x16x32_bf16 v[24:27], v[132:135], v[52:55], v[24:27]
  ds_read_b128 v[112:115], v8 offset:6144
  s_waitcnt lgkmcnt(4)
  v_mfma_f32_16x16x32_bf16 v[28:31], v[136:139], v[52:55], v[28:31]
  ds_read_b128 v[116:119], v8 offset:7168
  s_waitcnt lgkmcnt(4)
  v_mfma_f32_16x16x32_bf16 v[32:35], v[140:143], v[52:55], v[32:35]
  ds_read_b128 v[120:123], v8 offset:8192
  buffer_load_dwordx4 v[48:51], v5, s[8:11], s54 offen offset:2048 sc1
  s_waitcnt vmcnt(20)
  s_waitcnt lgkmcnt(4)
  v_mfma_f32_16x16x32_bf16 v[16:19], v[104:107], v[56:59], v[16:19]
  ds_read_b128 v[124:127], v8 offset:9216
  s_waitcnt lgkmcnt(4)
  v_mfma_f32_16x16x32_bf16 v[20:23], v[108:111], v[56:59], v[20:23]
  ds_read_b128 v[128:131], v8 offset:10240
  s_waitcnt lgkmcnt(4)
  v_mfma_f32_16x16x32_bf16 v[24:27], v[112:115], v[56:59], v[24:27]
  ds_read_b128 v[132:135], v8 offset:11264
  s_waitcnt lgkmcnt(4)
  v_mfma_f32_16x16x32_bf16 v[28:31], v[116:119], v[56:59], v[28:31]
  ds_read_b128 v[136:139], v8 offset:12288
  s_waitcnt lgkmcnt(4)
  v_mfma_f32_16x16x32_bf16 v[32:35], v[120:123], v[56:59], v[32:35]
  ds_read_b128 v[140:143], v8 offset:13312
  buffer_load_dwordx4 v[52:55], v5, s[8:11], s54 offen offset:3072 sc1
  s_waitcnt vmcnt(20)
  s_waitcnt lgkmcnt(4)
  v_mfma_f32_16x16x32_bf16 v[16:19], v[124:127], v[60:63], v[16:19]
  ds_read_b128 v[104:107], v8 offset:14336
  s_waitcnt lgkmcnt(4)
  v_mfma_f32_16x16x32_bf16 v[20:23], v[128:131], v[60:63], v[20:23]
  ds_read_b128 v[108:111], v8 offset:15360
  s_waitcnt lgkmcnt(4)
  v_mfma_f32_16x16x32_bf16 v[24:27], v[132:135], v[60:63], v[24:27]
  ds_read_b128 v[112:115], v8 offset:16384
  s_waitcnt lgkmcnt(4)
  v_mfma_f32_16x16x32_bf16 v[28:31], v[136:139], v[60:63], v[28:31]
  ds_read_b128 v[116:119], v8 offset:17408
  s_waitcnt lgkmcnt(4)
  v_mfma_f32_16x16x32_bf16 v[32:35], v[140:143], v[60:63], v[32:35]
  ds_read_b128 v[120:123], v8 offset:18432
  s_waitcnt vmcnt(19)
  s_waitcnt lgkmcnt(4)
  v_mfma_f32_16x16x32_bf16 v[16:19], v[104:107], v[64:67], v[16:19]
  ds_read_b128 v[124:127], v8 offset:19456
  s_waitcnt lgkmcnt(4)
  v_mfma_f32_16x16x32_bf16 v[20:23], v[108:111], v[64:67], v[20:23]
  ds_read_b128 v[128:131], v8 offset:20480
  s_waitcnt lgkmcnt(4)
  v_mfma_f32_16x16x32_bf16 v[24:27], v[112:115], v[64:67], v[24:27]
  ds_read_b128 v[132:135], v8 offset:21504
  s_waitcnt lgkmcnt(4)
  v_mfma_f32_16x16x32_bf16 v[28:31], v[116:119], v[64:67], v[28:31]
  ds_read_b128 v[136:139], v8 offset:22528
  s_waitcnt lgkmcnt(4)
  v_mfma_f32_16x16x32_bf16 v[32:35], v[120:123], v[64:67], v[32:35]
  ds_read_b128 v[140:143], v8 offset:23552
  s_waitcnt vmcnt(18)
  s_waitcnt lgkmcnt(4)
  v_mfma_f32_16x16x32_bf16 v[16:19], v[124:127], v[68:71], v[16:19]
  ds_read_b128 v[104:107], v8 offset:24576
  s_waitcnt lgkmcnt(4)
  v_mfma_f32_16x16x32_bf16 v[20:23], v[128:131], v[68:71], v[20:23]
  ds_read_b128 v[108:111], v8 offset:25600
  s_waitcnt lgkmcnt(4)
  v_mfma_f32_16x16x32_bf16 v[24:27], v[132:135], v[68:71], v[24:27]
  ds_read_b128 v[112:115], v8 offset:26624
  s_waitcnt lgkmcnt(4)
  v_mfma_f32_16x16x32_bf16 v[28:31], v[136:139], v[68:71], v[28:31]
  ds_read_b128 v[116:119], v8 offset:27648
  s_waitcnt lgkmcnt(4)
  v_mfma_f32_16x16x32_bf16 v[32:35], v[140:143], v[68:71], v[32:35]
  ds_read_b128 v[120:123], v8 offset:28672
  s_waitcnt vmcnt(17)
  s_waitcnt lgkmcnt(4)
  v_mfma_f32_16x16x32_bf16 v[16:19], v[104:107], v[72:75], v[16:19]
  ds_read_b128 v[124:127], v8 offset:29696
  s_waitcnt lgkmcnt(4)
  v_mfma_f32_16x16x32_bf16 v[20:23], v[108:111], v[72:75], v[20:23]
  ds_read_b128 v[128:131], v8 offset:30720
  s_waitcnt lgkmcnt(4)
  v_mfma_f32_16x16x32_bf16 v[24:27], v[112:115], v[72:75], v[24:27]
  ds_read_b128 v[132:135], v8 offset:31744
  s_waitcnt lgkmcnt(4)
  v_mfma_f32_16x16x32_bf16 v[28:31], v[116:119], v[72:75], v[28:31]
  ds_read_b128 v[136:139], v8 offset:32768
  s_waitcnt lgkmcnt(4)
  v_mfma_f32_16x16x32_bf16 v[32:35], v[120:123], v[72:75], v[32:35]
  ds_read_b128 v[140:143], v8 offset:33792
  s_waitcnt vmcnt(16)
  s_waitcnt lgkmcnt(4)
  v_mfma_f32_16x16x32_bf16 v[16:19], v[124:127], v[76:79], v[16:19]
  ds_read_b128 v[104:107], v8 offset:34816
  s_waitcnt lgkmcnt(4)
  v_mfma_f32_16x16x32_bf16 v[20:23], v[128:131], v[76:79], v[20:23]
  ds_read_b128 v[108:111], v8 offset:35840
  s_waitcnt lgkmcnt(4)
  v_mfma_f32_16x16x32_bf16 v[24:27], v[132:135], v[76:79], v[24:27]
  ds_read_b128 v[112:115], v8 offset:36864
  s_waitcnt lgkmcnt(4)
  v_mfma_f32_16x16x32_bf16 v[28:31], v[136:139], v[76:79], v[28:31]
  ds_read_b128 v[116:119], v8 offset:37888
  s_waitcnt lgkmcnt(4)
  v_mfma_f32_16x16x32_bf16 v[32:35], v[140:143], v[76:79], v[32:35]
  ds_read_b128 v[120:123], v8 offset:38912
  s_waitcnt vmcnt(15)
  s_waitcnt lgkmcnt(4)
  v_mfma_f32_16x16x32_bf16 v[16:19], v[104:107], v[80:83], v[16:19]
  ds_read_b128 v[124:127], v8 offset:39936
  s_waitcnt lgkmcnt(4)
  v_mfma_f32_16x16x32_bf16 v[20:23], v[108:111], v[80:83], v[20:23]
  ds_read_b128 v[128:131], v8 offset:40960
  s_waitcnt lgkmcnt(4)
  v_mfma_f32_16x16x32_bf16 v[24:27], v[112:115], v[80:83], v[24:27]
  ds_read_b128 v[132:135], v8 offset:41984
  s_waitcnt lgkmcnt(4)
  v_mfma_f32_16x16x32_bf16 v[28:31], v[116:119], v[80:83], v[28:31]
  ds_read_b128 v[136:139], v8 offset:43008
  s_waitcnt lgkmcnt(4)
  v_mfma_f32_16x16x32_bf16 v[32:35], v[120:123], v[80:83], v[32:35]
  ds_read_b128 v[140:143], v8 offset:44032
  s_waitcnt vmcnt(14)
  s_waitcnt lgkmcnt(4)
  v_mfma_f32_16x16x32_bf16 v[16:19], v[124:127], v[84:87], v[16:19]
  ds_read_b128 v[104:107], v8 offset:45056
  s_waitcnt lgkmcnt(4)
  v_mfma_f32_16x16x32_bf16 v[20:23], v[128:131], v[84:87], v[20:23]
  ds_read_b128 v[108:111], v8 offset:46080
  s_waitcnt lgkmcnt(4)
  v_mfma_f32_16x16x32_bf16 v[24:27], v[132:135], v[84:87], v[24:27]
  ds_read_b128 v[112:115], v8 offset:47104
  s_waitcnt lgkmcnt(4)
  v_mfma_f32_16x16x32_bf16 v[28:31], v[136:139], v[84:87], v[28:31]
  ds_read_b128 v[116:119], v8 offset:48128
  s_waitcnt lgkmcnt(4)
  v_mfma_f32_16x16x32_bf16 v[32:35], v[140:143], v[84:87], v[32:35]
  ds_read_b128 v[120:123], v8 offset:49152
  s_waitcnt vmcnt(13)
  s_waitcnt lgkmcnt(4)
  v_mfma_f32_16x16x32_bf16 v[16:19], v[104:107], v[88:91], v[16:19]
  ds_read_b128 v[124:127], v8 offset:50176
  s_waitcnt lgkmcnt(4)
  v_mfma_f32_16x16x32_bf16 v[20:23], v[108:111], v[88:91], v[20:23]
  ds_read_b128 v[128:131], v8 offset:51200
  s_waitcnt lgkmcnt(4)
  v_mfma_f32_16x16x32_bf16 v[24:27], v[112:115], v[88:91], v[24:27]
  ds_read_b128 v[132:135], v8 offset:52224
  s_waitcnt lgkmcnt(4)
  v_mfma_f32_16x16x32_bf16 v[28:31], v[116:119], v[88:91], v[28:31]
  ds_read_b128 v[136:139], v8 offset:53248
  s_waitcnt lgkmcnt(4)
  v_mfma_f32_16x16x32_bf16 v[32:35], v[120:123], v[88:91], v[32:35]
  ds_read_b128 v[140:143], v8 offset:54272
  s_waitcnt vmcnt(12)
  s_waitcnt lgkmcnt(4)
  v_mfma_f32_16x16x32_bf16 v[16:19], v[124:127], v[92:95], v[16:19]
  ds_read_b128 v[104:107], v8 offset:55296
  s_waitcnt lgkmcnt(4)
  v_mfma_f32_16x16x32_bf16 v[20:23], v[128:131], v[92:95], v[20:23]
  ds_read_b128 v[108:111], v8 offset:56320
  s_waitcnt lgkmcnt(4)
  v_mfma_f32_16x16x32_bf16 v[24:27], v[132:135], v[92:95], v[24:27]
  ds_read_b128 v[112:115], v8 offset:57344
  s_waitcnt lgkmcnt(4)
  v_mfma_f32_16x16x32_bf16 v[28:31], v[136:139], v[92:95], v[28:31]
  ds_read_b128 v[116:119], v8 offset:58368
  s_waitcnt lgkmcnt(4)
  v_mfma_f32_16x16x32_bf16 v[32:35], v[140:143], v[92:95], v[32:35]
  ds_read_b128 v[120:123], v8 offset:59392
  s_waitcnt vmcnt(5)
  s_waitcnt lgkmcnt(4)
  v_mfma_f32_16x16x32_bf16 v[16:19], v[104:107], v[96:99], v[16:19]
  ds_read_b128 v[124:127], v8 offset:60416
  s_waitcnt lgkmcnt(4)
  v_mfma_f32_16x16x32_bf16 v[20:23], v[108:111], v[96:99], v[20:23]
  ds_read_b128 v[128:131], v8 offset:61440
  s_waitcnt lgkmcnt(4)
  v_mfma_f32_16x16x32_bf16 v[24:27], v[112:115], v[96:99], v[24:27]
  ds_read_b128 v[132:135], v8 offset:62464
  s_waitcnt lgkmcnt(4)
  v_mfma_f32_16x16x32_bf16 v[28:31], v[116:119], v[96:99], v[28:31]
  ds_read_b128 v[136:139], v8 offset:63488
  s_waitcnt lgkmcnt(4)
  v_mfma_f32_16x16x32_bf16 v[32:35], v[120:123], v[96:99], v[32:35]
  ds_read_b128 v[140:143], v8 offset:64512
  s_waitcnt vmcnt(4)
  s_waitcnt lgkmcnt(4)
  v_mfma_f32_16x16x32_bf16 v[16:19], v[124:127], v[100:103], v[16:19]
  ds_read_b128 v[104:107], v9 offset:0
  s_waitcnt lgkmcnt(4)
  v_mfma_f32_16x16x32_bf16 v[20:23], v[128:131], v[100:103], v[20:23]
  ds_read_b128 v[108:111], v9 offset:1024
  s_waitcnt lgkmcnt(4)
  v_mfma_f32_16x16x32_bf16 v[24:27], v[132:135], v[100:103], v[24:27]
  ds_read_b128 v[112:115], v9 offset:2048
  s_waitcnt lgkmcnt(4)
  v_mfma_f32_16x16x32_bf16 v[28:31], v[136:139], v[100:103], v[28:31]
  ds_read_b128 v[116:119], v9 offset:3072
  s_waitcnt lgkmcnt(4)
  v_mfma_f32_16x16x32_bf16 v[32:35], v[140:143], v[100:103], v[32:35]
  ds_read_b128 v[120:123], v9 offset:4096
  s_waitcnt vmcnt(3)
  s_waitcnt lgkmcnt(4)
  v_mfma_f32_16x16x32_bf16 v[16:19], v[104:107], v[40:43], v[16:19]
  ds_read_b128 v[124:127], v9 offset:5120
  s_waitcnt lgkmcnt(4)
  v_mfma_f32_16x16x32_bf16 v[20:23], v[108:111], v[40:43], v[20:23]
  ds_read_b128 v[128:131], v9 offset:6144
  s_waitcnt lgkmcnt(4)
  v_mfma_f32_16x16x32_bf16 v[24:27], v[112:115], v[40:43], v[24:27]
  ds_read_b128 v[132:135], v9 offset:7168
  s_waitcnt lgkmcnt(4)
  v_mfma_f32_16x16x32_bf16 v[28:31], v[116:119], v[40:43], v[28:31]
  ds_read_b128 v[136:139], v9 offset:8192
  s_waitcnt lgkmcnt(4)
  v_mfma_f32_16x16x32_bf16 v[32:35], v[120:123], v[40:43], v[32:35]
  ds_read_b128 v[140:143], v9 offset:9216
  s_waitcnt vmcnt(2)
  s_waitcnt lgkmcnt(4)
  v_mfma_f32_16x16x32_bf16 v[16:19], v[124:127], v[44:47], v[16:19]
  ds_read_b128 v[104:107], v9 offset:10240
  s_waitcnt lgkmcnt(4)
  v_mfma_f32_16x16x32_bf16 v[20:23], v[128:131], v[44:47], v[20:23]
  ds_read_b128 v[108:111], v9 offset:11264
  s_waitcnt lgkmcnt(4)
  v_mfma_f32_16x16x32_bf16 v[24:27], v[132:135], v[44:47], v[24:27]
  ds_read_b128 v[112:115], v9 offset:12288
  s_waitcnt lgkmcnt(4)
  v_mfma_f32_16x16x32_bf16 v[28:31], v[136:139], v[44:47], v[28:31]
  ds_read_b128 v[116:119], v9 offset:13312
  s_waitcnt lgkmcnt(4)
  v_mfma_f32_16x16x32_bf16 v[32:35], v[140:143], v[44:47], v[32:35]
  ds_read_b128 v[120:123], v9 offset:14336
  s_waitcnt vmcnt(1)
  s_waitcnt lgkmcnt(4)
  v_mfma_f32_16x16x32_bf16 v[16:19], v[104:107], v[48:51], v[16:19]
  ds_read_b128 v[124:127], v9 offset:15360
  s_waitcnt lgkmcnt(4)
  v_mfma_f32_16x16x32_bf16 v[20:23], v[108:111], v[48:51], v[20:23]
  ds_read_b128 v[128:131], v9 offset:16384
  s_waitcnt lgkmcnt(4)
  v_mfma_f32_16x16x32_bf16 v[24:27], v[112:115], v[48:51], v[24:27]
  ds_read_b128 v[132:135], v9 offset:17408
  s_waitcnt lgkmcnt(4)
  v_mfma_f32_16x16x32_bf16 v[28:31], v[116:119], v[48:51], v[28:31]
  ds_read_b128 v[136:139], v9 offset:18432
  s_waitcnt lgkmcnt(4)
  v_mfma_f32_16x16x32_bf16 v[32:35], v[120:123], v[48:51], v[32:35]
  ds_read_b128 v[140:143], v9 offset:19456
  s_waitcnt vmcnt(0)
  s_waitcnt lgkmcnt(4)
  v_mfma_f32_16x16x32_bf16 v[16:19], v[124:127], v[52:55], v[16:19]
  s_waitcnt lgkmcnt(3)
  v_mfma_f32_16x16x32_bf16 v[20:23], v[128:131], v[52:55], v[20:23]
  s_waitcnt lgkmcnt(2)
  v_mfma_f32_16x16x32_bf16 v[24:27], v[132:135], v[52:55], v[24:27]
  s_waitcnt lgkmcnt(1)
  v_mfma_f32_16x16x32_bf16 v[28:31], v[136:139], v[52:55], v[28:31]
  s_waitcnt lgkmcnt(0)
  v_mfma_f32_16x16x32_bf16 v[32:35], v[140:143], v[52:55], v[32:35]
  v_lshlrev_b32 v10, 4, v4
  v_add_u32 v10, 151552, v10
  ds_read_b128 v[48:51], v10 offset:0
  ds_read_b128 v[52:55], v10 offset:64
  ds_read_b128 v[56:59], v10 offset:128
  ds_read_b128 v[60:63], v10 offset:192
  ds_read_b128 v[64:67], v10 offset:256
  ds_read_b128 v[68:71], v10 offset:320
  ds_read_b128 v[72:75], v10 offset:384
  ds_read_b128 v[76:79], v10 offset:448
  ds_read_b128 v[80:83], v10 offset:512
  ds_read_b128 v[84:87], v10 offset:576
  v_fma_mix_f32 v160, v144, v155, v154 op_sel:[0,0,0] op_sel_hi:[1,0,0]
  v_fma_mix_f32 v161, v144, v155, v154 op_sel:[1,0,0] op_sel_hi:[1,0,0]
  v_fma_mix_f32 v162, v145, v155, v154 op_sel:[0,0,0] op_sel_hi:[1,0,0]
  v_fma_mix_f32 v163, v145, v155, v154 op_sel:[1,0,0] op_sel_hi:[1,0,0]
  v_fma_mix_f32 v164, v146, v155, v154 op_sel:[0,0,0] op_sel_hi:[1,0,0]
  v_fma_mix_f32 v165, v146, v155, v154 op_sel:[1,0,0] op_sel_hi:[1,0,0]
  v_fma_mix_f32 v166, v147, v155, v154 op_sel:[0,0,0] op_sel_hi:[1,0,0]
  v_fma_mix_f32 v167, v147, v155, v154 op_sel:[1,0,0] op_sel_hi:[1,0,0]
  v_fma_mix_f32 v168, v148, v155, v154 op_sel:[0,0,0] op_sel_hi:[1,0,0]
  v_fma_mix_f32 v169, v148, v155, v154 op_sel:[1,0,0] op_sel_hi:[1,0,0]
  v_fma_mix_f32 v170, v149, v155, v154 op_sel:[0,0,0] op_sel_hi:[1,0,0]
  v_fma_mix_f32 v171, v149, v155, v154 op_sel:[1,0,0] op_sel_hi:[1,0,0]
  v_fma_mix_f32 v172, v150, v155, v154 op_sel:[0,0,0] op_sel_hi:[1,0,0]
  v_fma_mix_f32 v173, v150, v155, v154 op_sel:[1,0,0] op_sel_hi:[1,0,0]
  v_fma_mix_f32 v174, v151, v155, v154 op_sel:[0,0,0] op_sel_hi:[1,0,0]
  v_fma_mix_f32 v175, v151, v155, v154 op_sel:[1,0,0] op_sel_hi:[1,0,0]
  v_fma_mix_f32 v176, v152, v155, v154 op_sel:[0,0,0] op_sel_hi:[1,0,0]
  v_fma_mix_f32 v177, v152, v155, v154 op_sel:[1,0,0] op_sel_hi:[1,0,0]
  v_fma_mix_f32 v178, v153, v155, v154 op_sel:[0,0,0] op_sel_hi:[1,0,0]
  v_fma_mix_f32 v179, v153, v155, v154 op_sel:[1,0,0] op_sel_hi:[1,0,0]
  s_waitcnt lgkmcnt(5)
  v_fmac_f32 v160, v48, v16
  v_fmac_f32 v161, v49, v17
  v_fmac_f32 v162, v50, v18
  v_fmac_f32 v163, v51, v19
  v_fmac_f32 v164, v52, v20
  v_fmac_f32 v165, v53, v21
  v_fmac_f32 v166, v54, v22
  v_fmac_f32 v167, v55, v23
  v_fmac_f32 v168, v56, v24
  v_fmac_f32 v169, v57, v25
  v_fmac_f32 v170, v58, v26
  v_fmac_f32 v171, v59, v27
  v_fmac_f32 v172, v60, v28
  v_fmac_f32 v173, v61, v29
  v_fmac_f32 v174, v62, v30
  v_fmac_f32 v175, v63, v31
  v_fmac_f32 v176, v64, v32
  v_fmac_f32 v177, v65, v33
  v_fmac_f32 v178, v66, v34
  v_fmac_f32 v179, v67, v35
  s_waitcnt lgkmcnt(0)
  v_mul_f32 v68, v68, v160
  v_mul_f32 v69, v69, v161
  v_mul_f32 v70, v70, v162
  v_mul_f32 v71, v71, v163
  v_mul_f32 v72, v72, v164
  v_mul_f32 v73, v73, v165
  v_mul_f32 v74, v74, v166
  v_mul_f32 v75, v75, v167
  v_mul_f32 v76, v76, v168
  v_mul_f32 v77, v77, v169
  v_mul_f32 v78, v78, v170
  v_mul_f32 v79, v79, v171
  v_mul_f32 v80, v80, v172
  v_mul_f32 v81, v81, v173
  v_mul_f32 v82, v82, v174
  v_mul_f32 v83, v83, v175
  v_mul_f32 v84, v84, v176
  v_mul_f32 v85, v85, v177
  v_mul_f32 v86, v86, v178
  v_mul_f32 v87, v87, v179
  v_cvt_pk_bf16_f32 v48, v68, v69
  v_cvt_pk_bf16_f32 v49, v70, v71
  v_cvt_pk_bf16_f32 v50, v72, v73
  v_cvt_pk_bf16_f32 v51, v74, v75
  v_cvt_pk_bf16_f32 v52, v76, v77
  v_cvt_pk_bf16_f32 v53, v78, v79
  v_cvt_pk_bf16_f32 v54, v80, v81
  v_cvt_pk_bf16_f32 v55, v82, v83
  v_cvt_pk_bf16_f32 v56, v84, v85
  v_cvt_pk_bf16_f32 v57, v86, v87
  v_mov_b32 v58, v56
  v_mov_b32 v59, v57
  s_lshr_b32 s52, s15, 1
  s_mul_i32 s52, s52, 40960
  s_mul_i32 s53, s5, 5120
  s_add_u32 s52, s52, s53
  s_and_b32 s53, s15, 1
  s_lshl_b32 s53, s53, 8
  s_add_u32 s52, s52, s53
  s_add_u32 s52, s52, 19951616
  v_and_b32 v11, 1, v4
  v_lshlrev_b32 v11, 10, v11
  v_lshrrev_b32 v12, 1, v4
  v_lshl_add_u32 v11, v12, 9, v11
  v_lshl_add_u32 v11, v3, 4, v11
  v_permlane16_swap_b32 v48, v50
  v_permlane16_swap_b32 v49, v51
  v_permlane16_swap_b32 v52, v54
  v_permlane16_swap_b32 v53, v55
  v_permlane16_swap_b32 v56, v58
  v_permlane16_swap_b32 v57, v59
  buffer_store_dwordx4 v[48:51], v11, s[8:11], s52 offen offset:0 sc0 sc1
  buffer_store_dwordx4 v[52:55], v11, s[8:11], s52 offen offset:2048 sc0 sc1
  s_add_u32 s52, s52, 4096
  v_and_b32 v12, 1, v4
  v_cmp_eq_u32 vcc, 0, v12
  s_nop 3
  s_and_saveexec_b64 s[54:55], vcc
  buffer_store_dwordx4 v[56:59], v11, s[8:11], s52 offen sc0 sc1
  s_mov_b64 exec, s[54:55]
  v_cvt_pk_bf16_f32 v246, v160, v161
  v_cvt_pk_bf16_f32 v247, v162, v163
  v_cvt_pk_bf16_f32 v248, v164, v165
  v_cvt_pk_bf16_f32 v249, v166, v167
  v_cvt_pk_bf16_f32 v250, v168, v169
  v_cvt_pk_bf16_f32 v251, v170, v171
  v_cvt_pk_bf16_f32 v252, v172, v173
  v_cvt_pk_bf16_f32 v253, v174, v175
  v_cvt_pk_bf16_f32 v254, v176, v177
  v_cvt_pk_bf16_f32 v255, v178, v179
  v_add_f32 v12, v160, v161
  v_add_f32 v12, v12, v162
  v_add_f32 v12, v12, v163
  v_add_f32 v12, v12, v164
  v_add_f32 v12, v12, v165
  v_add_f32 v12, v12, v166
  v_add_f32 v12, v12, v167
  v_add_f32 v12, v12, v168
  v_add_f32 v12, v12, v169
  v_add_f32 v12, v12, v170
  v_add_f32 v12, v12, v171
  v_add_f32 v12, v12, v172
  v_add_f32 v12, v12, v173
  v_add_f32 v12, v12, v174
  v_add_f32 v12, v12, v175
  v_add_f32 v12, v12, v176
  v_add_f32 v12, v12, v177
  v_add_f32 v12, v12, v178
  v_add_f32 v12, v12, v179
  v_mov_b32 v14, v12
  v_mov_b32 v15, v12
  s_nop 1
  v_permlane16_swap_b32 v14, v15
  v_add_f32 v12, v14, v15
  v_mov_b32 v14, v12
  v_mov_b32 v15, v12
  s_nop 1
  v_permlane32_swap_b32 v14, v15
  v_add_f32 v12, v14, v15
  v_mul_f32 v14, 0xbc4ccccd, v12
  v_mov_b32 v13, 0
  v_add_f32 v160, v14, v160
  v_fmac_f32 v13, v160, v160
  v_add_f32 v161, v14, v161
  v_fmac_f32 v13, v161, v161
  v_add_f32 v162, v14, v162
  v_fmac_f32 v13, v162, v162
  v_add_f32 v163, v14, v163
  v_fmac_f32 v13, v163, v163
  v_add_f32 v164, v14, v164
  v_fmac_f32 v13, v164, v164
  v_add_f32 v165, v14, v165
  v_fmac_f32 v13, v165, v165
  v_add_f32 v166, v14, v166
  v_fmac_f32 v13, v166, v166
  v_add_f32 v167, v14, v167
  v_fmac_f32 v13, v167, v167
  v_add_f32 v168, v14, v168
  v_fmac_f32 v13, v168, v168
  v_add_f32 v169, v14, v169
  v_fmac_f32 v13, v169, v169
  v_add_f32 v170, v14, v170
  v_fmac_f32 v13, v170, v170
  v_add_f32 v171, v14, v171
  v_fmac_f32 v13, v171, v171
  v_add_f32 v172, v14, v172
  v_fmac_f32 v13, v172, v172
  v_add_f32 v173, v14, v173
  v_fmac_f32 v13, v173, v173
  v_add_f32 v174, v14, v174
  v_fmac_f32 v13, v174, v174
  v_add_f32 v175, v14, v175
  v_fmac_f32 v13, v175, v175
  v_add_f32 v176, v14, v176
  v_fmac_f32 v13, v176, v176
  v_add_f32 v177, v14, v177
  v_fmac_f32 v13, v177, v177
  v_add_f32 v178, v14, v178
  v_fmac_f32 v13, v178, v178
  v_add_f32 v179, v14, v179
  v_fmac_f32 v13, v179, v179
  v_mov_b32 v14, v13
  v_mov_b32 v15, v13
  s_nop 1
  v_permlane16_swap_b32 v14, v15
  v_add_f32 v13, v14, v15
  v_mov_b32 v14, v13
  v_mov_b32 v15, v13
  s_nop 1
  v_permlane32_swap_b32 v14, v15
  v_add_f32 v13, v14, v15
  s_lshl_b32 s52, s15, 10
  s_lshl_b32 s53, s5, 3
  s_add_u32 s52, s52, s53
  s_add_u32 s52, s52, 22573056
  v_lshlrev_b32 v14, 6, v3
  v_cmp_gt_u32 vcc, 16, v1
  s_nop 3
  s_and_saveexec_b64 s[54:55], vcc
  buffer_store_dwordx2 v[12:13], v14, s[8:11], s52 offen sc0 sc1
  s_mov_b64 exec, s[54:55]
  s_waitcnt vmcnt(0)
  s_barrier
  s_cmp_lg_u32 s12, 1
  s_cbranch_scc1 adaLN_cond__mha_block__glu_gated_glu__prompt_s34w186
  s_and_b32 s52, s2, 15
  s_add_u32 s52, s52, 56
  s_lshl_b32 s48, s52, 8
  s_add_u32 s48, s48, 0
  v_mov_b32 v2, 0
  v_mov_b32 v3, 1
  s_mov_b64 exec, 1
  buffer_atomic_add v3, v2, s[8:11], s48 offen sc0 sc1
  s_waitcnt vmcnt(0)
  s_mov_b64 exec, -1
  v_readfirstlane_b32 s49, v3
  s_nop 3
  s_cmp_lg_u32 s49, 15
  s_cbranch_scc1 adaLN_cond__mha_block__glu_gated_glu__prompt_arr87
  s_mov_b32 s48, 26880
  v_mov_b32 v2, 0
  v_mov_b32 v3, 1
  s_mov_b64 exec, 1
  buffer_atomic_add v3, v2, s[8:11], s48 offen sc0 sc1
  s_waitcnt vmcnt(0)
  s_mov_b64 exec, -1
  v_readfirstlane_b32 s49, v3
  s_nop 3
  s_cmp_lg_u32 s49, 15
  s_cbranch_scc1 adaLN_cond__mha_block__glu_gated_glu__prompt_arr87
  s_mov_b32 s48, 44288
  v_lshlrev_b32 v2, 8, v1
  v_mov_b32 v3, 1
  s_mov_b32 exec_lo, 0x1
  s_mov_b32 exec_hi, 0
  buffer_store_dword v3, v2, s[8:11], s48 offen sc0 sc1
  s_mov_b64 exec, -1
adaLN_cond__mha_block__glu_gated_glu__prompt_arr87:
adaLN_cond__mha_block__glu_gated_glu__prompt_s34w186:
  s_cmp_lg_u32 s12, 0
  s_cbranch_scc1 adaLN_cond__mha_block__glu_gated_glu__prompt_s34w85
  s_lshr_b32 s53, s4, 1
  s_add_u32 s52, s53, 40
  s_add_u32 s53, s53, 132
  s_lshl_b32 s48, s52, 8
  s_add_u32 s48, s48, 0
  v_mov_b32 v2, 0
  v_mov_b32 v3, 1
  s_mov_b64 exec, 1
  buffer_atomic_add v3, v2, s[8:11], s48 offen sc0 sc1
  s_waitcnt vmcnt(0)
  s_mov_b64 exec, -1
  v_readfirstlane_b32 s49, v3
  s_nop 3
  s_cmp_lg_u32 s49, 15
  s_cbranch_scc1 adaLN_cond__mha_block__glu_gated_glu__prompt_arr88
  s_lshl_b32 s48, s53, 8
  s_add_u32 s48, s48, 0
  v_lshlrev_b32 v2, 8, v1
  v_mov_b32 v3, 1
  s_mov_b32 exec_lo, 0x1
  s_mov_b32 exec_hi, 0
  buffer_store_dword v3, v2, s[8:11], s48 offen sc0 sc1
  s_mov_b64 exec, -1
adaLN_cond__mha_block__glu_gated_glu__prompt_arr88:
  s_add_u32 s52, s6, 132
  v_mov_b32 v5, 0
  v_mov_b32 v6, 0
  s_mov_b32 s51, s52
  v_add_u32 v7, s51, v1
  v_lshlrev_b32 v7, 8, v7
  v_subrev_u32 v8, 0, v1
  v_cmp_gt_u32 vcc, 1, v8
  s_nop 1
  v_cndmask_b32 v5, v5, v7, vcc
  v_mov_b32 v7, 1
  v_cndmask_b32 v6, v6, v7, vcc
  s_mov_b32 s49, 0
  s_mov_b32 s50, 0
adaLN_cond__mha_block__glu_gated_glu__prompt_poll89:
  buffer_load_dword v4, v5, s[8:11], s49 offen sc1
  s_waitcnt vmcnt(0)
  v_cmp_lt_u32 vcc, v4, v6
  s_nop 3
  s_cmp_eq_u64 vcc, 0
  s_cbranch_scc1 adaLN_cond__mha_block__glu_gated_glu__prompt_polled90
  s_add_u32 s50, s50, 1
  s_cmp_ge_u32 s50, 200000
  s_cbranch_scc1 adaLN_cond__mha_block__glu_gated_glu__prompt_polled90
  s_sleep 2
  s_branch adaLN_cond__mha_block__glu_gated_glu__prompt_poll89
adaLN_cond__mha_block__glu_gated_glu__prompt_polled90:
adaLN_cond__mha_block__glu_gated_glu__prompt_s34w85:
  s_barrier
  v_and_b32 v3, 31, v1
  v_lshrrev_b32 v4, 5, v1
  v_lshlrev_b32 v5, 4, v1
  s_lshl_b32 s15, s6, 2
  s_add_u32 s15, s15, s12
  s_mul_i32 s52, s15, 40960
  s_add_u32 s52, s52, 19951616
  s_lshl_b32 s54, s15, 11
  s_add_u32 s54, s54, 22573056
  v_lshlrev_b32 v6, 6, v3
  v_lshl_add_u32 v6, v4, 5, v6
  s_add_u32 s53, s52, 0
  buffer_load_dwordx4 v[112:115], v5, s[8:11], s53 offen offset:0 sc1
  buffer_load_dwordx4 v[116:119], v5, s[8:11], s53 offen offset:1024 sc1
  buffer_load_dwordx4 v[224:227], v6, s[8:11], s54 offen sc1
  buffer_load_dwordx4 v[228:231], v6, s[8:11], s54 offen offset:16 sc1
  buffer_load_dwordx4 v[120:123], v5, s[8:11], s53 offen offset:2048 sc1
  buffer_load_dwordx4 v[124:127], v5, s[8:11], s53 offen offset:3072 sc1
  s_add_u32 s53, s52, 4096
  buffer_load_dwordx4 v[128:131], v5, s[8:11], s53 offen offset:0 sc1
  buffer_load_dwordx4 v[132:135], v5, s[8:11], s53 offen offset:1024 sc1
  v_mov_b32 v16, 0
  v_mov_b32 v17, 0
  v_mov_b32 v18, 0
  v_mov_b32 v19, 0
  v_mov_b32 v20, 0
  v_mov_b32 v21, 0
  v_mov_b32 v22, 0
  v_mov_b32 v23, 0
  v_mov_b32 v24, 0
  v_mov_b32 v25, 0
  v_mov_b32 v26, 0
  v_mov_b32 v27, 0
  v_mov_b32 v28, 0
  v_mov_b32 v29, 0
  v_mov_b32 v30, 0
  v_mov_b32 v31, 0
  v_mov_b32 v32, 0
  v_mov_b32 v33, 0
  v_mov_b32 v34, 0
  v_mov_b32 v35, 0
  v_mov_b32 v36, 0
  v_mov_b32 v37, 0
  v_mov_b32 v38, 0
  v_mov_b32 v39, 0
  v_mov_b32 v40, 0
  v_mov_b32 v41, 0
  v_mov_b32 v42, 0
  v_mov_b32 v43, 0
  v_mov_b32 v44, 0
  v_mov_b32 v45, 0
  v_mov_b32 v46, 0
  v_mov_b32 v47, 0
  v_mov_b32 v48, 0
  v_mov_b32 v49, 0
  v_mov_b32 v50, 0
  v_mov_b32 v51, 0
  v_mov_b32 v52, 0
  v_mov_b32 v53, 0
  v_mov_b32 v54, 0
  v_mov_b32 v55, 0
  v_mov_b32 v56, 0
  v_mov_b32 v57, 0
  v_mov_b32 v58, 0
  v_mov_b32 v59, 0
  v_mov_b32 v60, 0
  v_mov_b32 v61, 0
  v_mov_b32 v62, 0
  v_mov_b32 v63, 0
  v_mov_b32 v64, 0
  v_mov_b32 v65, 0
  v_mov_b32 v66, 0
  v_mov_b32 v67, 0
  v_mov_b32 v68, 0
  v_mov_b32 v69, 0
  v_mov_b32 v70, 0
  v_mov_b32 v71, 0
  v_mov_b32 v72, 0
  v_mov_b32 v73, 0
  v_mov_b32 v74, 0
  v_mov_b32 v75, 0
  v_mov_b32 v76, 0
  v_mov_b32 v77, 0
  v_mov_b32 v78, 0
  v_mov_b32 v79, 0
  v_mov_b32 v80, 0
  v_mov_b32 v81, 0
  v_mov_b32 v82, 0
  v_mov_b32 v83, 0
  v_mov_b32 v84, 0
  v_mov_b32 v85, 0
  v_mov_b32 v86, 0
  v_mov_b32 v87, 0
  v_mov_b32 v88, 0
  v_mov_b32 v89, 0
  v_mov_b32 v90, 0
  v_mov_b32 v91, 0
  v_mov_b32 v92, 0
  v_mov_b32 v93, 0
  v_mov_b32 v94, 0
  v_mov_b32 v95, 0
  v_mov_b32 v96, 0
  v_mov_b32 v97, 0
  v_mov_b32 v98, 0
  v_mov_b32 v99, 0
  v_mov_b32 v100, 0
  v_mov_b32 v101, 0
  v_mov_b32 v102, 0
  v_mov_b32 v103, 0
  v_mov_b32 v104, 0
  v_mov_b32 v105, 0
  v_mov_b32 v106, 0
  v_mov_b32 v107, 0
  v_mov_b32 v108, 0
  v_mov_b32 v109, 0
  v_mov_b32 v110, 0
  v_mov_b32 v111, 0
  v_add_u32 v8, 0x10000, v5
  v_add_u32 v9, 0x20000, v5
  ds_read_b128 v[176:179], v5 offset:0
  ds_read_b128 v[180:183], v5 offset:1024
  ds_read_b128 v[184:187], v5 offset:2048
  ds_read_b128 v[188:191], v5 offset:3072
  ds_read_b128 v[192:195], v5 offset:4096
  ds_read_b128 v[196:199], v5 offset:5120
  s_waitcnt vmcnt(7)
  s_waitcnt lgkmcnt(5)
  v_mfma_f32_32x32x16_bf16 v[16:31], v[176:179], v[112:115], v[16:31]
  ds_read_b128 v[200:203], v5 offset:6144
  s_waitcnt lgkmcnt(5)
  v_mfma_f32_32x32x16_bf16 v[32:47], v[180:183], v[112:115], v[32:47]
  ds_read_b128 v[204:207], v5 offset:7168
  s_waitcnt lgkmcnt(5)
  v_mfma_f32_32x32x16_bf16 v[48:63], v[184:187], v[112:115], v[48:63]
  ds_read_b128 v[208:211], v5 offset:8192
  s_waitcnt lgkmcnt(5)
  v_mfma_f32_32x32x16_bf16 v[64:79], v[188:191], v[112:115], v[64:79]
  ds_read_b128 v[212:215], v5 offset:9216
  s_waitcnt lgkmcnt(5)
  v_mfma_f32_32x32x16_bf16 v[80:95], v[192:195], v[112:115], v[80:95]
  ds_read_b128 v[216:219], v5 offset:10240
  s_waitcnt lgkmcnt(5)
  v_mfma_f32_32x32x16_bf16 v[96:111], v[196:199], v[112:115], v[96:111]
  ds_read_b128 v[220:223], v5 offset:11264
  buffer_load_dwordx4 v[136:139], v5, s[8:11], s53 offen offset:2048 sc1
  buffer_load_dwordx4 v[140:143], v5, s[8:11], s53 offen offset:3072 sc1
  s_waitcnt vmcnt(8)
  s_waitcnt lgkmcnt(5)
  v_mfma_f32_32x32x16_bf16 v[16:31], v[200:203], v[116:119], v[16:31]
  ds_read_b128 v[176:179], v5 offset:12288
  s_waitcnt lgkmcnt(5)
  v_mfma_f32_32x32x16_bf16 v[32:47], v[204:207], v[116:119], v[32:47]
  ds_read_b128 v[180:183], v5 offset:13312
  s_waitcnt lgkmcnt(5)
  v_mfma_f32_32x32x16_bf16 v[48:63], v[208:211], v[116:119], v[48:63]
  ds_read_b128 v[184:187], v5 offset:14336
  s_waitcnt lgkmcnt(5)
  v_mfma_f32_32x32x16_bf16 v[64:79], v[212:215], v[116:119], v[64:79]
  ds_read_b128 v[188:191], v5 offset:15360
  s_waitcnt lgkmcnt(5)
  v_mfma_f32_32x32x16_bf16 v[80:95], v[216:219], v[116:119], v[80:95]
  ds_read_b128 v[192:195], v5 offset:16384
  s_waitcnt lgkmcnt(5)
  v_mfma_f32_32x32x16_bf16 v[96:111], v[220:223], v[116:119], v[96:111]
  ds_read_b128 v[196:199], v5 offset:17408
  s_add_u32 s53, s52, 8192
  buffer_load_dwordx4 v[144:147], v5, s[8:11], s53 offen offset:0 sc1
  buffer_load_dwordx4 v[148:151], v5, s[8:11], s53 offen offset:1024 sc1
  s_waitcnt vmcnt(7)
  s_waitcnt lgkmcnt(5)
  v_mfma_f32_32x32x16_bf16 v[16:31], v[176:179], v[120:123], v[16:31]
  ds_read_b128 v[200:203], v5 offset:18432
  s_waitcnt lgkmcnt(5)
  v_mfma_f32_32x32x16_bf16 v[32:47], v[180:183], v[120:123], v[32:47]
  ds_read_b128 v[204:207], v5 offset:19456
  s_waitcnt lgkmcnt(5)
  v_mfma_f32_32x32x16_bf16 v[48:63], v[184:187], v[120:123], v[48:63]
  ds_read_b128 v[208:211], v5 offset:20480
  s_waitcnt lgkmcnt(5)
  v_mfma_f32_32x32x16_bf16 v[64:79], v[188:191], v[120:123], v[64:79]
  ds_read_b128 v[212:215], v5 offset:21504
  s_waitcnt lgkmcnt(5)
  v_mfma_f32_32x32x16_bf16 v[80:95], v[192:195], v[120:123], v[80:95]
  ds_read_b128 v[216:219], v5 offset:22528
  s_waitcnt lgkmcnt(5)
  v_mfma_f32_32x32x16_bf16 v[96:111], v[196:199], v[120:123], v[96:111]
  ds_read_b128 v[220:223], v5 offset:23552
  buffer_load_dwordx4 v[152:155], v5, s[8:11], s53 offen offset:2048 sc1
  buffer_load_dwordx4 v[156:159], v5, s[8:11], s53 offen offset:3072 sc1
  s_waitcnt vmcnt(8)
  s_waitcnt lgkmcnt(5)
  v_mfma_f32_32x32x16_bf16 v[16:31], v[200:203], v[124:127], v[16:31]
  s_barrier
  ds_read_b128 v[176:179], v5 offset:24576
  v_add_f32 v232, v224, v226
  v_add_f32 v233, v228, v230
  v_add_f32 v232, v232, v233
  s_waitcnt lgkmcnt(5)
  v_mfma_f32_32x32x16_bf16 v[32:47], v[204:207], v[124:127], v[32:47]
  ds_read_b128 v[180:183], v5 offset:25600
  v_mov_b32 v233, v232
  v_mov_b32 v234, v232
  s_nop 1
  v_permlane32_swap_b32 v233, v234
  s_waitcnt lgkmcnt(5)
  v_mfma_f32_32x32x16_bf16 v[48:63], v[208:211], v[124:127], v[48:63]
  ds_read_b128 v[184:187], v5 offset:26624
  v_add_f32 v232, v233, v234
  v_mul_f32 v232, 0x3acccccd, v232
  s_mov_b32 s55, 0x3c4ccccd
  s_waitcnt lgkmcnt(5)
  v_mfma_f32_32x32x16_bf16 v[64:79], v[212:215], v[124:127], v[64:79]
  ds_read_b128 v[188:191], v5 offset:27648
  v_add_f32 v233, v225, v227
  v_add_f32 v234, v229, v231
  v_add_f32 v233, v233, v234
  s_waitcnt lgkmcnt(5)
  v_mfma_f32_32x32x16_bf16 v[80:95], v[216:219], v[124:127], v[80:95]
  ds_read_b128 v[192:195], v5 offset:28672
  v_mov_b32 v234, 0
  v_fma_f32 v224, v224, s55, -v232
  v_fmac_f32 v234, v224, v224
  s_waitcnt lgkmcnt(5)
  v_mfma_f32_32x32x16_bf16 v[96:111], v[220:223], v[124:127], v[96:111]
  ds_read_b128 v[196:199], v5 offset:29696
  v_fma_f32 v226, v226, s55, -v232
  v_fmac_f32 v234, v226, v226
  v_fma_f32 v228, v228, s55, -v232
  s_add_u32 s53, s52, 12288
  buffer_load_dwordx4 v[160:163], v5, s[8:11], s53 offen offset:0 sc1
  buffer_load_dwordx4 v[164:167], v5, s[8:11], s53 offen offset:1024 sc1
  s_waitcnt vmcnt(9)
  s_waitcnt lgkmcnt(5)
  v_mfma_f32_32x32x16_bf16 v[16:31], v[176:179], v[128:131], v[16:31]
  ds_read_b128 v[200:203], v5 offset:30720
  v_fmac_f32 v234, v228, v228
  v_fma_f32 v230, v230, s55, -v232
  v_fmac_f32 v234, v230, v230
  s_waitcnt lgkmcnt(5)
  v_mfma_f32_32x32x16_bf16 v[32:47], v[180:183], v[128:131], v[32:47]
  ds_read_b128 v[204:207], v5 offset:31744
  v_mov_b32 v235, 0x42a00000
  v_fmac_f32 v233, v234, v235
  v_mov_b32 v234, v233
  s_waitcnt lgkmcnt(5)
  v_mfma_f32_32x32x16_bf16 v[48:63], v[184:187], v[128:131], v[48:63]
  ds_read_b128 v[208:211], v5 offset:32768
  v_mov_b32 v235, v233
  s_nop 1
  v_permlane32_swap_b32 v234, v235
  v_add_f32 v233, v234, v235
  s_waitcnt lgkmcnt(5)
  v_mfma_f32_32x32x16_bf16 v[64:79], v[188:191], v[128:131], v[64:79]
  ds_read_b128 v[212:215], v5 offset:33792
  v_mov_b32 v234, 0x3727c5ac
  v_mov_b32 v235, 0x3acccccd
  v_fmac_f32 v234, v233, v235
  s_waitcnt lgkmcnt(5)
  v_mfma_f32_32x32x16_bf16 v[80:95], v[192:195], v[128:131], v[80:95]
  ds_read_b128 v[216:219], v5 offset:34816
  v_rsq_f32 v234, v234
  s_nop 0
  v_mov_b32 v236, v234
  s_waitcnt lgkmcnt(5)
  v_mfma_f32_32x32x16_bf16 v[96:111], v[196:199], v[128:131], v[96:111]
  ds_read_b128 v[220:223], v5 offset:35840
  v_mov_b32 v237, v234
  v_mul_f32 v238, 0xbfb8aa3b, v234
  v_mov_b32 v239, v238
  buffer_load_dwordx4 v[168:171], v5, s[8:11], s53 offen offset:2048 sc1
  s_waitcnt vmcnt(9)
  s_waitcnt lgkmcnt(5)
  v_mfma_f32_32x32x16_bf16 v[16:31], v[200:203], v[132:135], v[16:31]
  ds_read_b128 v[176:179], v5 offset:36864
  v_mul_f32 v240, v232, v234
  v_sub_f32 v240, 0, v240
  v_mov_b32 v241, v240
  s_waitcnt lgkmcnt(5)
  v_mfma_f32_32x32x16_bf16 v[32:47], v[204:207], v[132:135], v[32:47]
  ds_read_b128 v[180:183], v5 offset:37888
  s_waitcnt lgkmcnt(5)
  v_mfma_f32_32x32x16_bf16 v[48:63], v[208:211], v[132:135], v[48:63]
  ds_read_b128 v[184:187], v5 offset:38912
  s_waitcnt lgkmcnt(5)
  v_mfma_f32_32x32x16_bf16 v[64:79], v[212:215], v[132:135], v[64:79]
  ds_read_b128 v[188:191], v5 offset:39936
  s_waitcnt lgkmcnt(5)
  v_mfma_f32_32x32x16_bf16 v[80:95], v[216:219], v[132:135], v[80:95]
  ds_read_b128 v[192:195], v5 offset:40960
  s_waitcnt lgkmcnt(5)
  v_mfma_f32_32x32x16_bf16 v[96:111], v[220:223], v[132:135], v[96:111]
  ds_read_b128 v[196:199], v5 offset:41984
  buffer_load_dwordx4 v[172:175], v5, s[8:11], s53 offen offset:3072 sc1
  s_waitcnt vmcnt(9)
  s_waitcnt lgkmcnt(5)
  v_mfma_f32_32x32x16_bf16 v[16:31], v[176:179], v[136:139], v[16:31]
  ds_read_b128 v[200:203], v5 offset:43008
  s_waitcnt lgkmcnt(5)
  v_mfma_f32_32x32x16_bf16 v[32:47], v[180:183], v[136:139], v[32:47]
  ds_read_b128 v[204:207], v5 offset:44032
  s_waitcnt lgkmcnt(5)
  v_mfma_f32_32x32x16_bf16 v[48:63], v[184:187], v[136:139], v[48:63]
  ds_read_b128 v[208:211], v5 offset:45056
  s_waitcnt lgkmcnt(5)
  v_mfma_f32_32x32x16_bf16 v[64:79], v[188:191], v[136:139], v[64:79]
  ds_read_b128 v[212:215], v5 offset:46080
  s_waitcnt lgkmcnt(5)
  v_mfma_f32_32x32x16_bf16 v[80:95], v[192:195], v[136:139], v[80:95]
  ds_read_b128 v[216:219], v5 offset:47104
  s_waitcnt lgkmcnt(5)
  v_mfma_f32_32x32x16_bf16 v[96:111], v[196:199], v[136:139], v[96:111]
  ds_read_b128 v[220:223], v5 offset:48128
  s_add_u32 s53, s52, 16384
  buffer_load_dwordx4 v[112:115], v5, s[8:11], s53 offen offset:0 sc1
  s_waitcnt vmcnt(9)
  s_waitcnt lgkmcnt(5)
  v_mfma_f32_32x32x16_bf16 v[16:31], v[200:203], v[140:143], v[16:31]
  s_barrier
  ds_read_b128 v[176:179], v5 offset:49152
  s_waitcnt lgkmcnt(5)
  v_mfma_f32_32x32x16_bf16 v[32:47], v[204:207], v[140:143], v[32:47]
  ds_read_b128 v[180:183], v5 offset:50176
  s_waitcnt lgkmcnt(5)
  v_mfma_f32_32x32x16_bf16 v[48:63], v[208:211], v[140:143], v[48:63]
  ds_read_b128 v[184:187], v5 offset:51200
  s_waitcnt lgkmcnt(5)
  v_mfma_f32_32x32x16_bf16 v[64:79], v[212:215], v[140:143], v[64:79]
  ds_read_b128 v[188:191], v5 offset:52224
  s_waitcnt lgkmcnt(5)
  v_mfma_f32_32x32x16_bf16 v[80:95], v[216:219], v[140:143], v[80:95]
  ds_read_b128 v[192:195], v5 offset:53248
  s_waitcnt lgkmcnt(5)
  v_mfma_f32_32x32x16_bf16 v[96:111], v[220:223], v[140:143], v[96:111]
  ds_read_b128 v[196:199], v5 offset:54272
  buffer_load_dwordx4 v[116:119], v5, s[8:11], s53 offen offset:1024 sc1
  s_waitcnt vmcnt(9)
  s_waitcnt lgkmcnt(5)
  v_mfma_f32_32x32x16_bf16 v[16:31], v[176:179], v[144:147], v[16:31]
  ds_read_b128 v[200:203], v5 offset:55296
  s_waitcnt lgkmcnt(5)
  v_mfma_f32_32x32x16_bf16 v[32:47], v[180:183], v[144:147], v[32:47]
  ds_read_b128 v[204:207], v5 offset:56320
  s_waitcnt lgkmcnt(5)
  v_mfma_f32_32x32x16_bf16 v[48:63], v[184:187], v[144:147], v[48:63]
  ds_read_b128 v[208:211], v5 offset:57344
  s_waitcnt lgkmcnt(5)
  v_mfma_f32_32x32x16_bf16 v[64:79], v[188:191], v[144:147], v[64:79]
  ds_read_b128 v[212:215], v5 offset:58368
  s_waitcnt lgkmcnt(5)
  v_mfma_f32_32x32x16_bf16 v[80:95], v[192:195], v[144:147], v[80:95]
  ds_read_b128 v[216:219], v5 offset:59392
  s_waitcnt lgkmcnt(5)
  v_mfma_f32_32x32x16_bf16 v[96:111], v[196:199], v[144:147], v[96:111]
  ds_read_b128 v[220:223], v5 offset:60416
  buffer_load_dwordx4 v[120:123], v5, s[8:11], s53 offen offset:2048 sc1
  s_waitcnt vmcnt(9)
  s_waitcnt lgkmcnt(5)
  v_mfma_f32_32x32x16_bf16 v[16:31], v[200:203], v[148:151], v[16:31]
  ds_read_b128 v[176:179], v5 offset:61440
  s_waitcnt lgkmcnt(5)
  v_mfma_f32_32x32x16_bf16 v[32:47], v[204:207], v[148:151], v[32:47]
  ds_read_b128 v[180:183], v5 offset:62464
  s_waitcnt lgkmcnt(5)
  v_mfma_f32_32x32x16_bf16 v[48:63], v[208:211], v[148:151], v[48:63]
  ds_read_b128 v[184:187], v5 offset:63488
  s_waitcnt lgkmcnt(5)
  v_mfma_f32_32x32x16_bf16 v[64:79], v[212:215], v[148:151], v[64:79]
  ds_read_b128 v[188:191], v5 offset:64512
  s_waitcnt lgkmcnt(5)
  v_mfma_f32_32x32x16_bf16 v[80:95], v[216:219], v[148:151], v[80:95]
  ds_read_b128 v[192:195], v8 offset:0
  s_waitcnt lgkmcnt(5)
  v_mfma_f32_32x32x16_bf16 v[96:111], v[220:223], v[148:151], v[96:111]
  ds_read_b128 v[196:199], v8 offset:1024
  buffer_load_dwordx4 v[124:127], v5, s[8:11], s53 offen offset:3072 sc1
  s_waitcnt vmcnt(9)
  s_waitcnt lgkmcnt(5)
  v_mfma_f32_32x32x16_bf16 v[16:31], v[176:179], v[152:155], v[16:31]
  ds_read_b128 v[200:203], v8 offset:2048
  s_waitcnt lgkmcnt(5)
  v_mfma_f32_32x32x16_bf16 v[32:47], v[180:183], v[152:155], v[32:47]
  ds_read_b128 v[204:207], v8 offset:3072
  s_waitcnt lgkmcnt(5)
  v_mfma_f32_32x32x16_bf16 v[48:63], v[184:187], v[152:155], v[48:63]
  ds_read_b128 v[208:211], v8 offset:4096
  s_waitcnt lgkmcnt(5)
  v_mfma_f32_32x32x16_bf16 v[64:79], v[188:191], v[152:155], v[64:79]
  ds_read_b128 v[212:215], v8 offset:5120
  s_waitcnt lgkmcnt(5)
  v_mfma_f32_32x32x16_bf16 v[80:95], v[192:195], v[152:155], v[80:95]
  ds_read_b128 v[216:219], v8 offset:6144
  s_waitcnt lgkmcnt(5)
  v_mfma_f32_32x32x16_bf16 v[96:111], v[196:199], v[152:155], v[96:111]
  ds_read_b128 v[220:223], v8 offset:7168
  s_add_u32 s53, s52, 20480
  buffer_load_dwordx4 v[128:131], v5, s[8:11], s53 offen offset:0 sc1
  s_waitcnt vmcnt(9)
  s_waitcnt lgkmcnt(5)
  v_mfma_f32_32x32x16_bf16 v[16:31], v[200:203], v[156:159], v[16:31]
  s_barrier
  ds_read_b128 v[176:179], v8 offset:8192
  s_waitcnt lgkmcnt(5)
  v_mfma_f32_32x32x16_bf16 v[32:47], v[204:207], v[156:159], v[32:47]
  ds_read_b128 v[180:183], v8 offset:9216
  s_waitcnt lgkmcnt(5)
  v_mfma_f32_32x32x16_bf16 v[48:63], v[208:211], v[156:159], v[48:63]
  ds_read_b128 v[184:187], v8 offset:10240
  s_waitcnt lgkmcnt(5)
  v_mfma_f32_32x32x16_bf16 v[64:79], v[212:215], v[156:159], v[64:79]
  ds_read_b128 v[188:191], v8 offset:11264
  s_waitcnt lgkmcnt(5)
  v_mfma_f32_32x32x16_bf16 v[80:95], v[216:219], v[156:159], v[80:95]
  ds_read_b128 v[192:195], v8 offset:12288
  s_waitcnt lgkmcnt(5)
  v_mfma_f32_32x32x16_bf16 v[96:111], v[220:223], v[156:159], v[96:111]
  ds_read_b128 v[196:199], v8 offset:13312
  buffer_load_dwordx4 v[132:135], v5, s[8:11], s53 offen offset:1024 sc1
  s_waitcnt vmcnt(9)
  s_waitcnt lgkmcnt(5)
  v_mfma_f32_32x32x16_bf16 v[16:31], v[176:179], v[160:163], v[16:31]
  ds_read_b128 v[200:203], v8 offset:14336
  s_waitcnt lgkmcnt(5)
  v_mfma_f32_32x32x16_bf16 v[32:47], v[180:183], v[160:163], v[32:47]
  ds_read_b128 v[204:207], v8 offset:15360
  s_waitcnt lgkmcnt(5)
  v_mfma_f32_32x32x16_bf16 v[48:63], v[184:187], v[160:163], v[48:63]
  ds_read_b128 v[208:211], v8 offset:16384
  s_waitcnt lgkmcnt(5)
  v_mfma_f32_32x32x16_bf16 v[64:79], v[188:191], v[160:163], v[64:79]
  ds_read_b128 v[212:215], v8 offset:17408
  s_waitcnt lgkmcnt(5)
  v_mfma_f32_32x32x16_bf16 v[80:95], v[192:195], v[160:163], v[80:95]
  ds_read_b128 v[216:219], v8 offset:18432
  s_waitcnt lgkmcnt(5)
  v_mfma_f32_32x32x16_bf16 v[96:111], v[196:199], v[160:163], v[96:111]
  ds_read_b128 v[220:223], v8 offset:19456
  buffer_load_dwordx4 v[136:139], v5, s[8:11], s53 offen offset:2048 sc1
  s_waitcnt vmcnt(9)
  s_waitcnt lgkmcnt(5)
  v_mfma_f32_32x32x16_bf16 v[16:31], v[200:203], v[164:167], v[16:31]
  ds_read_b128 v[176:179], v8 offset:20480
  s_waitcnt lgkmcnt(5)
  v_mfma_f32_32x32x16_bf16 v[32:47], v[204:207], v[164:167], v[32:47]
  ds_read_b128 v[180:183], v8 offset:21504
  s_waitcnt lgkmcnt(5)
  v_mfma_f32_32x32x16_bf16 v[48:63], v[208:211], v[164:167], v[48:63]
  ds_read_b128 v[184:187], v8 offset:22528
  s_waitcnt lgkmcnt(5)
  v_mfma_f32_32x32x16_bf16 v[64:79], v[212:215], v[164:167], v[64:79]
  ds_read_b128 v[188:191], v8 offset:23552
  s_waitcnt lgkmcnt(5)
  v_mfma_f32_32x32x16_bf16 v[80:95], v[216:219], v[164:167], v[80:95]
  ds_read_b128 v[192:195], v8 offset:24576
  s_waitcnt lgkmcnt(5)
  v_mfma_f32_32x32x16_bf16 v[96:111], v[220:223], v[164:167], v[96:111]
  ds_read_b128 v[196:199], v8 offset:25600
  buffer_load_dwordx4 v[140:143], v5, s[8:11], s53 offen offset:3072 sc1
  s_waitcnt vmcnt(9)
  s_waitcnt lgkmcnt(5)
  v_mfma_f32_32x32x16_bf16 v[16:31], v[176:179], v[168:171], v[16:31]
  ds_read_b128 v[200:203], v8 offset:26624
  s_waitcnt lgkmcnt(5)
  v_mfma_f32_32x32x16_bf16 v[32:47], v[180:183], v[168:171], v[32:47]
  ds_read_b128 v[204:207], v8 offset:27648
  s_waitcnt lgkmcnt(5)
  v_mfma_f32_32x32x16_bf16 v[48:63], v[184:187], v[168:171], v[48:63]
  ds_read_b128 v[208:211], v8 offset:28672
  s_waitcnt lgkmcnt(5)
  v_mfma_f32_32x32x16_bf16 v[64:79], v[188:191], v[168:171], v[64:79]
  ds_read_b128 v[212:215], v8 offset:29696
  s_waitcnt lgkmcnt(5)
  v_mfma_f32_32x32x16_bf16 v[80:95], v[192:195], v[168:171], v[80:95]
  ds_read_b128 v[216:219], v8 offset:30720
  s_waitcnt lgkmcnt(5)
  v_mfma_f32_32x32x16_bf16 v[96:111], v[196:199], v[168:171], v[96:111]
  ds_read_b128 v[220:223], v8 offset:31744
  s_add_u32 s53, s52, 24576
  buffer_load_dwordx4 v[144:147], v5, s[8:11], s53 offen offset:0 sc1
  s_waitcnt vmcnt(9)
  s_waitcnt lgkmcnt(5)
  v_mfma_f32_32x32x16_bf16 v[16:31], v[200:203], v[172:175], v[16:31]
  s_barrier
  ds_read_b128 v[176:179], v8 offset:32768
  s_waitcnt lgkmcnt(5)
  v_mfma_f32_32x32x16_bf16 v[32:47], v[204:207], v[172:175], v[32:47]
  ds_read_b128 v[180:183], v8 offset:33792
  s_waitcnt lgkmcnt(5)
  v_mfma_f32_32x32x16_bf16 v[48:63], v[208:211], v[172:175], v[48:63]
  ds_read_b128 v[184:187], v8 offset:34816
  s_waitcnt lgkmcnt(5)
  v_mfma_f32_32x32x16_bf16 v[64:79], v[212:215], v[172:175], v[64:79]
  ds_read_b128 v[188:191], v8 offset:35840
  s_waitcnt lgkmcnt(5)
  v_mfma_f32_32x32x16_bf16 v[80:95], v[216:219], v[172:175], v[80:95]
  ds_read_b128 v[192:195], v8 offset:36864
  s_waitcnt lgkmcnt(5)
  v_mfma_f32_32x32x16_bf16 v[96:111], v[220:223], v[172:175], v[96:111]
  ds_read_b128 v[196:199], v8 offset:37888
  buffer_load_dwordx4 v[148:151], v5, s[8:11], s53 offen offset:1024 sc1
  s_waitcnt vmcnt(9)
  s_waitcnt lgkmcnt(5)
  v_mfma_f32_32x32x16_bf16 v[16:31], v[176:179], v[112:115], v[16:31]
  ds_read_b128 v[200:203], v8 offset:38912
  s_waitcnt lgkmcnt(5)
  v_mfma_f32_32x32x16_bf16 v[32:47], v[180:183], v[112:115], v[32:47]
  ds_read_b128 v[204:207], v8 offset:39936
  s_waitcnt lgkmcnt(5)
  v_mfma_f32_32x32x16_bf16 v[48:63], v[184:187], v[112:115], v[48:63]
  ds_read_b128 v[208:211], v8 offset:40960
  s_waitcnt lgkmcnt(5)
  v_mfma_f32_32x32x16_bf16 v[64:79], v[188:191], v[112:115], v[64:79]
  ds_read_b128 v[212:215], v8 offset:41984
  s_waitcnt lgkmcnt(5)
  v_mfma_f32_32x32x16_bf16 v[80:95], v[192:195], v[112:115], v[80:95]
  ds_read_b128 v[216:219], v8 offset:43008
  s_waitcnt lgkmcnt(5)
  v_mfma_f32_32x32x16_bf16 v[96:111], v[196:199], v[112:115], v[96:111]
  ds_read_b128 v[220:223], v8 offset:44032
  buffer_load_dwordx4 v[152:155], v5, s[8:11], s53 offen offset:2048 sc1
  s_waitcnt vmcnt(9)
  s_waitcnt lgkmcnt(5)
  v_mfma_f32_32x32x16_bf16 v[16:31], v[200:203], v[116:119], v[16:31]
  ds_read_b128 v[176:179], v8 offset:45056
  s_waitcnt lgkmcnt(5)
  v_mfma_f32_32x32x16_bf16 v[32:47], v[204:207], v[116:119], v[32:47]
  ds_read_b128 v[180:183], v8 offset:46080
  s_waitcnt lgkmcnt(5)
  v_mfma_f32_32x32x16_bf16 v[48:63], v[208:211], v[116:119], v[48:63]
  ds_read_b128 v[184:187], v8 offset:47104
  s_waitcnt lgkmcnt(5)
  v_mfma_f32_32x32x16_bf16 v[64:79], v[212:215], v[116:119], v[64:79]
  ds_read_b128 v[188:191], v8 offset:48128
  s_waitcnt lgkmcnt(5)
  v_mfma_f32_32x32x16_bf16 v[80:95], v[216:219], v[116:119], v[80:95]
  ds_read_b128 v[192:195], v8 offset:49152
  s_waitcnt lgkmcnt(5)
  v_mfma_f32_32x32x16_bf16 v[96:111], v[220:223], v[116:119], v[96:111]
  ds_read_b128 v[196:199], v8 offset:50176
  buffer_load_dwordx4 v[156:159], v5, s[8:11], s53 offen offset:3072 sc1
  s_waitcnt vmcnt(9)
  s_waitcnt lgkmcnt(5)
  v_mfma_f32_32x32x16_bf16 v[16:31], v[176:179], v[120:123], v[16:31]
  ds_read_b128 v[200:203], v8 offset:51200
  s_waitcnt lgkmcnt(5)
  v_mfma_f32_32x32x16_bf16 v[32:47], v[180:183], v[120:123], v[32:47]
  ds_read_b128 v[204:207], v8 offset:52224
  s_waitcnt lgkmcnt(5)
  v_mfma_f32_32x32x16_bf16 v[48:63], v[184:187], v[120:123], v[48:63]
  ds_read_b128 v[208:211], v8 offset:53248
  s_waitcnt lgkmcnt(5)
  v_mfma_f32_32x32x16_bf16 v[64:79], v[188:191], v[120:123], v[64:79]
  ds_read_b128 v[212:215], v8 offset:54272
  s_waitcnt lgkmcnt(5)
  v_mfma_f32_32x32x16_bf16 v[80:95], v[192:195], v[120:123], v[80:95]
  ds_read_b128 v[216:219], v8 offset:55296
  s_waitcnt lgkmcnt(5)
  v_mfma_f32_32x32x16_bf16 v[96:111], v[196:199], v[120:123], v[96:111]
  ds_read_b128 v[220:223], v8 offset:56320
  s_add_u32 s53, s52, 28672
  buffer_load_dwordx4 v[160:163], v5, s[8:11], s53 offen offset:0 sc1
  s_waitcnt vmcnt(9)
  s_waitcnt lgkmcnt(5)
  v_mfma_f32_32x32x16_bf16 v[16:31], v[200:203], v[124:127], v[16:31]
  s_barrier
  ds_read_b128 v[176:179], v8 offset:57344
  s_waitcnt lgkmcnt(5)
  v_mfma_f32_32x32x16_bf16 v[32:47], v[204:207], v[124:127], v[32:47]
  ds_read_b128 v[180:183], v8 offset:58368
  s_waitcnt lgkmcnt(5)
  v_mfma_f32_32x32x16_bf16 v[48:63], v[208:211], v[124:127], v[48:63]
  ds_read_b128 v[184:187], v8 offset:59392
  s_waitcnt lgkmcnt(5)
  v_mfma_f32_32x32x16_bf16 v[64:79], v[212:215], v[124:127], v[64:79]
  ds_read_b128 v[188:191], v8 offset:60416
  s_waitcnt lgkmcnt(5)
  v_mfma_f32_32x32x16_bf16 v[80:95], v[216:219], v[124:127], v[80:95]
  ds_read_b128 v[192:195], v8 offset:61440
  s_waitcnt lgkmcnt(5)
  v_mfma_f32_32x32x16_bf16 v[96:111], v[220:223], v[124:127], v[96:111]
  ds_read_b128 v[196:199], v8 offset:62464
  buffer_load_dwordx4 v[164:167], v5, s[8:11], s53 offen offset:1024 sc1
  s_waitcnt vmcnt(9)
  s_waitcnt lgkmcnt(5)
  v_mfma_f32_32x32x16_bf16 v[16:31], v[176:179], v[128:131], v[16:31]
  ds_read_b128 v[200:203], v8 offset:63488
  s_waitcnt lgkmcnt(5)
  v_mfma_f32_32x32x16_bf16 v[32:47], v[180:183], v[128:131], v[32:47]
  ds_read_b128 v[204:207], v8 offset:64512
  s_waitcnt lgkmcnt(5)
  v_mfma_f32_32x32x16_bf16 v[48:63], v[184:187], v[128:131], v[48:63]
  ds_read_b128 v[208:211], v9 offset:0
  s_waitcnt lgkmcnt(5)
  v_mfma_f32_32x32x16_bf16 v[64:79], v[188:191], v[128:131], v[64:79]
  ds_read_b128 v[212:215], v9 offset:1024
  s_waitcnt lgkmcnt(5)
  v_mfma_f32_32x32x16_bf16 v[80:95], v[192:195], v[128:131], v[80:95]
  ds_read_b128 v[216:219], v9 offset:2048
  s_waitcnt lgkmcnt(5)
  v_mfma_f32_32x32x16_bf16 v[96:111], v[196:199], v[128:131], v[96:111]
  ds_read_b128 v[220:223], v9 offset:3072
  buffer_load_dwordx4 v[168:171], v5, s[8:11], s53 offen offset:2048 sc1
  s_waitcnt vmcnt(9)
  s_waitcnt lgkmcnt(5)
  v_mfma_f32_32x32x16_bf16 v[16:31], v[200:203], v[132:135], v[16:31]
  ds_read_b128 v[176:179], v9 offset:4096
  s_waitcnt lgkmcnt(5)
  v_mfma_f32_32x32x16_bf16 v[32:47], v[204:207], v[132:135], v[32:47]
  ds_read_b128 v[180:183], v9 offset:5120
  s_waitcnt lgkmcnt(5)
  v_mfma_f32_32x32x16_bf16 v[48:63], v[208:211], v[132:135], v[48:63]
  ds_read_b128 v[184:187], v9 offset:6144
  s_waitcnt lgkmcnt(5)
  v_mfma_f32_32x32x16_bf16 v[64:79], v[212:215], v[132:135], v[64:79]
  ds_read_b128 v[188:191], v9 offset:7168
  s_waitcnt lgkmcnt(5)
  v_mfma_f32_32x32x16_bf16 v[80:95], v[216:219], v[132:135], v[80:95]
  ds_read_b128 v[192:195], v9 offset:8192
  s_waitcnt lgkmcnt(5)
  v_mfma_f32_32x32x16_bf16 v[96:111], v[220:223], v[132:135], v[96:111]
  ds_read_b128 v[196:199], v9 offset:9216
  buffer_load_dwordx4 v[172:175], v5, s[8:11], s53 offen offset:3072 sc1
  s_waitcnt vmcnt(9)
  s_waitcnt lgkmcnt(5)
  v_mfma_f32_32x32x16_bf16 v[16:31], v[176:179], v[136:139], v[16:31]
  ds_read_b128 v[200:203], v9 offset:10240
  s_waitcnt lgkmcnt(5)
  v_mfma_f32_32x32x16_bf16 v[32:47], v[180:183], v[136:139], v[32:47]
  ds_read_b128 v[204:207], v9 offset:11264
  s_waitcnt lgkmcnt(5)
  v_mfma_f32_32x32x16_bf16 v[48:63], v[184:187], v[136:139], v[48:63]
  ds_read_b128 v[208:211], v9 offset:12288
  s_waitcnt lgkmcnt(5)
  v_mfma_f32_32x32x16_bf16 v[64:79], v[188:191], v[136:139], v[64:79]
  ds_read_b128 v[212:215], v9 offset:13312
  s_waitcnt lgkmcnt(5)
  v_mfma_f32_32x32x16_bf16 v[80:95], v[192:195], v[136:139], v[80:95]
  ds_read_b128 v[216:219], v9 offset:14336
  s_waitcnt lgkmcnt(5)
  v_mfma_f32_32x32x16_bf16 v[96:111], v[196:199], v[136:139], v[96:111]
  ds_read_b128 v[220:223], v9 offset:15360
  s_add_u32 s53, s52, 32768
  buffer_load_dwordx4 v[112:115], v5, s[8:11], s53 offen offset:0 sc1
  s_waitcnt vmcnt(9)
  s_waitcnt lgkmcnt(5)
  v_mfma_f32_32x32x16_bf16 v[16:31], v[200:203], v[140:143], v[16:31]
  s_barrier
  ds_read_b128 v[176:179], v5 offset:0
  s_waitcnt lgkmcnt(5)
  v_mfma_f32_32x32x16_bf16 v[32:47], v[204:207], v[140:143], v[32:47]
  ds_read_b128 v[180:183], v5 offset:1024
  s_waitcnt lgkmcnt(5)
  v_mfma_f32_32x32x16_bf16 v[48:63], v[208:211], v[140:143], v[48:63]
  ds_read_b128 v[184:187], v5 offset:2048
  s_waitcnt lgkmcnt(5)
  v_mfma_f32_32x32x16_bf16 v[64:79], v[212:215], v[140:143], v[64:79]
  ds_read_b128 v[188:191], v5 offset:3072
  s_waitcnt lgkmcnt(5)
  v_mfma_f32_32x32x16_bf16 v[80:95], v[216:219], v[140:143], v[80:95]
  ds_read_b128 v[192:195], v5 offset:4096
  s_waitcnt lgkmcnt(5)
  v_mfma_f32_32x32x16_bf16 v[96:111], v[220:223], v[140:143], v[96:111]
  ds_read_b128 v[196:199], v5 offset:5120
  buffer_load_dwordx4 v[116:119], v5, s[8:11], s53 offen offset:1024 sc1
  s_waitcnt vmcnt(9)
  s_waitcnt lgkmcnt(5)
  v_mfma_f32_32x32x16_bf16 v[16:31], v[176:179], v[144:147], v[16:31]
  ds_read_b128 v[200:203], v5 offset:6144
  s_waitcnt lgkmcnt(5)
  v_mfma_f32_32x32x16_bf16 v[32:47], v[180:183], v[144:147], v[32:47]
  ds_read_b128 v[204:207], v5 offset:7168
  s_waitcnt lgkmcnt(5)
  v_mfma_f32_32x32x16_bf16 v[48:63], v[184:187], v[144:147], v[48:63]
  ds_read_b128 v[208:211], v5 offset:8192
  s_waitcnt lgkmcnt(5)
  v_mfma_f32_32x32x16_bf16 v[64:79], v[188:191], v[144:147], v[64:79]
  ds_read_b128 v[212:215], v5 offset:9216
  s_waitcnt lgkmcnt(5)
  v_mfma_f32_32x32x16_bf16 v[80:95], v[192:195], v[144:147], v[80:95]
  ds_read_b128 v[216:219], v5 offset:10240
  s_waitcnt lgkmcnt(5)
  v_mfma_f32_32x32x16_bf16 v[96:111], v[196:199], v[144:147], v[96:111]
  ds_read_b128 v[220:223], v5 offset:11264
  buffer_load_dwordx4 v[120:123], v5, s[8:11], s53 offen offset:2048 sc1
  s_waitcnt vmcnt(9)
  s_waitcnt lgkmcnt(5)
  v_mfma_f32_32x32x16_bf16 v[16:31], v[200:203], v[148:151], v[16:31]
  ds_read_b128 v[176:179], v5 offset:12288
  s_waitcnt lgkmcnt(5)
  v_mfma_f32_32x32x16_bf16 v[32:47], v[204:207], v[148:151], v[32:47]
  ds_read_b128 v[180:183], v5 offset:13312
  s_waitcnt lgkmcnt(5)
  v_mfma_f32_32x32x16_bf16 v[48:63], v[208:211], v[148:151], v[48:63]
  ds_read_b128 v[184:187], v5 offset:14336
  s_waitcnt lgkmcnt(5)
  v_mfma_f32_32x32x16_bf16 v[64:79], v[212:215], v[148:151], v[64:79]
  ds_read_b128 v[188:191], v5 offset:15360
  s_waitcnt lgkmcnt(5)
  v_mfma_f32_32x32x16_bf16 v[80:95], v[216:219], v[148:151], v[80:95]
  ds_read_b128 v[192:195], v5 offset:16384
  s_waitcnt lgkmcnt(5)
  v_mfma_f32_32x32x16_bf16 v[96:111], v[220:223], v[148:151], v[96:111]
  ds_read_b128 v[196:199], v5 offset:17408
  buffer_load_dwordx4 v[124:127], v5, s[8:11], s53 offen offset:3072 sc1
  s_waitcnt vmcnt(9)
  s_waitcnt lgkmcnt(5)
  v_mfma_f32_32x32x16_bf16 v[16:31], v[176:179], v[152:155], v[16:31]
  ds_read_b128 v[200:203], v5 offset:18432
  s_waitcnt lgkmcnt(5)
  v_mfma_f32_32x32x16_bf16 v[32:47], v[180:183], v[152:155], v[32:47]
  ds_read_b128 v[204:207], v5 offset:19456
  s_waitcnt lgkmcnt(5)
  v_mfma_f32_32x32x16_bf16 v[48:63], v[184:187], v[152:155], v[48:63]
  ds_read_b128 v[208:211], v5 offset:20480
  s_waitcnt lgkmcnt(5)
  v_mfma_f32_32x32x16_bf16 v[64:79], v[188:191], v[152:155], v[64:79]
  ds_read_b128 v[212:215], v5 offset:21504
  s_waitcnt lgkmcnt(5)
  v_mfma_f32_32x32x16_bf16 v[80:95], v[192:195], v[152:155], v[80:95]
  ds_read_b128 v[216:219], v5 offset:22528
  s_waitcnt lgkmcnt(5)
  v_mfma_f32_32x32x16_bf16 v[96:111], v[196:199], v[152:155], v[96:111]
  ds_read_b128 v[220:223], v5 offset:23552
  s_add_u32 s53, s52, 36864
  buffer_load_dwordx4 v[128:131], v5, s[8:11], s53 offen offset:0 sc1
  s_waitcnt vmcnt(9)
  s_waitcnt lgkmcnt(5)
  v_mfma_f32_32x32x16_bf16 v[16:31], v[200:203], v[156:159], v[16:31]
  s_barrier
  ds_read_b128 v[176:179], v5 offset:24576
  s_waitcnt lgkmcnt(5)
  v_mfma_f32_32x32x16_bf16 v[32:47], v[204:207], v[156:159], v[32:47]
  ds_read_b128 v[180:183], v5 offset:25600
  s_waitcnt lgkmcnt(5)
  v_mfma_f32_32x32x16_bf16 v[48:63], v[208:211], v[156:159], v[48:63]
  ds_read_b128 v[184:187], v5 offset:26624
  s_waitcnt lgkmcnt(5)
  v_mfma_f32_32x32x16_bf16 v[64:79], v[212:215], v[156:159], v[64:79]
  ds_read_b128 v[188:191], v5 offset:27648
  s_waitcnt lgkmcnt(5)
  v_mfma_f32_32x32x16_bf16 v[80:95], v[216:219], v[156:159], v[80:95]
  ds_read_b128 v[192:195], v5 offset:28672
  s_waitcnt lgkmcnt(5)
  v_mfma_f32_32x32x16_bf16 v[96:111], v[220:223], v[156:159], v[96:111]
  ds_read_b128 v[196:199], v5 offset:29696
  buffer_load_dwordx4 v[132:135], v5, s[8:11], s53 offen offset:1024 sc1
  s_waitcnt vmcnt(9)
  s_waitcnt lgkmcnt(5)
  v_mfma_f32_32x32x16_bf16 v[16:31], v[176:179], v[160:163], v[16:31]
  ds_read_b128 v[200:203], v5 offset:30720
  s_waitcnt lgkmcnt(5)
  v_mfma_f32_32x32x16_bf16 v[32:47], v[180:183], v[160:163], v[32:47]
  ds_read_b128 v[204:207], v5 offset:31744
  s_waitcnt lgkmcnt(5)
  v_mfma_f32_32x32x16_bf16 v[48:63], v[184:187], v[160:163], v[48:63]
  ds_read_b128 v[208:211], v5 offset:32768
  s_waitcnt lgkmcnt(5)
  v_mfma_f32_32x32x16_bf16 v[64:79], v[188:191], v[160:163], v[64:79]
  ds_read_b128 v[212:215], v5 offset:33792
  s_waitcnt lgkmcnt(5)
  v_mfma_f32_32x32x16_bf16 v[80:95], v[192:195], v[160:163], v[80:95]
  ds_read_b128 v[216:219], v5 offset:34816
  s_waitcnt lgkmcnt(5)
  v_mfma_f32_32x32x16_bf16 v[96:111], v[196:199], v[160:163], v[96:111]
  ds_read_b128 v[220:223], v5 offset:35840
  buffer_load_dwordx4 v[136:139], v5, s[8:11], s53 offen offset:2048 sc1
  s_waitcnt vmcnt(9)
  s_waitcnt lgkmcnt(5)
  v_mfma_f32_32x32x16_bf16 v[16:31], v[200:203], v[164:167], v[16:31]
  ds_read_b128 v[176:179], v5 offset:36864
  s_waitcnt lgkmcnt(5)
  v_mfma_f32_32x32x16_bf16 v[32:47], v[204:207], v[164:167], v[32:47]
  ds_read_b128 v[180:183], v5 offset:37888
  s_waitcnt lgkmcnt(5)
  v_mfma_f32_32x32x16_bf16 v[48:63], v[208:211], v[164:167], v[48:63]
  ds_read_b128 v[184:187], v5 offset:38912
  s_waitcnt lgkmcnt(5)
  v_mfma_f32_32x32x16_bf16 v[64:79], v[212:215], v[164:167], v[64:79]
  ds_read_b128 v[188:191], v5 offset:39936
  s_waitcnt lgkmcnt(5)
  v_mfma_f32_32x32x16_bf16 v[80:95], v[216:219], v[164:167], v[80:95]
  ds_read_b128 v[192:195], v5 offset:40960
  s_waitcnt lgkmcnt(5)
  v_mfma_f32_32x32x16_bf16 v[96:111], v[220:223], v[164:167], v[96:111]
  ds_read_b128 v[196:199], v5 offset:41984
  buffer_load_dwordx4 v[140:143], v5, s[8:11], s53 offen offset:3072 sc1
  s_waitcnt vmcnt(9)
  s_waitcnt lgkmcnt(5)
  v_mfma_f32_32x32x16_bf16 v[16:31], v[176:179], v[168:171], v[16:31]
  ds_read_b128 v[200:203], v5 offset:43008
  s_waitcnt lgkmcnt(5)
  v_mfma_f32_32x32x16_bf16 v[32:47], v[180:183], v[168:171], v[32:47]
  ds_read_b128 v[204:207], v5 offset:44032
  s_waitcnt lgkmcnt(5)
  v_mfma_f32_32x32x16_bf16 v[48:63], v[184:187], v[168:171], v[48:63]
  ds_read_b128 v[208:211], v5 offset:45056
  s_waitcnt lgkmcnt(5)
  v_mfma_f32_32x32x16_bf16 v[64:79], v[188:191], v[168:171], v[64:79]
  ds_read_b128 v[212:215], v5 offset:46080
  s_waitcnt lgkmcnt(5)
  v_mfma_f32_32x32x16_bf16 v[80:95], v[192:195], v[168:171], v[80:95]
  ds_read_b128 v[216:219], v5 offset:47104
  s_waitcnt lgkmcnt(5)
  v_mfma_f32_32x32x16_bf16 v[96:111], v[196:199], v[168:171], v[96:111]
  ds_read_b128 v[220:223], v5 offset:48128
  s_waitcnt vmcnt(8)
  s_waitcnt lgkmcnt(5)
  v_mfma_f32_32x32x16_bf16 v[16:31], v[200:203], v[172:175], v[16:31]
  s_barrier
  ds_read_b128 v[176:179], v5 offset:49152
  s_waitcnt lgkmcnt(5)
  v_mfma_f32_32x32x16_bf16 v[32:47], v[204:207], v[172:175], v[32:47]
  ds_read_b128 v[180:183], v5 offset:50176
  s_waitcnt lgkmcnt(5)
  v_mfma_f32_32x32x16_bf16 v[48:63], v[208:211], v[172:175], v[48:63]
  ds_read_b128 v[184:187], v5 offset:51200
  s_waitcnt lgkmcnt(5)
  v_mfma_f32_32x32x16_bf16 v[64:79], v[212:215], v[172:175], v[64:79]
  ds_read_b128 v[188:191], v5 offset:52224
  s_waitcnt lgkmcnt(5)
  v_mfma_f32_32x32x16_bf16 v[80:95], v[216:219], v[172:175], v[80:95]
  ds_read_b128 v[192:195], v5 offset:53248
  s_waitcnt lgkmcnt(5)
  v_mfma_f32_32x32x16_bf16 v[96:111], v[220:223], v[172:175], v[96:111]
  ds_read_b128 v[196:199], v5 offset:54272
  s_waitcnt vmcnt(7)
  s_waitcnt lgkmcnt(5)
  v_mfma_f32_32x32x16_bf16 v[16:31], v[176:179], v[112:115], v[16:31]
  ds_read_b128 v[200:203], v5 offset:55296
  s_waitcnt lgkmcnt(5)
  v_mfma_f32_32x32x16_bf16 v[32:47], v[180:183], v[112:115], v[32:47]
  ds_read_b128 v[204:207], v5 offset:56320
  s_waitcnt lgkmcnt(5)
  v_mfma_f32_32x32x16_bf16 v[48:63], v[184:187], v[112:115], v[48:63]
  ds_read_b128 v[208:211], v5 offset:57344
  s_waitcnt lgkmcnt(5)
  v_mfma_f32_32x32x16_bf16 v[64:79], v[188:191], v[112:115], v[64:79]
  ds_read_b128 v[212:215], v5 offset:58368
  s_waitcnt lgkmcnt(5)
  v_mfma_f32_32x32x16_bf16 v[80:95], v[192:195], v[112:115], v[80:95]
  ds_read_b128 v[216:219], v5 offset:59392
  s_waitcnt lgkmcnt(5)
  v_mfma_f32_32x32x16_bf16 v[96:111], v[196:199], v[112:115], v[96:111]
  ds_read_b128 v[220:223], v5 offset:60416
  s_waitcnt vmcnt(6)
  s_waitcnt lgkmcnt(5)
  v_mfma_f32_32x32x16_bf16 v[16:31], v[200:203], v[116:119], v[16:31]
  ds_read_b128 v[176:179], v5 offset:61440
  s_waitcnt lgkmcnt(5)
  v_mfma_f32_32x32x16_bf16 v[32:47], v[204:207], v[116:119], v[32:47]
  ds_read_b128 v[180:183], v5 offset:62464
  s_waitcnt lgkmcnt(5)
  v_mfma_f32_32x32x16_bf16 v[48:63], v[208:211], v[116:119], v[48:63]
  ds_read_b128 v[184:187], v5 offset:63488
  s_waitcnt lgkmcnt(5)
  v_mfma_f32_32x32x16_bf16 v[64:79], v[212:215], v[116:119], v[64:79]
  ds_read_b128 v[188:191], v5 offset:64512
  s_waitcnt lgkmcnt(5)
  v_mfma_f32_32x32x16_bf16 v[80:95], v[216:219], v[116:119], v[80:95]
  ds_read_b128 v[192:195], v8 offset:0
  s_waitcnt lgkmcnt(5)
  v_mfma_f32_32x32x16_bf16 v[96:111], v[220:223], v[116:119], v[96:111]
  ds_read_b128 v[196:199], v8 offset:1024
  s_waitcnt vmcnt(5)
  s_waitcnt lgkmcnt(5)
  v_mfma_f32_32x32x16_bf16 v[16:31], v[176:179], v[120:123], v[16:31]
  ds_read_b128 v[200:203], v8 offset:2048
  s_waitcnt lgkmcnt(5)
  v_mfma_f32_32x32x16_bf16 v[32:47], v[180:183], v[120:123], v[32:47]
  ds_read_b128 v[204:207], v8 offset:3072
  s_waitcnt lgkmcnt(5)
  v_mfma_f32_32x32x16_bf16 v[48:63], v[184:187], v[120:123], v[48:63]
  ds_read_b128 v[208:211], v8 offset:4096
  s_waitcnt lgkmcnt(5)
  v_mfma_f32_32x32x16_bf16 v[64:79], v[188:191], v[120:123], v[64:79]
  ds_read_b128 v[212:215], v8 offset:5120
  s_waitcnt lgkmcnt(5)
  v_mfma_f32_32x32x16_bf16 v[80:95], v[192:195], v[120:123], v[80:95]
  ds_read_b128 v[216:219], v8 offset:6144
  s_waitcnt lgkmcnt(5)
  v_mfma_f32_32x32x16_bf16 v[96:111], v[196:199], v[120:123], v[96:111]
  ds_read_b128 v[220:223], v8 offset:7168
  s_waitcnt vmcnt(4)
  s_waitcnt lgkmcnt(5)
  v_mfma_f32_32x32x16_bf16 v[16:31], v[200:203], v[124:127], v[16:31]
  s_barrier
  ds_read_b128 v[176:179], v8 offset:8192
  s_waitcnt lgkmcnt(5)
  v_mfma_f32_32x32x16_bf16 v[32:47], v[204:207], v[124:127], v[32:47]
  ds_read_b128 v[180:183], v8 offset:9216
  s_waitcnt lgkmcnt(5)
  v_mfma_f32_32x32x16_bf16 v[48:63], v[208:211], v[124:127], v[48:63]
  ds_read_b128 v[184:187], v8 offset:10240
  s_waitcnt lgkmcnt(5)
  v_mfma_f32_32x32x16_bf16 v[64:79], v[212:215], v[124:127], v[64:79]
  ds_read_b128 v[188:191], v8 offset:11264
  s_waitcnt lgkmcnt(5)
  v_mfma_f32_32x32x16_bf16 v[80:95], v[216:219], v[124:127], v[80:95]
  ds_read_b128 v[192:195], v8 offset:12288
  s_waitcnt lgkmcnt(5)
  v_mfma_f32_32x32x16_bf16 v[96:111], v[220:223], v[124:127], v[96:111]
  ds_read_b128 v[196:199], v8 offset:13312
  s_waitcnt vmcnt(3)
  s_waitcnt lgkmcnt(5)
  v_mfma_f32_32x32x16_bf16 v[16:31], v[176:179], v[128:131], v[16:31]
  ds_read_b128 v[200:203], v8 offset:14336
  s_waitcnt lgkmcnt(5)
  v_mfma_f32_32x32x16_bf16 v[32:47], v[180:183], v[128:131], v[32:47]
  ds_read_b128 v[204:207], v8 offset:15360
  s_waitcnt lgkmcnt(5)
  v_mfma_f32_32x32x16_bf16 v[48:63], v[184:187], v[128:131], v[48:63]
  ds_read_b128 v[208:211], v8 offset:16384
  s_waitcnt lgkmcnt(5)
  v_mfma_f32_32x32x16_bf16 v[64:79], v[188:191], v[128:131], v[64:79]
  ds_read_b128 v[212:215], v8 offset:17408
  s_waitcnt lgkmcnt(5)
  v_mfma_f32_32x32x16_bf16 v[80:95], v[192:195], v[128:131], v[80:95]
  ds_read_b128 v[216:219], v8 offset:18432
  s_waitcnt lgkmcnt(5)
  v_mfma_f32_32x32x16_bf16 v[96:111], v[196:199], v[128:131], v[96:111]
  ds_read_b128 v[220:223], v8 offset:19456
  s_waitcnt vmcnt(2)
  s_waitcnt lgkmcnt(5)
  v_mfma_f32_32x32x16_bf16 v[16:31], v[200:203], v[132:135], v[16:31]
  ds_read_b128 v[176:179], v8 offset:20480
  s_waitcnt lgkmcnt(5)
  v_mfma_f32_32x32x16_bf16 v[32:47], v[204:207], v[132:135], v[32:47]
  ds_read_b128 v[180:183], v8 offset:21504
  s_waitcnt lgkmcnt(5)
  v_mfma_f32_32x32x16_bf16 v[48:63], v[208:211], v[132:135], v[48:63]
  ds_read_b128 v[184:187], v8 offset:22528
  s_waitcnt lgkmcnt(5)
  v_mfma_f32_32x32x16_bf16 v[64:79], v[212:215], v[132:135], v[64:79]
  ds_read_b128 v[188:191], v8 offset:23552
  s_waitcnt lgkmcnt(5)
  v_mfma_f32_32x32x16_bf16 v[80:95], v[216:219], v[132:135], v[80:95]
  ds_read_b128 v[192:195], v8 offset:24576
  s_waitcnt lgkmcnt(5)
  v_mfma_f32_32x32x16_bf16 v[96:111], v[220:223], v[132:135], v[96:111]
  ds_read_b128 v[196:199], v8 offset:25600
  s_waitcnt vmcnt(1)
  s_waitcnt lgkmcnt(5)
  v_mfma_f32_32x32x16_bf16 v[16:31], v[176:179], v[136:139], v[16:31]
  ds_read_b128 v[200:203], v8 offset:26624
  s_waitcnt lgkmcnt(5)
  v_mfma_f32_32x32x16_bf16 v[32:47], v[180:183], v[136:139], v[32:47]
  ds_read_b128 v[204:207], v8 offset:27648
  s_waitcnt lgkmcnt(5)
  v_mfma_f32_32x32x16_bf16 v[48:63], v[184:187], v[136:139], v[48:63]
  ds_read_b128 v[208:211], v8 offset:28672
  s_waitcnt lgkmcnt(5)
  v_mfma_f32_32x32x16_bf16 v[64:79], v[188:191], v[136:139], v[64:79]
  ds_read_b128 v[212:215], v8 offset:29696
  s_waitcnt lgkmcnt(5)
  v_mfma_f32_32x32x16_bf16 v[80:95], v[192:195], v[136:139], v[80:95]
  ds_read_b128 v[216:219], v8 offset:30720
  s_waitcnt lgkmcnt(5)
  v_mfma_f32_32x32x16_bf16 v[96:111], v[196:199], v[136:139], v[96:111]
  ds_read_b128 v[220:223], v8 offset:31744
  s_waitcnt vmcnt(0)
  s_waitcnt lgkmcnt(5)
  v_mfma_f32_32x32x16_bf16 v[16:31], v[200:203], v[140:143], v[16:31]
  s_waitcnt lgkmcnt(4)
  v_mfma_f32_32x32x16_bf16 v[32:47], v[204:207], v[140:143], v[32:47]
  s_waitcnt lgkmcnt(3)
  v_mfma_f32_32x32x16_bf16 v[48:63], v[208:211], v[140:143], v[48:63]
  s_waitcnt lgkmcnt(2)
  v_mfma_f32_32x32x16_bf16 v[64:79], v[212:215], v[140:143], v[64:79]
  s_waitcnt lgkmcnt(1)
  v_mfma_f32_32x32x16_bf16 v[80:95], v[216:219], v[140:143], v[80:95]
  s_waitcnt lgkmcnt(0)
  v_mfma_f32_32x32x16_bf16 v[96:111], v[220:223], v[140:143], v[96:111]
  v_lshlrev_b32 v10, 4, v4
  v_add_u32 v10, 147456, v10
  s_lshl_b32 s52, s15, 1
  s_mul_i32 s52, s52, 49152
  s_mul_i32 s53, s7, 3072
  s_add_u32 s52, s52, s53
  s_add_u32 s52, s52, 22704128
  v_lshrrev_b32 v11, 4, v3
  v_mul_u32_u24 v11, 0xc000, v11
  v_and_b32 v12, 15, v3
  v_lshl_add_u32 v11, v12, 4, v11
  v_lshl_add_u32 v11, v4, 8, v11
  v_mov_b32 v242, 1.0
  v_mov_b32 v243, 1.0
  ds_read_b128 v[112:115], v10 offset:0
  ds_read_b128 v[116:119], v10 offset:32
  ds_read_b128 v[120:123], v10 offset:64
  ds_read_b128 v[124:127], v10 offset:96
  ds_read_b128 v[128:131], v10 offset:128
  ds_read_b128 v[132:135], v10 offset:160
  ds_read_b128 v[136:139], v10 offset:192
  ds_read_b128 v[140:143], v10 offset:224
  ds_read_b128 v[144:147], v10 offset:768
  ds_read_b128 v[148:151], v10 offset:800
  ds_read_b128 v[152:155], v10 offset:832
  ds_read_b128 v[156:159], v10 offset:864
  ds_read_b128 v[160:163], v10 offset:896
  ds_read_b128 v[164:167], v10 offset:928
  ds_read_b128 v[168:171], v10 offset:960
  ds_read_b128 v[172:175], v10 offset:992
  s_waitcnt lgkmcnt(8)
  v_pk_fma_f32 v[128:129], v[112:113], v[240:241], v[128:129]
  v_pk_fma_f32 v[16:17], v[16:17], v[238:239], v[128:129]
  v_pk_fma_f32 v[130:131], v[114:115], v[240:241], v[130:131]
  v_pk_fma_f32 v[18:19], v[18:19], v[238:239], v[130:131]
  v_pk_fma_f32 v[132:133], v[116:117], v[240:241], v[132:133]
  v_pk_fma_f32 v[20:21], v[20:21], v[238:239], v[132:133]
  v_pk_fma_f32 v[134:135], v[118:119], v[240:241], v[134:135]
  v_pk_fma_f32 v[22:23], v[22:23], v[238:239], v[134:135]
  v_pk_fma_f32 v[136:137], v[120:121], v[240:241], v[136:137]
  v_pk_fma_f32 v[24:25], v[24:25], v[238:239], v[136:137]
  v_pk_fma_f32 v[138:139], v[122:123], v[240:241], v[138:139]
  v_pk_fma_f32 v[26:27], v[26:27], v[238:239], v[138:139]
  v_pk_fma_f32 v[140:141], v[124:125], v[240:241], v[140:141]
  v_pk_fma_f32 v[28:29], v[28:29], v[238:239], v[140:141]
  v_pk_fma_f32 v[142:143], v[126:127], v[240:241], v[142:143]
  v_pk_fma_f32 v[30:31], v[30:31], v[238:239], v[142:143]
  ds_read_b128 v[192:195], v10 offset:256
  ds_read_b128 v[196:199], v10 offset:288
  ds_read_b128 v[200:203], v10 offset:320
  ds_read_b128 v[204:207], v10 offset:352
  ds_read_b128 v[208:211], v10 offset:384
  ds_read_b128 v[212:215], v10 offset:416
  ds_read_b128 v[216:219], v10 offset:448
  ds_read_b128 v[220:223], v10 offset:480
  v_exp_f32 v16, v16
  v_exp_f32 v17, v17
  v_exp_f32 v18, v18
  v_exp_f32 v19, v19
  v_exp_f32 v20, v20
  v_exp_f32 v21, v21
  v_exp_f32 v22, v22
  v_exp_f32 v23, v23
  v_exp_f32 v24, v24
  v_exp_f32 v25, v25
  v_exp_f32 v26, v26
  v_exp_f32 v27, v27
  v_exp_f32 v28, v28
  v_exp_f32 v29, v29
  v_exp_f32 v30, v30
  v_exp_f32 v31, v31
  s_waitcnt lgkmcnt(8)
  v_pk_fma_f32 v[160:161], v[144:145], v[240:241], v[160:161]
  v_pk_fma_f32 v[64:65], v[64:65], v[236:237], v[160:161]
  v_pk_fma_f32 v[162:163], v[146:147], v[240:241], v[162:163]
  v_pk_fma_f32 v[66:67], v[66:67], v[236:237], v[162:163]
  v_pk_fma_f32 v[164:165], v[148:149], v[240:241], v[164:165]
  v_pk_fma_f32 v[68:69], v[68:69], v[236:237], v[164:165]
  v_pk_fma_f32 v[166:167], v[150:151], v[240:241], v[166:167]
  v_pk_fma_f32 v[70:71], v[70:71], v[236:237], v[166:167]
  v_pk_fma_f32 v[168:169], v[152:153], v[240:241], v[168:169]
  v_pk_fma_f32 v[72:73], v[72:73], v[236:237], v[168:169]
  v_pk_fma_f32 v[170:171], v[154:155], v[240:241], v[170:171]
  v_pk_fma_f32 v[74:75], v[74:75], v[236:237], v[170:171]
  v_pk_fma_f32 v[172:173], v[156:157], v[240:241], v[172:173]
  v_pk_fma_f32 v[76:77], v[76:77], v[236:237], v[172:173]
  v_pk_fma_f32 v[174:175], v[158:159], v[240:241], v[174:175]
  v_pk_fma_f32 v[78:79], v[78:79], v[236:237], v[174:175]
  v_pk_add_f32 v[16:17], v[16:17], v[242:243]
  v_pk_add_f32 v[18:19], v[18:19], v[242:243]
  v_pk_add_f32 v[20:21], v[20:21], v[242:243]
  v_pk_add_f32 v[22:23], v[22:23], v[242:243]
  v_pk_add_f32 v[24:25], v[24:25], v[242:243]
  v_pk_add_f32 v[26:27], v[26:27], v[242:243]
  v_pk_add_f32 v[28:29], v[28:29], v[242:243]
  v_pk_add_f32 v[30:31], v[30:31], v[242:243]
  ds_read_b128 v[112:115], v10 offset:1024
  ds_read_b128 v[116:119], v10 offset:1056
  ds_read_b128 v[120:123], v10 offset:1088
  ds_read_b128 v[124:127], v10 offset:1120
  ds_read_b128 v[128:131], v10 offset:1152
  ds_read_b128 v[132:135], v10 offset:1184
  ds_read_b128 v[136:139], v10 offset:1216
  ds_read_b128 v[140:143], v10 offset:1248
  v_rcp_f32 v16, v16
  v_rcp_f32 v17, v17
  v_rcp_f32 v18, v18
  v_rcp_f32 v19, v19
  v_rcp_f32 v20, v20
  v_rcp_f32 v21, v21
  v_rcp_f32 v22, v22
  v_rcp_f32 v23, v23
  v_rcp_f32 v24, v24
  v_rcp_f32 v25, v25
  v_rcp_f32 v26, v26
  v_rcp_f32 v27, v27
  v_rcp_f32 v28, v28
  v_rcp_f32 v29, v29
  v_rcp_f32 v30, v30
  v_rcp_f32 v31, v31
  v_pk_mul_f32 v[16:17], v[16:17], v[64:65]
  v_pk_mul_f32 v[18:19], v[18:19], v[66:67]
  v_pk_mul_f32 v[20:21], v[20:21], v[68:69]
  v_pk_mul_f32 v[22:23], v[22:23], v[70:71]
  v_pk_mul_f32 v[24:25], v[24:25], v[72:73]
  v_pk_mul_f32 v[26:27], v[26:27], v[74:75]
  v_pk_mul_f32 v[28:29], v[28:29], v[76:77]
  v_pk_mul_f32 v[30:31], v[30:31], v[78:79]
  v_cvt_pk_bf16_f32 v176, v16, v17
  v_cvt_pk_bf16_f32 v177, v18, v19
  v_cvt_pk_bf16_f32 v178, v20, v21
  v_cvt_pk_bf16_f32 v179, v22, v23
  v_cvt_pk_bf16_f32 v180, v24, v25
  v_cvt_pk_bf16_f32 v181, v26, v27
  v_cvt_pk_bf16_f32 v182, v28, v29
  v_cvt_pk_bf16_f32 v183, v30, v31
  v_permlane32_swap_b32 v176, v178
  v_permlane32_swap_b32 v177, v179
  buffer_store_dwordx4 v[176:179], v11, s[8:11], s52 offen offset:0 sc0 sc1
  v_permlane32_swap_b32 v180, v182
  v_permlane32_swap_b32 v181, v183
  buffer_store_dwordx4 v[180:183], v11, s[8:11], s52 offen offset:512 sc0 sc1
  s_add_u32 s52, s52, 1024
  s_waitcnt lgkmcnt(8)
  v_pk_fma_f32 v[208:209], v[192:193], v[240:241], v[208:209]
  v_pk_fma_f32 v[32:33], v[32:33], v[238:239], v[208:209]
  v_pk_fma_f32 v[210:211], v[194:195], v[240:241], v[210:211]
  v_pk_fma_f32 v[34:35], v[34:35], v[238:239], v[210:211]
  v_pk_fma_f32 v[212:213], v[196:197], v[240:241], v[212:213]
  v_pk_fma_f32 v[36:37], v[36:37], v[238:239], v[212:213]
  v_pk_fma_f32 v[214:215], v[198:199], v[240:241], v[214:215]
  v_pk_fma_f32 v[38:39], v[38:39], v[238:239], v[214:215]
  v_pk_fma_f32 v[216:217], v[200:201], v[240:241], v[216:217]
  v_pk_fma_f32 v[40:41], v[40:41], v[238:239], v[216:217]
  v_pk_fma_f32 v[218:219], v[202:203], v[240:241], v[218:219]
  v_pk_fma_f32 v[42:43], v[42:43], v[238:239], v[218:219]
  v_pk_fma_f32 v[220:221], v[204:205], v[240:241], v[220:221]
  v_pk_fma_f32 v[44:45], v[44:45], v[238:239], v[220:221]
  v_pk_fma_f32 v[222:223], v[206:207], v[240:241], v[222:223]
  v_pk_fma_f32 v[46:47], v[46:47], v[238:239], v[222:223]
  v_exp_f32 v32, v32
  v_exp_f32 v33, v33
  v_exp_f32 v34, v34
  v_exp_f32 v35, v35
  v_exp_f32 v36, v36
  v_exp_f32 v37, v37
  v_exp_f32 v38, v38
  v_exp_f32 v39, v39
  v_exp_f32 v40, v40
  v_exp_f32 v41, v41
  v_exp_f32 v42, v42
  v_exp_f32 v43, v43
  v_exp_f32 v44, v44
  v_exp_f32 v45, v45
  v_exp_f32 v46, v46
  v_exp_f32 v47, v47
  s_waitcnt lgkmcnt(0)
  v_pk_fma_f32 v[128:129], v[112:113], v[240:241], v[128:129]
  v_pk_fma_f32 v[80:81], v[80:81], v[236:237], v[128:129]
  v_pk_fma_f32 v[130:131], v[114:115], v[240:241], v[130:131]
  v_pk_fma_f32 v[82:83], v[82:83], v[236:237], v[130:131]
  v_pk_fma_f32 v[132:133], v[116:117], v[240:241], v[132:133]
  v_pk_fma_f32 v[84:85], v[84:85], v[236:237], v[132:133]
  v_pk_fma_f32 v[134:135], v[118:119], v[240:241], v[134:135]
  v_pk_fma_f32 v[86:87], v[86:87], v[236:237], v[134:135]
  v_pk_fma_f32 v[136:137], v[120:121], v[240:241], v[136:137]
  v_pk_fma_f32 v[88:89], v[88:89], v[236:237], v[136:137]
  v_pk_fma_f32 v[138:139], v[122:123], v[240:241], v[138:139]
  v_pk_fma_f32 v[90:91], v[90:91], v[236:237], v[138:139]
  v_pk_fma_f32 v[140:141], v[124:125], v[240:241], v[140:141]
  v_pk_fma_f32 v[92:93], v[92:93], v[236:237], v[140:141]
  v_pk_fma_f32 v[142:143], v[126:127], v[240:241], v[142:143]
  v_pk_fma_f32 v[94:95], v[94:95], v[236:237], v[142:143]
  v_pk_add_f32 v[32:33], v[32:33], v[242:243]
  v_pk_add_f32 v[34:35], v[34:35], v[242:243]
  v_pk_add_f32 v[36:37], v[36:37], v[242:243]
  v_pk_add_f32 v[38:39], v[38:39], v[242:243]
  v_pk_add_f32 v[40:41], v[40:41], v[242:243]
  v_pk_add_f32 v[42:43], v[42:43], v[242:243]
  v_pk_add_f32 v[44:45], v[44:45], v[242:243]
  v_pk_add_f32 v[46:47], v[46:47], v[242:243]
  ds_read_b128 v[144:147], v10 offset:512
  ds_read_b128 v[148:151], v10 offset:544
  ds_read_b128 v[152:155], v10 offset:576
  ds_read_b128 v[156:159], v10 offset:608
  ds_read_b128 v[160:163], v10 offset:640
  ds_read_b128 v[164:167], v10 offset:672
  ds_read_b128 v[168:171], v10 offset:704
  ds_read_b128 v[172:175], v10 offset:736
  ds_read_b128 v[192:195], v10 offset:1280
  ds_read_b128 v[196:199], v10 offset:1312
  ds_read_b128 v[200:203], v10 offset:1344
  ds_read_b128 v[204:207], v10 offset:1376
  ds_read_b128 v[208:211], v10 offset:1408
  ds_read_b128 v[212:215], v10 offset:1440
  ds_read_b128 v[216:219], v10 offset:1472
  ds_read_b128 v[220:223], v10 offset:1504
  v_rcp_f32 v32, v32
  v_rcp_f32 v33, v33
  v_rcp_f32 v34, v34
  v_rcp_f32 v35, v35
  v_rcp_f32 v36, v36
  v_rcp_f32 v37, v37
  v_rcp_f32 v38, v38
  v_rcp_f32 v39, v39
  v_rcp_f32 v40, v40
  v_rcp_f32 v41, v41
  v_rcp_f32 v42, v42
  v_rcp_f32 v43, v43
  v_rcp_f32 v44, v44
  v_rcp_f32 v45, v45
  v_rcp_f32 v46, v46
  v_rcp_f32 v47, v47
  v_pk_mul_f32 v[32:33], v[32:33], v[80:81]
  v_pk_mul_f32 v[34:35], v[34:35], v[82:83]
  v_pk_mul_f32 v[36:37], v[36:37], v[84:85]
  v_pk_mul_f32 v[38:39], v[38:39], v[86:87]
  v_pk_mul_f32 v[40:41], v[40:41], v[88:89]
  v_pk_mul_f32 v[42:43], v[42:43], v[90:91]
  v_pk_mul_f32 v[44:45], v[44:45], v[92:93]
  v_pk_mul_f32 v[46:47], v[46:47], v[94:95]
  v_cvt_pk_bf16_f32 v184, v32, v33
  v_cvt_pk_bf16_f32 v185, v34, v35
  v_cvt_pk_bf16_f32 v186, v36, v37
  v_cvt_pk_bf16_f32 v187, v38, v39
  v_cvt_pk_bf16_f32 v188, v40, v41
  v_cvt_pk_bf16_f32 v189, v42, v43
  v_cvt_pk_bf16_f32 v190, v44, v45
  v_cvt_pk_bf16_f32 v191, v46, v47
  v_permlane32_swap_b32 v184, v186
  v_permlane32_swap_b32 v185, v187
  buffer_store_dwordx4 v[184:187], v11, s[8:11], s52 offen offset:0 sc0 sc1
  v_permlane32_swap_b32 v188, v190
  v_permlane32_swap_b32 v189, v191
  buffer_store_dwordx4 v[188:191], v11, s[8:11], s52 offen offset:512 sc0 sc1
  s_add_u32 s52, s52, 1024
  s_waitcnt lgkmcnt(8)
  v_pk_fma_f32 v[160:161], v[144:145], v[240:241], v[160:161]
  v_pk_fma_f32 v[48:49], v[48:49], v[238:239], v[160:161]
  v_pk_fma_f32 v[162:163], v[146:147], v[240:241], v[162:163]
  v_pk_fma_f32 v[50:51], v[50:51], v[238:239], v[162:163]
  v_pk_fma_f32 v[164:165], v[148:149], v[240:241], v[164:165]
  v_pk_fma_f32 v[52:53], v[52:53], v[238:239], v[164:165]
  v_pk_fma_f32 v[166:167], v[150:151], v[240:241], v[166:167]
  v_pk_fma_f32 v[54:55], v[54:55], v[238:239], v[166:167]
  v_pk_fma_f32 v[168:169], v[152:153], v[240:241], v[168:169]
  v_pk_fma_f32 v[56:57], v[56:57], v[238:239], v[168:169]
  v_pk_fma_f32 v[170:171], v[154:155], v[240:241], v[170:171]
  v_pk_fma_f32 v[58:59], v[58:59], v[238:239], v[170:171]
  v_pk_fma_f32 v[172:173], v[156:157], v[240:241], v[172:173]
  v_pk_fma_f32 v[60:61], v[60:61], v[238:239], v[172:173]
  v_pk_fma_f32 v[174:175], v[158:159], v[240:241], v[174:175]
  v_pk_fma_f32 v[62:63], v[62:63], v[238:239], v[174:175]
  v_exp_f32 v48, v48
  v_exp_f32 v49, v49
  v_exp_f32 v50, v50
  v_exp_f32 v51, v51
  v_exp_f32 v52, v52
  v_exp_f32 v53, v53
  v_exp_f32 v54, v54
  v_exp_f32 v55, v55
  v_exp_f32 v56, v56
  v_exp_f32 v57, v57
  v_exp_f32 v58, v58
  v_exp_f32 v59, v59
  v_exp_f32 v60, v60
  v_exp_f32 v61, v61
  v_exp_f32 v62, v62
  v_exp_f32 v63, v63
  s_waitcnt lgkmcnt(0)
  v_pk_fma_f32 v[208:209], v[192:193], v[240:241], v[208:209]
  v_pk_fma_f32 v[96:97], v[96:97], v[236:237], v[208:209]
  v_pk_fma_f32 v[210:211], v[194:195], v[240:241], v[210:211]
  v_pk_fma_f32 v[98:99], v[98:99], v[236:237], v[210:211]
  v_pk_fma_f32 v[212:213], v[196:197], v[240:241], v[212:213]
  v_pk_fma_f32 v[100:101], v[100:101], v[236:237], v[212:213]
  v_pk_fma_f32 v[214:215], v[198:199], v[240:241], v[214:215]
  v_pk_fma_f32 v[102:103], v[102:103], v[236:237], v[214:215]
  v_pk_fma_f32 v[216:217], v[200:201], v[240:241], v[216:217]
  v_pk_fma_f32 v[104:105], v[104:105], v[236:237], v[216:217]
  v_pk_fma_f32 v[218:219], v[202:203], v[240:241], v[218:219]
  v_pk_fma_f32 v[106:107], v[106:107], v[236:237], v[218:219]
  v_pk_fma_f32 v[220:221], v[204:205], v[240:241], v[220:221]
  v_pk_fma_f32 v[108:109], v[108:109], v[236:237], v[220:221]
  v_pk_fma_f32 v[222:223], v[206:207], v[240:241], v[222:223]
  v_pk_fma_f32 v[110:111], v[110:111], v[236:237], v[222:223]
  v_pk_add_f32 v[48:49], v[48:49], v[242:243]
  v_pk_add_f32 v[50:51], v[50:51], v[242:243]
  v_pk_add_f32 v[52:53], v[52:53], v[242:243]
  v_pk_add_f32 v[54:55], v[54:55], v[242:243]
  v_pk_add_f32 v[56:57], v[56:57], v[242:243]
  v_pk_add_f32 v[58:59], v[58:59], v[242:243]
  v_pk_add_f32 v[60:61], v[60:61], v[242:243]
  v_pk_add_f32 v[62:63], v[62:63], v[242:243]
  v_rcp_f32 v48, v48
  v_rcp_f32 v49, v49
  v_rcp_f32 v50, v50
  v_rcp_f32 v51, v51
  v_rcp_f32 v52, v52
  v_rcp_f32 v53, v53
  v_rcp_f32 v54, v54
  v_rcp_f32 v55, v55
  v_rcp_f32 v56, v56
  v_rcp_f32 v57, v57
  v_rcp_f32 v58, v58
  v_rcp_f32 v59, v59
  v_rcp_f32 v60, v60
  v_rcp_f32 v61, v61
  v_rcp_f32 v62, v62
  v_rcp_f32 v63, v63
  v_pk_mul_f32 v[48:49], v[48:49], v[96:97]
  v_pk_mul_f32 v[50:51], v[50:51], v[98:99]
  v_pk_mul_f32 v[52:53], v[52:53], v[100:101]
  v_pk_mul_f32 v[54:55], v[54:55], v[102:103]
  v_pk_mul_f32 v[56:57], v[56:57], v[104:105]
  v_pk_mul_f32 v[58:59], v[58:59], v[106:107]
  v_pk_mul_f32 v[60:61], v[60:61], v[108:109]
  v_pk_mul_f32 v[62:63], v[62:63], v[110:111]
  v_cvt_pk_bf16_f32 v176, v48, v49
  v_cvt_pk_bf16_f32 v177, v50, v51
  v_cvt_pk_bf16_f32 v178, v52, v53
  v_cvt_pk_bf16_f32 v179, v54, v55
  v_cvt_pk_bf16_f32 v180, v56, v57
  v_cvt_pk_bf16_f32 v181, v58, v59
  v_cvt_pk_bf16_f32 v182, v60, v61
  v_cvt_pk_bf16_f32 v183, v62, v63
  v_permlane32_swap_b32 v176, v178
  v_permlane32_swap_b32 v177, v179
  buffer_store_dwordx4 v[176:179], v11, s[8:11], s52 offen offset:0 sc0 sc1
  v_permlane32_swap_b32 v180, v182
  v_permlane32_swap_b32 v181, v183
  buffer_store_dwordx4 v[180:183], v11, s[8:11], s52 offen offset:512 sc0 sc1
  s_add_u32 s52, s52, 1024
  s_waitcnt vmcnt(0)
  s_barrier
  s_cmp_lg_u32 s12, 0
  s_cbranch_scc1 adaLN_cond__mha_block__glu_gated_glu__prompt_s45w91
  s_add_u32 s52, s6, 72
  s_add_u32 s53, s6, 148
  s_lshl_b32 s48, s52, 8
  s_add_u32 s48, s48, 0
  v_mov_b32 v2, 0
  v_mov_b32 v3, 1
  s_mov_b64 exec, 1
  buffer_atomic_add v3, v2, s[8:11], s48 offen sc1
  s_mov_b64 exec, -1
  s_lshr_b32 s52, s4, 1
  s_add_u32 s52, s52, 72
  v_mov_b32 v5, 0
  v_mov_b32 v6, 0
  s_mov_b32 s51, s52
  v_add_u32 v7, s51, v1
  v_lshlrev_b32 v7, 8, v7
  v_subrev_u32 v8, 0, v1
  v_cmp_gt_u32 vcc, 1, v8
  s_nop 1
  v_cndmask_b32 v5, v5, v7, vcc
  v_mov_b32 v7, 16
  v_cndmask_b32 v6, v6, v7, vcc
  s_mov_b32 s49, 0
  s_mov_b32 s50, 0
adaLN_cond__mha_block__glu_gated_glu__prompt_poll92:
  buffer_load_dword v4, v5, s[8:11], s49 offen sc1
  s_waitcnt vmcnt(0)
  v_cmp_lt_u32 vcc, v4, v6
  s_nop 3
  s_cmp_eq_u64 vcc, 0
  s_cbranch_scc1 adaLN_cond__mha_block__glu_gated_glu__prompt_polled93
  s_add_u32 s50, s50, 1
  s_cmp_ge_u32 s50, 200000
  s_cbranch_scc1 adaLN_cond__mha_block__glu_gated_glu__prompt_polled93
  s_sleep 2
  s_branch adaLN_cond__mha_block__glu_gated_glu__prompt_poll92
adaLN_cond__mha_block__glu_gated_glu__prompt_polled93:
adaLN_cond__mha_block__glu_gated_glu__prompt_s45w91:
  s_barrier
  v_and_b32 v3, 15, v1
  v_lshrrev_b32 v4, 4, v1
  v_lshlrev_b32 v5, 4, v1
  s_lshl_b32 s15, s4, 2
  s_add_u32 s15, s15, s12
  s_lshl_b32 s52, s15, 4
  v_add_u32 v6, s52, v3
  s_movk_i32 s52, 1280
  v_mul_u32_u24 v6, s52, v6
  s_mul_i32 s52, s5, 160
  v_lshl_add_u32 v6, v4, 3, v6
  v_add_u32 v6, s52, v6
  v_add_u32 v8, 0x10000, v5
  v_add_u32 v9, 0x20000, v5
  s_mul_i32 s53, s15, 49152
  s_add_u32 s53, s53, 22704128
  s_add_u32 s54, s53, 0
  buffer_load_dwordx4 v[40:43], v5, s[8:11], s54 offen offset:0 sc1
  buffer_load_dwordx4 v[44:47], v5, s[8:11], s54 offen offset:1024 sc1
  buffer_load_dwordx4 v[48:51], v5, s[8:11], s54 offen offset:2048 sc1
  buffer_load_dwordx4 v[52:55], v5, s[8:11], s54 offen offset:3072 sc1
  s_add_u32 s54, s53, 4096
  buffer_load_dwordx4 v[56:59], v5, s[8:11], s54 offen offset:0 sc1
  buffer_load_dwordx4 v[60:63], v5, s[8:11], s54 offen offset:1024 sc1
  v_mov_b32 v16, 0
  v_mov_b32 v17, 0
  v_mov_b32 v18, 0
  v_mov_b32 v19, 0
  v_mov_b32 v20, 0
  v_mov_b32 v21, 0
  v_mov_b32 v22, 0
  v_mov_b32 v23, 0
  v_mov_b32 v24, 0
  v_mov_b32 v25, 0
  v_mov_b32 v26, 0
  v_mov_b32 v27, 0
  v_mov_b32 v28, 0
  v_mov_b32 v29, 0
  v_mov_b32 v30, 0
  v_mov_b32 v31, 0
  v_mov_b32 v32, 0
  v_mov_b32 v33, 0
  v_mov_b32 v34, 0
  v_mov_b32 v35, 0
  ds_read_b128 v[104:107], v5 offset:0
  ds_read_b128 v[108:111], v5 offset:1024
  ds_read_b128 v[112:115], v5 offset:2048
  ds_read_b128 v[116:119], v5 offset:3072
  ds_read_b128 v[120:123], v5 offset:4096
  s_waitcnt vmcnt(5)
  s_waitcnt lgkmcnt(4)
  v_mfma_f32_16x16x32_bf16 v[16:19], v[104:107], v[40:43], v[16:19]
  ds_read_b128 v[124:127], v5 offset:5120
  s_waitcnt lgkmcnt(4)
  v_mfma_f32_16x16x32_bf16 v[20:23], v[108:111], v[40:43], v[20:23]
  ds_read_b128 v[128:131], v5 offset:6144
  s_waitcnt lgkmcnt(4)
  v_mfma_f32_16x16x32_bf16 v[24:27], v[112:115], v[40:43], v[24:27]
  ds_read_b128 v[132:135], v5 offset:7168
  s_waitcnt lgkmcnt(4)
  v_mfma_f32_16x16x32_bf16 v[28:31], v[116:119], v[40:43], v[28:31]
  ds_read_b128 v[136:139], v5 offset:8192
  s_waitcnt lgkmcnt(4)
  v_mfma_f32_16x16x32_bf16 v[32:35], v[120:123], v[40:43], v[32:35]
  ds_read_b128 v[140:143], v5 offset:9216
  buffer_load_dwordx4 v[64:67], v5, s[8:11], s54 offen offset:2048 sc1
  buffer_load_dwordx4 v[68:71], v5, s[8:11], s54 offen offset:3072 sc1
  s_waitcnt vmcnt(6)
  s_waitcnt lgkmcnt(4)
  v_mfma_f32_16x16x32_bf16 v[16:19], v[124:127], v[44:47], v[16:19]
  ds_read_b128 v[104:107], v5 offset:10240
  s_waitcnt lgkmcnt(4)
  v_mfma_f32_16x16x32_bf16 v[20:23], v[128:131], v[44:47], v[20:23]
  ds_read_b128 v[108:111], v5 offset:11264
  s_waitcnt lgkmcnt(4)
  v_mfma_f32_16x16x32_bf16 v[24:27], v[132:135], v[44:47], v[24:27]
  ds_read_b128 v[112:115], v5 offset:12288
  s_waitcnt lgkmcnt(4)
  v_mfma_f32_16x16x32_bf16 v[28:31], v[136:139], v[44:47], v[28:31]
  ds_read_b128 v[116:119], v5 offset:13312
  s_waitcnt lgkmcnt(4)
  v_mfma_f32_16x16x32_bf16 v[32:35], v[140:143], v[44:47], v[32:35]
  ds_read_b128 v[120:123], v5 offset:14336
  s_add_u32 s54, s53, 8192
  buffer_load_dwordx4 v[72:75], v5, s[8:11], s54 offen offset:0 sc1
  buffer_load_dwordx4 v[76:79], v5, s[8:11], s54 offen offset:1024 sc1
  s_waitcnt vmcnt(7)
  s_waitcnt lgkmcnt(4)
  v_mfma_f32_16x16x32_bf16 v[16:19], v[104:107], v[48:51], v[16:19]
  ds_read_b128 v[124:127], v5 offset:15360
  s_waitcnt lgkmcnt(4)
  v_mfma_f32_16x16x32_bf16 v[20:23], v[108:111], v[48:51], v[20:23]
  ds_read_b128 v[128:131], v5 offset:16384
  s_waitcnt lgkmcnt(4)
  v_mfma_f32_16x16x32_bf16 v[24:27], v[112:115], v[48:51], v[24:27]
  ds_read_b128 v[132:135], v5 offset:17408
  s_waitcnt lgkmcnt(4)
  v_mfma_f32_16x16x32_bf16 v[28:31], v[116:119], v[48:51], v[28:31]
  ds_read_b128 v[136:139], v5 offset:18432
  s_waitcnt lgkmcnt(4)
  v_mfma_f32_16x16x32_bf16 v[32:35], v[120:123], v[48:51], v[32:35]
  ds_read_b128 v[140:143], v5 offset:19456
  buffer_load_dwordx4 v[80:83], v5, s[8:11], s54 offen offset:2048 sc1
  buffer_load_dwordx4 v[84:87], v5, s[8:11], s54 offen offset:3072 sc1
  s_waitcnt vmcnt(8)
  s_waitcnt lgkmcnt(4)
  v_mfma_f32_16x16x32_bf16 v[16:19], v[124:127], v[52:55], v[16:19]
  s_barrier
  ds_read_b128 v[104:107], v5 offset:20480
  s_waitcnt lgkmcnt(4)
  v_mfma_f32_16x16x32_bf16 v[20:23], v[128:131], v[52:55], v[20:23]
  ds_read_b128 v[108:111], v5 offset:21504
  s_waitcnt lgkmcnt(4)
  v_mfma_f32_16x16x32_bf16 v[24:27], v[132:135], v[52:55], v[24:27]
  ds_read_b128 v[112:115], v5 offset:22528
  s_waitcnt lgkmcnt(4)
  v_mfma_f32_16x16x32_bf16 v[28:31], v[136:139], v[52:55], v[28:31]
  ds_read_b128 v[116:119], v5 offset:23552
  s_waitcnt lgkmcnt(4)
  v_mfma_f32_16x16x32_bf16 v[32:35], v[140:143], v[52:55], v[32:35]
  ds_read_b128 v[120:123], v5 offset:24576
  s_add_u32 s54, s53, 12288
  buffer_load_dwordx4 v[88:91], v5, s[8:11], s54 offen offset:0 sc1
  buffer_load_dwordx4 v[92:95], v5, s[8:11], s54 offen offset:1024 sc1
  s_waitcnt vmcnt(9)
  s_waitcnt lgkmcnt(4)
  v_mfma_f32_16x16x32_bf16 v[16:19], v[104:107], v[56:59], v[16:19]
  ds_read_b128 v[124:127], v5 offset:25600
  s_waitcnt lgkmcnt(4)
  v_mfma_f32_16x16x32_bf16 v[20:23], v[108:111], v[56:59], v[20:23]
  ds_read_b128 v[128:131], v5 offset:26624
  s_waitcnt lgkmcnt(4)
  v_mfma_f32_16x16x32_bf16 v[24:27], v[112:115], v[56:59], v[24:27]
  ds_read_b128 v[132:135], v5 offset:27648
  s_waitcnt lgkmcnt(4)
  v_mfma_f32_16x16x32_bf16 v[28:31], v[116:119], v[56:59], v[28:31]
  ds_read_b128 v[136:139], v5 offset:28672
  s_waitcnt lgkmcnt(4)
  v_mfma_f32_16x16x32_bf16 v[32:35], v[120:123], v[56:59], v[32:35]
  ds_read_b128 v[140:143], v5 offset:29696
  buffer_load_dwordx4 v[96:99], v5, s[8:11], s54 offen offset:2048 sc1
  s_waitcnt vmcnt(9)
  s_waitcnt lgkmcnt(4)
  v_mfma_f32_16x16x32_bf16 v[16:19], v[124:127], v[60:63], v[16:19]
  ds_read_b128 v[104:107], v5 offset:30720
  s_waitcnt lgkmcnt(4)
  v_mfma_f32_16x16x32_bf16 v[20:23], v[128:131], v[60:63], v[20:23]
  ds_read_b128 v[108:111], v5 offset:31744
  s_waitcnt lgkmcnt(4)
  v_mfma_f32_16x16x32_bf16 v[24:27], v[132:135], v[60:63], v[24:27]
  ds_read_b128 v[112:115], v5 offset:32768
  s_waitcnt lgkmcnt(4)
  v_mfma_f32_16x16x32_bf16 v[28:31], v[136:139], v[60:63], v[28:31]
  ds_read_b128 v[116:119], v5 offset:33792
  s_waitcnt lgkmcnt(4)
  v_mfma_f32_16x16x32_bf16 v[32:35], v[140:143], v[60:63], v[32:35]
  ds_read_b128 v[120:123], v5 offset:34816
  buffer_load_dwordx4 v[100:103], v5, s[8:11], s54 offen offset:3072 sc1
  s_waitcnt vmcnt(9)
  s_waitcnt lgkmcnt(4)
  v_mfma_f32_16x16x32_bf16 v[16:19], v[104:107], v[64:67], v[16:19]
  ds_read_b128 v[124:127], v5 offset:35840
  s_waitcnt lgkmcnt(4)
  v_mfma_f32_16x16x32_bf16 v[20:23], v[108:111], v[64:67], v[20:23]
  ds_read_b128 v[128:131], v5 offset:36864
  s_waitcnt lgkmcnt(4)
  v_mfma_f32_16x16x32_bf16 v[24:27], v[112:115], v[64:67], v[24:27]
  ds_read_b128 v[132:135], v5 offset:37888
  s_waitcnt lgkmcnt(4)
  v_mfma_f32_16x16x32_bf16 v[28:31], v[116:119], v[64:67], v[28:31]
  ds_read_b128 v[136:139], v5 offset:38912
  s_waitcnt lgkmcnt(4)
  v_mfma_f32_16x16x32_bf16 v[32:35], v[120:123], v[64:67], v[32:35]
  ds_read_b128 v[140:143], v5 offset:39936
  s_add_u32 s54, s53, 16384
  buffer_load_dwordx4 v[40:43], v5, s[8:11], s54 offen offset:0 sc1
  s_waitcnt vmcnt(9)
  s_waitcnt lgkmcnt(4)
  v_mfma_f32_16x16x32_bf16 v[16:19], v[124:127], v[68:71], v[16:19]
  s_barrier
  ds_read_b128 v[104:107], v8 offset:32768
  s_waitcnt lgkmcnt(4)
  v_mfma_f32_16x16x32_bf16 v[20:23], v[128:131], v[68:71], v[20:23]
  ds_read_b128 v[108:111], v8 offset:33792
  s_waitcnt lgkmcnt(4)
  v_mfma_f32_16x16x32_bf16 v[24:27], v[132:135], v[68:71], v[24:27]
  ds_read_b128 v[112:115], v8 offset:34816
  s_waitcnt lgkmcnt(4)
  v_mfma_f32_16x16x32_bf16 v[28:31], v[136:139], v[68:71], v[28:31]
  ds_read_b128 v[116:119], v8 offset:35840
  s_waitcnt lgkmcnt(4)
  v_mfma_f32_16x16x32_bf16 v[32:35], v[140:143], v[68:71], v[32:35]
  ds_read_b128 v[120:123], v8 offset:36864
  buffer_load_dwordx4 v[44:47], v5, s[8:11], s54 offen offset:1024 sc1
  s_waitcnt vmcnt(9)
  s_waitcnt lgkmcnt(4)
  v_mfma_f32_16x16x32_bf16 v[16:19], v[104:107], v[72:75], v[16:19]
  ds_read_b128 v[124:127], v8 offset:37888
  s_waitcnt lgkmcnt(4)
  v_mfma_f32_16x16x32_bf16 v[20:23], v[108:111], v[72:75], v[20:23]
  ds_read_b128 v[128:131], v8 offset:38912
  s_waitcnt lgkmcnt(4)
  v_mfma_f32_16x16x32_bf16 v[24:27], v[112:115], v[72:75], v[24:27]
  ds_read_b128 v[132:135], v8 offset:39936
  s_waitcnt lgkmcnt(4)
  v_mfma_f32_16x16x32_bf16 v[28:31], v[116:119], v[72:75], v[28:31]
  ds_read_b128 v[136:139], v8 offset:40960
  s_waitcnt lgkmcnt(4)
  v_mfma_f32_16x16x32_bf16 v[32:35], v[120:123], v[72:75], v[32:35]
  ds_read_b128 v[140:143], v8 offset:41984
  buffer_load_dwordx4 v[48:51], v5, s[8:11], s54 offen offset:2048 sc1
  s_waitcnt vmcnt(9)
  s_waitcnt lgkmcnt(4)
  v_mfma_f32_16x16x32_bf16 v[16:19], v[124:127], v[76:79], v[16:19]
  ds_read_b128 v[104:107], v8 offset:43008
  s_waitcnt lgkmcnt(4)
  v_mfma_f32_16x16x32_bf16 v[20:23], v[128:131], v[76:79], v[20:23]
  ds_read_b128 v[108:111], v8 offset:44032
  s_waitcnt lgkmcnt(4)
  v_mfma_f32_16x16x32_bf16 v[24:27], v[132:135], v[76:79], v[24:27]
  ds_read_b128 v[112:115], v8 offset:45056
  s_waitcnt lgkmcnt(4)
  v_mfma_f32_16x16x32_bf16 v[28:31], v[136:139], v[76:79], v[28:31]
  ds_read_b128 v[116:119], v8 offset:46080
  s_waitcnt lgkmcnt(4)
  v_mfma_f32_16x16x32_bf16 v[32:35], v[140:143], v[76:79], v[32:35]
  ds_read_b128 v[120:123], v8 offset:47104
  buffer_load_dwordx4 v[52:55], v5, s[8:11], s54 offen offset:3072 sc1
  s_waitcnt vmcnt(9)
  s_waitcnt lgkmcnt(4)
  v_mfma_f32_16x16x32_bf16 v[16:19], v[104:107], v[80:83], v[16:19]
  ds_read_b128 v[124:127], v8 offset:48128
  s_waitcnt lgkmcnt(4)
  v_mfma_f32_16x16x32_bf16 v[20:23], v[108:111], v[80:83], v[20:23]
  ds_read_b128 v[128:131], v8 offset:49152
  s_waitcnt lgkmcnt(4)
  v_mfma_f32_16x16x32_bf16 v[24:27], v[112:115], v[80:83], v[24:27]
  ds_read_b128 v[132:135], v8 offset:50176
  s_waitcnt lgkmcnt(4)
  v_mfma_f32_16x16x32_bf16 v[28:31], v[116:119], v[80:83], v[28:31]
  ds_read_b128 v[136:139], v8 offset:51200
  s_waitcnt lgkmcnt(4)
  v_mfma_f32_16x16x32_bf16 v[32:35], v[120:123], v[80:83], v[32:35]
  ds_read_b128 v[140:143], v8 offset:52224
  s_add_u32 s54, s53, 20480
  buffer_load_dwordx4 v[56:59], v5, s[8:11], s54 offen offset:0 sc1
  s_waitcnt vmcnt(9)
  s_waitcnt lgkmcnt(4)
  v_mfma_f32_16x16x32_bf16 v[16:19], v[124:127], v[84:87], v[16:19]
  s_barrier
  ds_read_b128 v[104:107], v8 offset:53248
  s_waitcnt lgkmcnt(4)
  v_mfma_f32_16x16x32_bf16 v[20:23], v[128:131], v[84:87], v[20:23]
  ds_read_b128 v[108:111], v8 offset:54272
  s_waitcnt lgkmcnt(4)
  v_mfma_f32_16x16x32_bf16 v[24:27], v[132:135], v[84:87], v[24:27]
  ds_read_b128 v[112:115], v8 offset:55296
  s_waitcnt lgkmcnt(4)
  v_mfma_f32_16x16x32_bf16 v[28:31], v[136:139], v[84:87], v[28:31]
  ds_read_b128 v[116:119], v8 offset:56320
  s_waitcnt lgkmcnt(4)
  v_mfma_f32_16x16x32_bf16 v[32:35], v[140:143], v[84:87], v[32:35]
  ds_read_b128 v[120:123], v8 offset:57344
  buffer_load_dwordx4 v[60:63], v5, s[8:11], s54 offen offset:1024 sc1
  s_waitcnt vmcnt(9)
  s_waitcnt lgkmcnt(4)
  v_mfma_f32_16x16x32_bf16 v[16:19], v[104:107], v[88:91], v[16:19]
  ds_read_b128 v[124:127], v8 offset:58368
  s_waitcnt lgkmcnt(4)
  v_mfma_f32_16x16x32_bf16 v[20:23], v[108:111], v[88:91], v[20:23]
  ds_read_b128 v[128:131], v8 offset:59392
  s_waitcnt lgkmcnt(4)
  v_mfma_f32_16x16x32_bf16 v[24:27], v[112:115], v[88:91], v[24:27]
  ds_read_b128 v[132:135], v8 offset:60416
  s_waitcnt lgkmcnt(4)
  v_mfma_f32_16x16x32_bf16 v[28:31], v[116:119], v[88:91], v[28:31]
  ds_read_b128 v[136:139], v8 offset:61440
  s_waitcnt lgkmcnt(4)
  v_mfma_f32_16x16x32_bf16 v[32:35], v[120:123], v[88:91], v[32:35]
  ds_read_b128 v[140:143], v8 offset:62464
  buffer_load_dwordx4 v[64:67], v5, s[8:11], s54 offen offset:2048 sc1
  s_waitcnt vmcnt(9)
  s_waitcnt lgkmcnt(4)
  v_mfma_f32_16x16x32_bf16 v[16:19], v[124:127], v[92:95], v[16:19]
  ds_read_b128 v[104:107], v8 offset:63488
  s_waitcnt lgkmcnt(4)
  v_mfma_f32_16x16x32_bf16 v[20:23], v[128:131], v[92:95], v[20:23]
  ds_read_b128 v[108:111], v8 offset:64512
  s_waitcnt lgkmcnt(4)
  v_mfma_f32_16x16x32_bf16 v[24:27], v[132:135], v[92:95], v[24:27]
  ds_read_b128 v[112:115], v9 offset:0
  s_waitcnt lgkmcnt(4)
  v_mfma_f32_16x16x32_bf16 v[28:31], v[136:139], v[92:95], v[28:31]
  ds_read_b128 v[116:119], v9 offset:1024
  s_waitcnt lgkmcnt(4)
  v_mfma_f32_16x16x32_bf16 v[32:35], v[140:143], v[92:95], v[32:35]
  ds_read_b128 v[120:123], v9 offset:2048
  buffer_load_dwordx4 v[68:71], v5, s[8:11], s54 offen offset:3072 sc1
  s_waitcnt vmcnt(9)
  s_waitcnt lgkmcnt(4)
  v_mfma_f32_16x16x32_bf16 v[16:19], v[104:107], v[96:99], v[16:19]
  ds_read_b128 v[124:127], v9 offset:3072
  s_waitcnt lgkmcnt(4)
  v_mfma_f32_16x16x32_bf16 v[20:23], v[108:111], v[96:99], v[20:23]
  ds_read_b128 v[128:131], v9 offset:4096
  s_waitcnt lgkmcnt(4)
  v_mfma_f32_16x16x32_bf16 v[24:27], v[112:115], v[96:99], v[24:27]
  ds_read_b128 v[132:135], v9 offset:5120
  s_waitcnt lgkmcnt(4)
  v_mfma_f32_16x16x32_bf16 v[28:31], v[116:119], v[96:99], v[28:31]
  ds_read_b128 v[136:139], v9 offset:6144
  s_waitcnt lgkmcnt(4)
  v_mfma_f32_16x16x32_bf16 v[32:35], v[120:123], v[96:99], v[32:35]
  ds_read_b128 v[140:143], v9 offset:7168
  s_add_u32 s54, s53, 24576
  buffer_load_dwordx4 v[72:75], v5, s[8:11], s54 offen offset:0 sc1
  s_waitcnt vmcnt(9)
  s_waitcnt lgkmcnt(4)
  v_mfma_f32_16x16x32_bf16 v[16:19], v[124:127], v[100:103], v[16:19]
  s_barrier
  ds_read_b128 v[104:107], v5 offset:49152
  s_waitcnt lgkmcnt(4)
  v_mfma_f32_16x16x32_bf16 v[20:23], v[128:131], v[100:103], v[20:23]
  ds_read_b128 v[108:111], v5 offset:50176
  s_waitcnt lgkmcnt(4)
  v_mfma_f32_16x16x32_bf16 v[24:27], v[132:135], v[100:103], v[24:27]
  ds_read_b128 v[112:115], v5 offset:51200
  s_waitcnt lgkmcnt(4)
  v_mfma_f32_16x16x32_bf16 v[28:31], v[136:139], v[100:103], v[28:31]
  ds_read_b128 v[116:119], v5 offset:52224
  s_waitcnt lgkmcnt(4)
  v_mfma_f32_16x16x32_bf16 v[32:35], v[140:143], v[100:103], v[32:35]
  ds_read_b128 v[120:123], v5 offset:53248
  buffer_load_dwordx4 v[76:79], v5, s[8:11], s54 offen offset:1024 sc1
  s_waitcnt vmcnt(9)
  s_waitcnt lgkmcnt(4)
  v_mfma_f32_16x16x32_bf16 v[16:19], v[104:107], v[40:43], v[16:19]
  ds_read_b128 v[124:127], v5 offset:54272
  s_waitcnt lgkmcnt(4)
  v_mfma_f32_16x16x32_bf16 v[20:23], v[108:111], v[40:43], v[20:23]
  ds_read_b128 v[128:131], v5 offset:55296
  s_waitcnt lgkmcnt(4)
  v_mfma_f32_16x16x32_bf16 v[24:27], v[112:115], v[40:43], v[24:27]
  ds_read_b128 v[132:135], v5 offset:56320
  s_waitcnt lgkmcnt(4)
  v_mfma_f32_16x16x32_bf16 v[28:31], v[116:119], v[40:43], v[28:31]
  ds_read_b128 v[136:139], v5 offset:57344
  s_waitcnt lgkmcnt(4)
  v_mfma_f32_16x16x32_bf16 v[32:35], v[120:123], v[40:43], v[32:35]
  ds_read_b128 v[140:143], v5 offset:58368
  buffer_load_dwordx4 v[80:83], v5, s[8:11], s54 offen offset:2048 sc1
  s_waitcnt vmcnt(9)
  s_waitcnt lgkmcnt(4)
  v_mfma_f32_16x16x32_bf16 v[16:19], v[124:127], v[44:47], v[16:19]
  ds_read_b128 v[104:107], v5 offset:59392
  s_waitcnt lgkmcnt(4)
  v_mfma_f32_16x16x32_bf16 v[20:23], v[128:131], v[44:47], v[20:23]
  ds_read_b128 v[108:111], v5 offset:60416
  s_waitcnt lgkmcnt(4)
  v_mfma_f32_16x16x32_bf16 v[24:27], v[132:135], v[44:47], v[24:27]
  ds_read_b128 v[112:115], v5 offset:61440
  s_waitcnt lgkmcnt(4)
  v_mfma_f32_16x16x32_bf16 v[28:31], v[136:139], v[44:47], v[28:31]
  ds_read_b128 v[116:119], v5 offset:62464
  s_waitcnt lgkmcnt(4)
  v_mfma_f32_16x16x32_bf16 v[32:35], v[140:143], v[44:47], v[32:35]
  ds_read_b128 v[120:123], v5 offset:63488
  buffer_load_dwordx4 v[84:87], v5, s[8:11], s54 offen offset:3072 sc1
  s_waitcnt vmcnt(9)
  s_waitcnt lgkmcnt(4)
  v_mfma_f32_16x16x32_bf16 v[16:19], v[104:107], v[48:51], v[16:19]
  ds_read_b128 v[124:127], v5 offset:64512
  s_waitcnt lgkmcnt(4)
  v_mfma_f32_16x16x32_bf16 v[20:23], v[108:111], v[48:51], v[20:23]
  ds_read_b128 v[128:131], v8 offset:0
  s_waitcnt lgkmcnt(4)
  v_mfma_f32_16x16x32_bf16 v[24:27], v[112:115], v[48:51], v[24:27]
  ds_read_b128 v[132:135], v8 offset:1024
  s_waitcnt lgkmcnt(4)
  v_mfma_f32_16x16x32_bf16 v[28:31], v[116:119], v[48:51], v[28:31]
  ds_read_b128 v[136:139], v8 offset:2048
  s_waitcnt lgkmcnt(4)
  v_mfma_f32_16x16x32_bf16 v[32:35], v[120:123], v[48:51], v[32:35]
  ds_read_b128 v[140:143], v8 offset:3072
  s_add_u32 s54, s53, 28672
  buffer_load_dwordx4 v[88:91], v5, s[8:11], s54 offen offset:0 sc1
  s_waitcnt vmcnt(9)
  s_waitcnt lgkmcnt(4)
  v_mfma_f32_16x16x32_bf16 v[16:19], v[124:127], v[52:55], v[16:19]
  s_barrier
  ds_read_b128 v[104:107], v8 offset:4096
  s_waitcnt lgkmcnt(4)
  v_mfma_f32_16x16x32_bf16 v[20:23], v[128:131], v[52:55], v[20:23]
  ds_read_b128 v[108:111], v8 offset:5120
  s_waitcnt lgkmcnt(4)
  v_mfma_f32_16x16x32_bf16 v[24:27], v[132:135], v[52:55], v[24:27]
  ds_read_b128 v[112:115], v8 offset:6144
  s_waitcnt lgkmcnt(4)
  v_mfma_f32_16x16x32_bf16 v[28:31], v[136:139], v[52:55], v[28:31]
  ds_read_b128 v[116:119], v8 offset:7168
  s_waitcnt lgkmcnt(4)
  v_mfma_f32_16x16x32_bf16 v[32:35], v[140:143], v[52:55], v[32:35]
  ds_read_b128 v[120:123], v8 offset:8192
  buffer_load_dwordx4 v[92:95], v5, s[8:11], s54 offen offset:1024 sc1
  s_waitcnt vmcnt(9)
  s_waitcnt lgkmcnt(4)
  v_mfma_f32_16x16x32_bf16 v[16:19], v[104:107], v[56:59], v[16:19]
  ds_read_b128 v[124:127], v8 offset:9216
  s_waitcnt lgkmcnt(4)
  v_mfma_f32_16x16x32_bf16 v[20:23], v[108:111], v[56:59], v[20:23]
  ds_read_b128 v[128:131], v8 offset:10240
  s_waitcnt lgkmcnt(4)
  v_mfma_f32_16x16x32_bf16 v[24:27], v[112:115], v[56:59], v[24:27]
  ds_read_b128 v[132:135], v8 offset:11264
  s_waitcnt lgkmcnt(4)
  v_mfma_f32_16x16x32_bf16 v[28:31], v[116:119], v[56:59], v[28:31]
  ds_read_b128 v[136:139], v8 offset:12288
  s_waitcnt lgkmcnt(4)
  v_mfma_f32_16x16x32_bf16 v[32:35], v[120:123], v[56:59], v[32:35]
  ds_read_b128 v[140:143], v8 offset:13312
  buffer_load_dwordx4 v[96:99], v5, s[8:11], s54 offen offset:2048 sc1
  s_waitcnt vmcnt(9)
  s_waitcnt lgkmcnt(4)
  v_mfma_f32_16x16x32_bf16 v[16:19], v[124:127], v[60:63], v[16:19]
  ds_read_b128 v[104:107], v8 offset:14336
  s_waitcnt lgkmcnt(4)
  v_mfma_f32_16x16x32_bf16 v[20:23], v[128:131], v[60:63], v[20:23]
  ds_read_b128 v[108:111], v8 offset:15360
  s_waitcnt lgkmcnt(4)
  v_mfma_f32_16x16x32_bf16 v[24:27], v[132:135], v[60:63], v[24:27]
  ds_read_b128 v[112:115], v8 offset:16384
  s_waitcnt lgkmcnt(4)
  v_mfma_f32_16x16x32_bf16 v[28:31], v[136:139], v[60:63], v[28:31]
  ds_read_b128 v[116:119], v8 offset:17408
  s_waitcnt lgkmcnt(4)
  v_mfma_f32_16x16x32_bf16 v[32:35], v[140:143], v[60:63], v[32:35]
  ds_read_b128 v[120:123], v8 offset:18432
  buffer_load_dwordx4 v[100:103], v5, s[8:11], s54 offen offset:3072 sc1
  s_waitcnt vmcnt(9)
  s_waitcnt lgkmcnt(4)
  v_mfma_f32_16x16x32_bf16 v[16:19], v[104:107], v[64:67], v[16:19]
  ds_read_b128 v[124:127], v8 offset:19456
  s_waitcnt lgkmcnt(4)
  v_mfma_f32_16x16x32_bf16 v[20:23], v[108:111], v[64:67], v[20:23]
  ds_read_b128 v[128:131], v8 offset:20480
  s_waitcnt lgkmcnt(4)
  v_mfma_f32_16x16x32_bf16 v[24:27], v[112:115], v[64:67], v[24:27]
  ds_read_b128 v[132:135], v8 offset:21504
  s_waitcnt lgkmcnt(4)
  v_mfma_f32_16x16x32_bf16 v[28:31], v[116:119], v[64:67], v[28:31]
  ds_read_b128 v[136:139], v8 offset:22528
  s_waitcnt lgkmcnt(4)
  v_mfma_f32_16x16x32_bf16 v[32:35], v[120:123], v[64:67], v[32:35]
  ds_read_b128 v[140:143], v8 offset:23552
  s_add_u32 s54, s53, 32768
  buffer_load_dwordx4 v[40:43], v5, s[8:11], s54 offen offset:0 sc1
  s_waitcnt vmcnt(9)
  s_waitcnt lgkmcnt(4)
  v_mfma_f32_16x16x32_bf16 v[16:19], v[124:127], v[68:71], v[16:19]
  s_barrier
  ds_read_b128 v[104:107], v9 offset:8192
  s_waitcnt lgkmcnt(4)
  v_mfma_f32_16x16x32_bf16 v[20:23], v[128:131], v[68:71], v[20:23]
  ds_read_b128 v[108:111], v9 offset:9216
  s_waitcnt lgkmcnt(4)
  v_mfma_f32_16x16x32_bf16 v[24:27], v[132:135], v[68:71], v[24:27]
  ds_read_b128 v[112:115], v9 offset:10240
  s_waitcnt lgkmcnt(4)
  v_mfma_f32_16x16x32_bf16 v[28:31], v[136:139], v[68:71], v[28:31]
  ds_read_b128 v[116:119], v9 offset:11264
  s_waitcnt lgkmcnt(4)
  v_mfma_f32_16x16x32_bf16 v[32:35], v[140:143], v[68:71], v[32:35]
  ds_read_b128 v[120:123], v9 offset:12288
  buffer_load_dwordx4 v[44:47], v5, s[8:11], s54 offen offset:1024 sc1
  s_waitcnt vmcnt(9)
  s_waitcnt lgkmcnt(4)
  v_mfma_f32_16x16x32_bf16 v[16:19], v[104:107], v[72:75], v[16:19]
  ds_read_b128 v[124:127], v9 offset:13312
  s_waitcnt lgkmcnt(4)
  v_mfma_f32_16x16x32_bf16 v[20:23], v[108:111], v[72:75], v[20:23]
  ds_read_b128 v[128:131], v9 offset:14336
  s_waitcnt lgkmcnt(4)
  v_mfma_f32_16x16x32_bf16 v[24:27], v[112:115], v[72:75], v[24:27]
  ds_read_b128 v[132:135], v9 offset:15360
  s_waitcnt lgkmcnt(4)
  v_mfma_f32_16x16x32_bf16 v[28:31], v[116:119], v[72:75], v[28:31]
  ds_read_b128 v[136:139], v9 offset:16384
  s_waitcnt lgkmcnt(4)
  v_mfma_f32_16x16x32_bf16 v[32:35], v[120:123], v[72:75], v[32:35]
  ds_read_b128 v[140:143], v9 offset:17408
  buffer_load_dwordx4 v[48:51], v5, s[8:11], s54 offen offset:2048 sc1
  s_waitcnt vmcnt(9)
  s_waitcnt lgkmcnt(4)
  v_mfma_f32_16x16x32_bf16 v[16:19], v[124:127], v[76:79], v[16:19]
  ds_read_b128 v[104:107], v9 offset:18432
  s_waitcnt lgkmcnt(4)
  v_mfma_f32_16x16x32_bf16 v[20:23], v[128:131], v[76:79], v[20:23]
  ds_read_b128 v[108:111], v9 offset:19456
  s_waitcnt lgkmcnt(4)
  v_mfma_f32_16x16x32_bf16 v[24:27], v[132:135], v[76:79], v[24:27]
  ds_read_b128 v[112:115], v9 offset:20480
  s_waitcnt lgkmcnt(4)
  v_mfma_f32_16x16x32_bf16 v[28:31], v[136:139], v[76:79], v[28:31]
  ds_read_b128 v[116:119], v9 offset:21504
  s_waitcnt lgkmcnt(4)
  v_mfma_f32_16x16x32_bf16 v[32:35], v[140:143], v[76:79], v[32:35]
  ds_read_b128 v[120:123], v9 offset:22528
  buffer_load_dwordx4 v[52:55], v5, s[8:11], s54 offen offset:3072 sc1
  s_waitcnt vmcnt(9)
  s_waitcnt lgkmcnt(4)
  v_mfma_f32_16x16x32_bf16 v[16:19], v[104:107], v[80:83], v[16:19]
  ds_read_b128 v[124:127], v9 offset:23552
  s_waitcnt lgkmcnt(4)
  v_mfma_f32_16x16x32_bf16 v[20:23], v[108:111], v[80:83], v[20:23]
  ds_read_b128 v[128:131], v9 offset:24576
  s_waitcnt lgkmcnt(4)
  v_mfma_f32_16x16x32_bf16 v[24:27], v[112:115], v[80:83], v[24:27]
  ds_read_b128 v[132:135], v9 offset:25600
  s_waitcnt lgkmcnt(4)
  v_mfma_f32_16x16x32_bf16 v[28:31], v[116:119], v[80:83], v[28:31]
  ds_read_b128 v[136:139], v9 offset:26624
  s_waitcnt lgkmcnt(4)
  v_mfma_f32_16x16x32_bf16 v[32:35], v[120:123], v[80:83], v[32:35]
  ds_read_b128 v[140:143], v9 offset:27648
  s_add_u32 s54, s53, 36864
  buffer_load_dwordx4 v[56:59], v5, s[8:11], s54 offen offset:0 sc1
  s_waitcnt vmcnt(9)
  s_waitcnt lgkmcnt(4)
  v_mfma_f32_16x16x32_bf16 v[16:19], v[124:127], v[84:87], v[16:19]
  s_barrier
  ds_read_b128 v[104:107], v5 offset:0
  s_waitcnt lgkmcnt(4)
  v_mfma_f32_16x16x32_bf16 v[20:23], v[128:131], v[84:87], v[20:23]
  ds_read_b128 v[108:111], v5 offset:1024
  s_waitcnt lgkmcnt(4)
  v_mfma_f32_16x16x32_bf16 v[24:27], v[132:135], v[84:87], v[24:27]
  ds_read_b128 v[112:115], v5 offset:2048
  s_waitcnt lgkmcnt(4)
  v_mfma_f32_16x16x32_bf16 v[28:31], v[136:139], v[84:87], v[28:31]
  ds_read_b128 v[116:119], v5 offset:3072
  s_waitcnt lgkmcnt(4)
  v_mfma_f32_16x16x32_bf16 v[32:35], v[140:143], v[84:87], v[32:35]
  ds_read_b128 v[120:123], v5 offset:4096
  buffer_load_dwordx4 v[60:63], v5, s[8:11], s54 offen offset:1024 sc1
  s_waitcnt vmcnt(9)
  s_waitcnt lgkmcnt(4)
  v_mfma_f32_16x16x32_bf16 v[16:19], v[104:107], v[88:91], v[16:19]
  ds_read_b128 v[124:127], v5 offset:5120
  s_waitcnt lgkmcnt(4)
  v_mfma_f32_16x16x32_bf16 v[20:23], v[108:111], v[88:91], v[20:23]
  ds_read_b128 v[128:131], v5 offset:6144
  s_waitcnt lgkmcnt(4)
  v_mfma_f32_16x16x32_bf16 v[24:27], v[112:115], v[88:91], v[24:27]
  ds_read_b128 v[132:135], v5 offset:7168
  s_waitcnt lgkmcnt(4)
  v_mfma_f32_16x16x32_bf16 v[28:31], v[116:119], v[88:91], v[28:31]
  ds_read_b128 v[136:139], v5 offset:8192
  s_waitcnt lgkmcnt(4)
  v_mfma_f32_16x16x32_bf16 v[32:35], v[120:123], v[88:91], v[32:35]
  ds_read_b128 v[140:143], v5 offset:9216
  buffer_load_dwordx4 v[64:67], v5, s[8:11], s54 offen offset:2048 sc1
  s_waitcnt vmcnt(9)
  s_waitcnt lgkmcnt(4)
  v_mfma_f32_16x16x32_bf16 v[16:19], v[124:127], v[92:95], v[16:19]
  ds_read_b128 v[104:107], v5 offset:10240
  s_waitcnt lgkmcnt(4)
  v_mfma_f32_16x16x32_bf16 v[20:23], v[128:131], v[92:95], v[20:23]
  ds_read_b128 v[108:111], v5 offset:11264
  s_waitcnt lgkmcnt(4)
  v_mfma_f32_16x16x32_bf16 v[24:27], v[132:135], v[92:95], v[24:27]
  ds_read_b128 v[112:115], v5 offset:12288
  s_waitcnt lgkmcnt(4)
  v_mfma_f32_16x16x32_bf16 v[28:31], v[136:139], v[92:95], v[28:31]
  ds_read_b128 v[116:119], v5 offset:13312
  s_waitcnt lgkmcnt(4)
  v_mfma_f32_16x16x32_bf16 v[32:35], v[140:143], v[92:95], v[32:35]
  ds_read_b128 v[120:123], v5 offset:14336
  buffer_load_dwordx4 v[68:71], v5, s[8:11], s54 offen offset:3072 sc1
  s_waitcnt vmcnt(9)
  s_waitcnt lgkmcnt(4)
  v_mfma_f32_16x16x32_bf16 v[16:19], v[104:107], v[96:99], v[16:19]
  ds_read_b128 v[124:127], v5 offset:15360
  s_waitcnt lgkmcnt(4)
  v_mfma_f32_16x16x32_bf16 v[20:23], v[108:111], v[96:99], v[20:23]
  ds_read_b128 v[128:131], v5 offset:16384
  s_waitcnt lgkmcnt(4)
  v_mfma_f32_16x16x32_bf16 v[24:27], v[112:115], v[96:99], v[24:27]
  ds_read_b128 v[132:135], v5 offset:17408
  s_waitcnt lgkmcnt(4)
  v_mfma_f32_16x16x32_bf16 v[28:31], v[116:119], v[96:99], v[28:31]
  ds_read_b128 v[136:139], v5 offset:18432
  s_waitcnt lgkmcnt(4)
  v_mfma_f32_16x16x32_bf16 v[32:35], v[120:123], v[96:99], v[32:35]
  ds_read_b128 v[140:143], v5 offset:19456
  s_add_u32 s54, s53, 40960
  buffer_load_dwordx4 v[72:75], v5, s[8:11], s54 offen offset:0 sc1
  s_waitcnt vmcnt(9)
  s_waitcnt lgkmcnt(4)
  v_mfma_f32_16x16x32_bf16 v[16:19], v[124:127], v[100:103], v[16:19]
  s_barrier
  ds_read_b128 v[104:107], v5 offset:20480
  s_waitcnt lgkmcnt(4)
  v_mfma_f32_16x16x32_bf16 v[20:23], v[128:131], v[100:103], v[20:23]
  ds_read_b128 v[108:111], v5 offset:21504
  s_waitcnt lgkmcnt(4)
  v_mfma_f32_16x16x32_bf16 v[24:27], v[132:135], v[100:103], v[24:27]
  ds_read_b128 v[112:115], v5 offset:22528
  s_waitcnt lgkmcnt(4)
  v_mfma_f32_16x16x32_bf16 v[28:31], v[136:139], v[100:103], v[28:31]
  ds_read_b128 v[116:119], v5 offset:23552
  s_waitcnt lgkmcnt(4)
  v_mfma_f32_16x16x32_bf16 v[32:35], v[140:143], v[100:103], v[32:35]
  ds_read_b128 v[120:123], v5 offset:24576
  buffer_load_dwordx4 v[76:79], v5, s[8:11], s54 offen offset:1024 sc1
  s_waitcnt vmcnt(9)
  s_waitcnt lgkmcnt(4)
  v_mfma_f32_16x16x32_bf16 v[16:19], v[104:107], v[40:43], v[16:19]
  ds_read_b128 v[124:127], v5 offset:25600
  s_waitcnt lgkmcnt(4)
  v_mfma_f32_16x16x32_bf16 v[20:23], v[108:111], v[40:43], v[20:23]
  ds_read_b128 v[128:131], v5 offset:26624
  s_waitcnt lgkmcnt(4)
  v_mfma_f32_16x16x32_bf16 v[24:27], v[112:115], v[40:43], v[24:27]
  ds_read_b128 v[132:135], v5 offset:27648
  s_waitcnt lgkmcnt(4)
  v_mfma_f32_16x16x32_bf16 v[28:31], v[116:119], v[40:43], v[28:31]
  ds_read_b128 v[136:139], v5 offset:28672
  s_waitcnt lgkmcnt(4)
  v_mfma_f32_16x16x32_bf16 v[32:35], v[120:123], v[40:43], v[32:35]
  ds_read_b128 v[140:143], v5 offset:29696
  buffer_load_dwordx4 v[80:83], v5, s[8:11], s54 offen offset:2048 sc1
  s_waitcnt vmcnt(9)
  s_waitcnt lgkmcnt(4)
  v_mfma_f32_16x16x32_bf16 v[16:19], v[124:127], v[44:47], v[16:19]
  ds_read_b128 v[104:107], v5 offset:30720
  s_waitcnt lgkmcnt(4)
  v_mfma_f32_16x16x32_bf16 v[20:23], v[128:131], v[44:47], v[20:23]
  ds_read_b128 v[108:111], v5 offset:31744
  s_waitcnt lgkmcnt(4)
  v_mfma_f32_16x16x32_bf16 v[24:27], v[132:135], v[44:47], v[24:27]
  ds_read_b128 v[112:115], v5 offset:32768
  s_waitcnt lgkmcnt(4)
  v_mfma_f32_16x16x32_bf16 v[28:31], v[136:139], v[44:47], v[28:31]
  ds_read_b128 v[116:119], v5 offset:33792
  s_waitcnt lgkmcnt(4)
  v_mfma_f32_16x16x32_bf16 v[32:35], v[140:143], v[44:47], v[32:35]
  ds_read_b128 v[120:123], v5 offset:34816
  buffer_load_dwordx4 v[84:87], v5, s[8:11], s54 offen offset:3072 sc1
  s_waitcnt vmcnt(9)
  s_waitcnt lgkmcnt(4)
  v_mfma_f32_16x16x32_bf16 v[16:19], v[104:107], v[48:51], v[16:19]
  ds_read_b128 v[124:127], v5 offset:35840
  s_waitcnt lgkmcnt(4)
  v_mfma_f32_16x16x32_bf16 v[20:23], v[108:111], v[48:51], v[20:23]
  ds_read_b128 v[128:131], v5 offset:36864
  s_waitcnt lgkmcnt(4)
  v_mfma_f32_16x16x32_bf16 v[24:27], v[112:115], v[48:51], v[24:27]
  ds_read_b128 v[132:135], v5 offset:37888
  s_waitcnt lgkmcnt(4)
  v_mfma_f32_16x16x32_bf16 v[28:31], v[116:119], v[48:51], v[28:31]
  ds_read_b128 v[136:139], v5 offset:38912
  s_waitcnt lgkmcnt(4)
  v_mfma_f32_16x16x32_bf16 v[32:35], v[120:123], v[48:51], v[32:35]
  ds_read_b128 v[140:143], v5 offset:39936
  s_add_u32 s54, s53, 45056
  buffer_load_dwordx4 v[88:91], v5, s[8:11], s54 offen offset:0 sc1
  s_waitcnt vmcnt(9)
  s_waitcnt lgkmcnt(4)
  v_mfma_f32_16x16x32_bf16 v[16:19], v[124:127], v[52:55], v[16:19]
  s_barrier
  ds_read_b128 v[104:107], v8 offset:32768
  s_waitcnt lgkmcnt(4)
  v_mfma_f32_16x16x32_bf16 v[20:23], v[128:131], v[52:55], v[20:23]
  ds_read_b128 v[108:111], v8 offset:33792
  s_waitcnt lgkmcnt(4)
  v_mfma_f32_16x16x32_bf16 v[24:27], v[132:135], v[52:55], v[24:27]
  ds_read_b128 v[112:115], v8 offset:34816
  s_waitcnt lgkmcnt(4)
  v_mfma_f32_16x16x32_bf16 v[28:31], v[136:139], v[52:55], v[28:31]
  ds_read_b128 v[116:119], v8 offset:35840
  s_waitcnt lgkmcnt(4)
  v_mfma_f32_16x16x32_bf16 v[32:35], v[140:143], v[52:55], v[32:35]
  ds_read_b128 v[120:123], v8 offset:36864
  buffer_load_dwordx4 v[92:95], v5, s[8:11], s54 offen offset:1024 sc1
  s_waitcnt vmcnt(9)
  s_waitcnt lgkmcnt(4)
  v_mfma_f32_16x16x32_bf16 v[16:19], v[104:107], v[56:59], v[16:19]
  ds_read_b128 v[124:127], v8 offset:37888
  s_waitcnt lgkmcnt(4)
  v_mfma_f32_16x16x32_bf16 v[20:23], v[108:111], v[56:59], v[20:23]
  ds_read_b128 v[128:131], v8 offset:38912
  s_waitcnt lgkmcnt(4)
  v_mfma_f32_16x16x32_bf16 v[24:27], v[112:115], v[56:59], v[24:27]
  ds_read_b128 v[132:135], v8 offset:39936
  s_waitcnt lgkmcnt(4)
  v_mfma_f32_16x16x32_bf16 v[28:31], v[116:119], v[56:59], v[28:31]
  ds_read_b128 v[136:139], v8 offset:40960
  s_waitcnt lgkmcnt(4)
  v_mfma_f32_16x16x32_bf16 v[32:35], v[120:123], v[56:59], v[32:35]
  ds_read_b128 v[140:143], v8 offset:41984
  buffer_load_dwordx4 v[96:99], v5, s[8:11], s54 offen offset:2048 sc1
  s_waitcnt vmcnt(9)
  s_waitcnt lgkmcnt(4)
  v_mfma_f32_16x16x32_bf16 v[16:19], v[124:127], v[60:63], v[16:19]
  ds_read_b128 v[104:107], v8 offset:43008
  s_waitcnt lgkmcnt(4)
  v_mfma_f32_16x16x32_bf16 v[20:23], v[128:131], v[60:63], v[20:23]
  ds_read_b128 v[108:111], v8 offset:44032
  s_waitcnt lgkmcnt(4)
  v_mfma_f32_16x16x32_bf16 v[24:27], v[132:135], v[60:63], v[24:27]
  ds_read_b128 v[112:115], v8 offset:45056
  s_waitcnt lgkmcnt(4)
  v_mfma_f32_16x16x32_bf16 v[28:31], v[136:139], v[60:63], v[28:31]
  ds_read_b128 v[116:119], v8 offset:46080
  s_waitcnt lgkmcnt(4)
  v_mfma_f32_16x16x32_bf16 v[32:35], v[140:143], v[60:63], v[32:35]
  ds_read_b128 v[120:123], v8 offset:47104
  buffer_load_dwordx4 v[100:103], v5, s[8:11], s54 offen offset:3072 sc1
  s_waitcnt vmcnt(9)
  s_waitcnt lgkmcnt(4)
  v_mfma_f32_16x16x32_bf16 v[16:19], v[104:107], v[64:67], v[16:19]
  ds_read_b128 v[124:127], v8 offset:48128
  s_waitcnt lgkmcnt(4)
  v_mfma_f32_16x16x32_bf16 v[20:23], v[108:111], v[64:67], v[20:23]
  ds_read_b128 v[128:131], v8 offset:49152
  s_waitcnt lgkmcnt(4)
  v_mfma_f32_16x16x32_bf16 v[24:27], v[112:115], v[64:67], v[24:27]
  ds_read_b128 v[132:135], v8 offset:50176
  s_waitcnt lgkmcnt(4)
  v_mfma_f32_16x16x32_bf16 v[28:31], v[116:119], v[64:67], v[28:31]
  ds_read_b128 v[136:139], v8 offset:51200
  s_waitcnt lgkmcnt(4)
  v_mfma_f32_16x16x32_bf16 v[32:35], v[120:123], v[64:67], v[32:35]
  ds_read_b128 v[140:143], v8 offset:52224
  s_waitcnt vmcnt(8)
  s_waitcnt lgkmcnt(4)
  v_mfma_f32_16x16x32_bf16 v[16:19], v[124:127], v[68:71], v[16:19]
  s_barrier
  ds_read_b128 v[104:107], v8 offset:53248
  s_waitcnt lgkmcnt(4)
  v_mfma_f32_16x16x32_bf16 v[20:23], v[128:131], v[68:71], v[20:23]
  ds_read_b128 v[108:111], v8 offset:54272
  s_waitcnt lgkmcnt(4)
  v_mfma_f32_16x16x32_bf16 v[24:27], v[132:135], v[68:71], v[24:27]
  ds_read_b128 v[112:115], v8 offset:55296
  s_waitcnt lgkmcnt(4)
  v_mfma_f32_16x16x32_bf16 v[28:31], v[136:139], v[68:71], v[28:31]
  ds_read_b128 v[116:119], v8 offset:56320
  s_waitcnt lgkmcnt(4)
  v_mfma_f32_16x16x32_bf16 v[32:35], v[140:143], v[68:71], v[32:35]
  ds_read_b128 v[120:123], v8 offset:57344
  s_waitcnt vmcnt(7)
  s_waitcnt lgkmcnt(4)
  v_mfma_f32_16x16x32_bf16 v[16:19], v[104:107], v[72:75], v[16:19]
  ds_read_b128 v[124:127], v8 offset:58368
  s_waitcnt lgkmcnt(4)
  v_mfma_f32_16x16x32_bf16 v[20:23], v[108:111], v[72:75], v[20:23]
  ds_read_b128 v[128:131], v8 offset:59392
  s_waitcnt lgkmcnt(4)
  v_mfma_f32_16x16x32_bf16 v[24:27], v[112:115], v[72:75], v[24:27]
  ds_read_b128 v[132:135], v8 offset:60416
  s_waitcnt lgkmcnt(4)
  v_mfma_f32_16x16x32_bf16 v[28:31], v[116:119], v[72:75], v[28:31]
  ds_read_b128 v[136:139], v8 offset:61440
  s_waitcnt lgkmcnt(4)
  v_mfma_f32_16x16x32_bf16 v[32:35], v[120:123], v[72:75], v[32:35]
  ds_read_b128 v[140:143], v8 offset:62464
  s_waitcnt vmcnt(6)
  s_waitcnt lgkmcnt(4)
  v_mfma_f32_16x16x32_bf16 v[16:19], v[124:127], v[76:79], v[16:19]
  ds_read_b128 v[104:107], v8 offset:63488
  s_waitcnt lgkmcnt(4)
  v_mfma_f32_16x16x32_bf16 v[20:23], v[128:131], v[76:79], v[20:23]
  ds_read_b128 v[108:111], v8 offset:64512
  s_waitcnt lgkmcnt(4)
  v_mfma_f32_16x16x32_bf16 v[24:27], v[132:135], v[76:79], v[24:27]
  ds_read_b128 v[112:115], v9 offset:0
  s_waitcnt lgkmcnt(4)
  v_mfma_f32_16x16x32_bf16 v[28:31], v[136:139], v[76:79], v[28:31]
  ds_read_b128 v[116:119], v9 offset:1024
  s_waitcnt lgkmcnt(4)
  v_mfma_f32_16x16x32_bf16 v[32:35], v[140:143], v[76:79], v[32:35]
  ds_read_b128 v[120:123], v9 offset:2048
  s_waitcnt vmcnt(5)
  s_waitcnt lgkmcnt(4)
  v_mfma_f32_16x16x32_bf16 v[16:19], v[104:107], v[80:83], v[16:19]
  ds_read_b128 v[124:127], v9 offset:3072
  s_waitcnt lgkmcnt(4)
  v_mfma_f32_16x16x32_bf16 v[20:23], v[108:111], v[80:83], v[20:23]
  ds_read_b128 v[128:131], v9 offset:4096
  s_waitcnt lgkmcnt(4)
  v_mfma_f32_16x16x32_bf16 v[24:27], v[112:115], v[80:83], v[24:27]
  ds_read_b128 v[132:135], v9 offset:5120
  s_waitcnt lgkmcnt(4)
  v_mfma_f32_16x16x32_bf16 v[28:31], v[116:119], v[80:83], v[28:31]
  ds_read_b128 v[136:139], v9 offset:6144
  s_waitcnt lgkmcnt(4)
  v_mfma_f32_16x16x32_bf16 v[32:35], v[120:123], v[80:83], v[32:35]
  ds_read_b128 v[140:143], v9 offset:7168
  s_waitcnt vmcnt(4)
  s_waitcnt lgkmcnt(4)
  v_mfma_f32_16x16x32_bf16 v[16:19], v[124:127], v[84:87], v[16:19]
  s_barrier
  ds_read_b128 v[104:107], v5 offset:49152
  s_waitcnt lgkmcnt(4)
  v_mfma_f32_16x16x32_bf16 v[20:23], v[128:131], v[84:87], v[20:23]
  ds_read_b128 v[108:111], v5 offset:50176
  s_waitcnt lgkmcnt(4)
  v_mfma_f32_16x16x32_bf16 v[24:27], v[132:135], v[84:87], v[24:27]
  ds_read_b128 v[112:115], v5 offset:51200
  s_waitcnt lgkmcnt(4)
  v_mfma_f32_16x16x32_bf16 v[28:31], v[136:139], v[84:87], v[28:31]
  ds_read_b128 v[116:119], v5 offset:52224
  s_waitcnt lgkmcnt(4)
  v_mfma_f32_16x16x32_bf16 v[32:35], v[140:143], v[84:87], v[32:35]
  ds_read_b128 v[120:123], v5 offset:53248
  s_waitcnt vmcnt(3)
  s_waitcnt lgkmcnt(4)
  v_mfma_f32_16x16x32_bf16 v[16:19], v[104:107], v[88:91], v[16:19]
  ds_read_b128 v[124:127], v5 offset:54272
  s_waitcnt lgkmcnt(4)
  v_mfma_f32_16x16x32_bf16 v[20:23], v[108:111], v[88:91], v[20:23]
  ds_read_b128 v[128:131], v5 offset:55296
  s_waitcnt lgkmcnt(4)
  v_mfma_f32_16x16x32_bf16 v[24:27], v[112:115], v[88:91], v[24:27]
  ds_read_b128 v[132:135], v5 offset:56320
  s_waitcnt lgkmcnt(4)
  v_mfma_f32_16x16x32_bf16 v[28:31], v[116:119], v[88:91], v[28:31]
  ds_read_b128 v[136:139], v5 offset:57344
  s_waitcnt lgkmcnt(4)
  v_mfma_f32_16x16x32_bf16 v[32:35], v[120:123], v[88:91], v[32:35]
  ds_read_b128 v[140:143], v5 offset:58368
  s_waitcnt vmcnt(2)
  s_waitcnt lgkmcnt(4)
  v_mfma_f32_16x16x32_bf16 v[16:19], v[124:127], v[92:95], v[16:19]
  ds_read_b128 v[104:107], v5 offset:59392
  s_waitcnt lgkmcnt(4)
  v_mfma_f32_16x16x32_bf16 v[20:23], v[128:131], v[92:95], v[20:23]
  ds_read_b128 v[108:111], v5 offset:60416
  s_waitcnt lgkmcnt(4)
  v_mfma_f32_16x16x32_bf16 v[24:27], v[132:135], v[92:95], v[24:27]
  ds_read_b128 v[112:115], v5 offset:61440
  s_waitcnt lgkmcnt(4)
  v_mfma_f32_16x16x32_bf16 v[28:31], v[136:139], v[92:95], v[28:31]
  ds_read_b128 v[116:119], v5 offset:62464
  s_waitcnt lgkmcnt(4)
  v_mfma_f32_16x16x32_bf16 v[32:35], v[140:143], v[92:95], v[32:35]
  ds_read_b128 v[120:123], v5 offset:63488
  s_waitcnt vmcnt(1)
  s_waitcnt lgkmcnt(4)
  v_mfma_f32_16x16x32_bf16 v[16:19], v[104:107], v[96:99], v[16:19]
  ds_read_b128 v[124:127], v5 offset:64512
  s_waitcnt lgkmcnt(4)
  v_mfma_f32_16x16x32_bf16 v[20:23], v[108:111], v[96:99], v[20:23]
  ds_read_b128 v[128:131], v8 offset:0
  s_waitcnt lgkmcnt(4)
  v_mfma_f32_16x16x32_bf16 v[24:27], v[112:115], v[96:99], v[24:27]
  ds_read_b128 v[132:135], v8 offset:1024
  s_waitcnt lgkmcnt(4)
  v_mfma_f32_16x16x32_bf16 v[28:31], v[116:119], v[96:99], v[28:31]
  ds_read_b128 v[136:139], v8 offset:2048
  s_waitcnt lgkmcnt(4)
  v_mfma_f32_16x16x32_bf16 v[32:35], v[120:123], v[96:99], v[32:35]
  ds_read_b128 v[140:143], v8 offset:3072
  s_waitcnt vmcnt(0)
  s_waitcnt lgkmcnt(4)
  v_mfma_f32_16x16x32_bf16 v[16:19], v[124:127], v[100:103], v[16:19]
  s_waitcnt lgkmcnt(3)
  v_mfma_f32_16x16x32_bf16 v[20:23], v[128:131], v[100:103], v[20:23]
  s_waitcnt lgkmcnt(2)
  v_mfma_f32_16x16x32_bf16 v[24:27], v[132:135], v[100:103], v[24:27]
  s_waitcnt lgkmcnt(1)
  v_mfma_f32_16x16x32_bf16 v[28:31], v[136:139], v[100:103], v[28:31]
  s_waitcnt lgkmcnt(0)
  v_mfma_f32_16x16x32_bf16 v[32:35], v[140:143], v[100:103], v[32:35]
  v_lshlrev_b32 v10, 4, v4
  v_add_u32 v10, 159744, v10
  ds_read_b128 v[48:51], v10 offset:0
  ds_read_b128 v[52:55], v10 offset:64
  ds_read_b128 v[56:59], v10 offset:128
  ds_read_b128 v[60:63], v10 offset:192
  ds_read_b128 v[64:67], v10 offset:256
  v_lshlrev_b32 v160, 16, v246
  v_and_b32 v161, 0xffff0000, v246
  v_lshlrev_b32 v162, 16, v247
  v_and_b32 v163, 0xffff0000, v247
  v_lshlrev_b32 v164, 16, v248
  v_and_b32 v165, 0xffff0000, v248
  v_lshlrev_b32 v166, 16, v249
  v_and_b32 v167, 0xffff0000, v249
  v_lshlrev_b32 v168, 16, v250
  v_and_b32 v169, 0xffff0000, v250
  v_lshlrev_b32 v170, 16, v251
  v_and_b32 v171, 0xffff0000, v251
  v_lshlrev_b32 v172, 16, v252
  v_and_b32 v173, 0xffff0000, v252
  v_lshlrev_b32 v174, 16, v253
  v_and_b32 v175, 0xffff0000, v253
  v_lshlrev_b32 v176, 16, v254
  v_and_b32 v177, 0xffff0000, v254
  v_lshlrev_b32 v178, 16, v255
  v_and_b32 v179, 0xffff0000, v255
  s_waitcnt lgkmcnt(0)
  v_fmac_f32 v160, v48, v16
  v_fmac_f32 v161, v49, v17
  v_fmac_f32 v162, v50, v18
  v_fmac_f32 v163, v51, v19
  v_fmac_f32 v164, v52, v20
  v_fmac_f32 v165, v53, v21
  v_fmac_f32 v166, v54, v22
  v_fmac_f32 v167, v55, v23
  v_fmac_f32 v168, v56, v24
  v_fmac_f32 v169, v57, v25
  v_fmac_f32 v170, v58, v26
  v_fmac_f32 v171, v59, v27
  v_fmac_f32 v172, v60, v28
  v_fmac_f32 v173, v61, v29
  v_fmac_f32 v174, v62, v30
  v_fmac_f32 v175, v63, v31
  v_fmac_f32 v176, v64, v32
  v_fmac_f32 v177, v65, v33
  v_fmac_f32 v178, v66, v34
  v_fmac_f32 v179, v67, v35
  s_mov_b32 s40, s34
  s_mov_b32 s41, s35
  s_mov_b32 s42, 0x280000
  s_mov_b32 s43, 0x20000
  v_cvt_pk_bf16_f32 v48, v160, v161
  v_cvt_pk_bf16_f32 v49, v162, v163
  buffer_store_dwordx2 v[48:49], v6, s[40:43], 0 offen offset:0
  v_cvt_pk_bf16_f32 v50, v164, v165
  v_cvt_pk_bf16_f32 v51, v166, v167
  buffer_store_dwordx2 v[50:51], v6, s[40:43], 0 offen offset:32
  v_cvt_pk_bf16_f32 v52, v168, v169
  v_cvt_pk_bf16_f32 v53, v170, v171
  buffer_store_dwordx2 v[52:53], v6, s[40:43], 0 offen offset:64
  v_cvt_pk_bf16_f32 v54, v172, v173
  v_cvt_pk_bf16_f32 v55, v174, v175
  buffer_store_dwordx2 v[54:55], v6, s[40:43], 0 offen offset:96
  v_cvt_pk_bf16_f32 v56, v176, v177
  v_cvt_pk_bf16_f32 v57, v178, v179
  buffer_store_dwordx2 v[56:57], v6, s[40:43], 0 offen offset:128
  s_endpgm
adaLN_cond__mha_block__glu_gated_glu__prompt_prod384:
  v_lshlrev_b32 v5, 4, v1
  s_sub_u32 s60, s12, 4
  s_mul_i32 s61, s60, 6144
  s_mul_i32 s62, s7, 245760
  s_add_u32 s62, s62, s61
  s_add_u32 s62, s62, 2748416
  s_add_u32 m0, s61, 0
  s_add_u32 s63, s62, 0
  buffer_load_dwordx4 v5, s[8:11], s63 offen sc1 lds
  s_add_u32 m0, s61, 1024
  s_add_u32 s63, s62, 1024
  buffer_load_dwordx4 v5, s[8:11], s63 offen sc1 lds
  s_add_u32 m0, s61, 2048
  s_add_u32 s63, s62, 2048
  buffer_load_dwordx4 v5, s[8:11], s63 offen sc1 lds
  s_add_u32 m0, s61, 3072
  s_add_u32 s63, s62, 3072
  buffer_load_dwordx4 v5, s[8:11], s63 offen sc1 lds
  s_add_u32 m0, s61, 4096
  s_add_u32 s63, s62, 4096
  buffer_load_dwordx4 v5, s[8:11], s63 offen sc1 lds
  s_add_u32 m0, s61, 5120
  s_add_u32 s63, s62, 5120
  buffer_load_dwordx4 v5, s[8:11], s63 offen sc1 lds
  s_add_u32 m0, s61, 24576
  s_add_u32 s63, s62, 24576
  buffer_load_dwordx4 v5, s[8:11], s63 offen sc1 lds
  s_add_u32 m0, s61, 25600
  s_add_u32 s63, s62, 25600
  buffer_load_dwordx4 v5, s[8:11], s63 offen sc1 lds
  s_add_u32 m0, s61, 26624
  s_add_u32 s63, s62, 26624
  buffer_load_dwordx4 v5, s[8:11], s63 offen sc1 lds
  s_add_u32 m0, s61, 27648
  s_add_u32 s63, s62, 27648
  buffer_load_dwordx4 v5, s[8:11], s63 offen sc1 lds
  s_add_u32 m0, s61, 28672
  s_add_u32 s63, s62, 28672
  buffer_load_dwordx4 v5, s[8:11], s63 offen sc1 lds
  s_add_u32 m0, s61, 29696
  s_add_u32 s63, s62, 29696
  buffer_load_dwordx4 v5, s[8:11], s63 offen sc1 lds
  s_cmp_ge_u32 s2, 240
  s_cbranch_scc1 adaLN_cond__mha_block__glu_gated_glu__prompt_noub94
  s_sub_u32 s54, s12, 4
  s_lshl_b32 s52, s2, 2
  s_add_u32 s52, s52, s54
  s_mul_i32 s53, s52, 104858
  s_lshr_b32 s53, s53, 20
  s_mul_i32 s55, s53, 10
  s_sub_u32 s52, s52, s55
  s_mul_i32 s55, s53, 174763
  s_lshr_b32 s55, s55, 20
  s_mul_i32 s56, s55, 6
  s_sub_u32 s56, s53, s56
  s_mul_i32 s57, s55, 245760
  s_mul_i32 s58, s52, 24576
  s_add_u32 s57, s57, s58
  s_lshl_b32 s58, s56, 10
  s_add_u32 s57, s57, s58
  s_add_u32 s57, s57, 2748416
  v_lshlrev_b32 v9, 4, v1
  buffer_load_dwordx4 v[32:35], v9, s[8:11], s57 offen sc1
  s_add_u32 s57, s57, 6144
  buffer_load_dwordx4 v[36:39], v9, s[8:11], s57 offen sc1
  s_add_u32 s57, s57, 6144
  buffer_load_dwordx4 v[40:43], v9, s[8:11], s57 offen sc1
  s_add_u32 s57, s57, 6144
  buffer_load_dwordx4 v[44:47], v9, s[8:11], s57 offen sc1
  s_add_u32 s57, s57, 6144
  v_and_b32 v3, 31, v1
  v_lshrrev_b32 v4, 5, v1
  v_cmp_eq_u32 vcc, 0, v3
  v_mov_b32 v10, 7680
  v_mov_b32 v6, 10240
  v_cndmask_b32 v10, v10, v6, vcc
  v_lshl_add_u32 v10, v4, 5, v10
  v_mov_b32 v6, 0
  v_cndmask_b32_e64 v6, v6, 1.0, vcc
  s_lshl_b32 s58, s52, 8
  s_add_u32 s58, s58, 50176
  buffer_load_dwordx4 v[72:75], v10, s[8:11], s58 offen offset:0 sc1
  buffer_load_dwordx4 v[76:79], v10, s[8:11], s58 offen offset:16 sc1
  buffer_load_dwordx4 v[80:83], v10, s[8:11], s58 offen offset:64 sc1
  buffer_load_dwordx4 v[84:87], v10, s[8:11], s58 offen offset:80 sc1
  buffer_load_dwordx4 v[88:91], v10, s[8:11], s58 offen offset:128 sc1
  buffer_load_dwordx4 v[92:95], v10, s[8:11], s58 offen offset:144 sc1
  buffer_load_dwordx4 v[96:99], v10, s[8:11], s58 offen offset:192 sc1
  buffer_load_dwordx4 v[100:103], v10, s[8:11], s58 offen offset:208 sc1
  v_mov_b32 v16, 0
  v_mov_b32 v17, 0
  v_mov_b32 v18, 0
  v_mov_b32 v19, 0
  v_mov_b32 v20, 0
  v_mov_b32 v21, 0
  v_mov_b32 v22, 0
  v_mov_b32 v23, 0
  v_mov_b32 v24, 0
  v_mov_b32 v25, 0
  v_mov_b32 v26, 0
  v_mov_b32 v27, 0
  v_mov_b32 v28, 0
  v_mov_b32 v29, 0
  v_mov_b32 v30, 0
  v_mov_b32 v31, 0
  s_waitcnt vmcnt(0)
  v_add_f32 v72, v72, v6
  v_add_f32 v73, v73, v6
  v_add_f32 v74, v74, v6
  v_add_f32 v75, v75, v6
  v_add_f32 v76, v76, v6
  v_add_f32 v77, v77, v6
  v_add_f32 v78, v78, v6
  v_add_f32 v79, v79, v6
  v_cvt_pk_bf16_f32 v72, v72, v73
  v_cvt_pk_bf16_f32 v73, v74, v75
  v_cvt_pk_bf16_f32 v74, v76, v77
  v_cvt_pk_bf16_f32 v75, v78, v79
  s_nop 1
  v_mfma_f32_32x32x16_bf16 v[16:31], v[32:35], v[72:75], v[16:31]
  v_add_f32 v80, v80, v6
  v_add_f32 v81, v81, v6
  v_add_f32 v82, v82, v6
  v_add_f32 v83, v83, v6
  v_add_f32 v84, v84, v6
  v_add_f32 v85, v85, v6
  v_add_f32 v86, v86, v6
  v_add_f32 v87, v87, v6
  v_cvt_pk_bf16_f32 v80, v80, v81
  v_cvt_pk_bf16_f32 v81, v82, v83
  v_cvt_pk_bf16_f32 v82, v84, v85
  v_cvt_pk_bf16_f32 v83, v86, v87
  s_nop 1
  v_mfma_f32_32x32x16_bf16 v[16:31], v[36:39], v[80:83], v[16:31]
  v_add_f32 v88, v88, v6
  v_add_f32 v89, v89, v6
  v_add_f32 v90, v90, v6
  v_add_f32 v91, v91, v6
  v_add_f32 v92, v92, v6
  v_add_f32 v93, v93, v6
  v_add_f32 v94, v94, v6
  v_add_f32 v95, v95, v6
  v_cvt_pk_bf16_f32 v88, v88, v89
  v_cvt_pk_bf16_f32 v89, v90, v91
  v_cvt_pk_bf16_f32 v90, v92, v93
  v_cvt_pk_bf16_f32 v91, v94, v95
  s_nop 1
  v_mfma_f32_32x32x16_bf16 v[16:31], v[40:43], v[88:91], v[16:31]
  v_add_f32 v96, v96, v6
  v_add_f32 v97, v97, v6
  v_add_f32 v98, v98, v6
  v_add_f32 v99, v99, v6
  v_add_f32 v100, v100, v6
  v_add_f32 v101, v101, v6
  v_add_f32 v102, v102, v6
  v_add_f32 v103, v103, v6
  v_cvt_pk_bf16_f32 v96, v96, v97
  v_cvt_pk_bf16_f32 v97, v98, v99
  v_cvt_pk_bf16_f32 v98, v100, v101
  v_cvt_pk_bf16_f32 v99, v102, v103
  s_nop 1
  v_mfma_f32_32x32x16_bf16 v[16:31], v[44:47], v[96:99], v[16:31]
  s_lshl_b32 s58, s54, 8
  s_add_u32 s58, s58, 152576
  v_lshlrev_b32 v8, 4, v4
  v_lshl_add_u32 v8, v3, 7, v8
  v_add_u32 v8, s58, v8
  v_cmp_gt_u32 vcc, 2, v3
  s_nop 3
  s_and_saveexec_b64 s[60:61], vcc
  s_nop 0
  ds_write_b128 v8, v[16:19] offset:0
  ds_write_b128 v8, v[20:23] offset:32
  ds_write_b128 v8, v[24:27] offset:64
  ds_write_b128 v8, v[28:31] offset:96
  s_mov_b64 exec, s[60:61]
  s_waitcnt lgkmcnt(0)
  v_lshlrev_b32 v8, 2, v1
  v_add_u32 v9, s58, v8
  ds_read_b32 v10, v9
  s_mov_b32 s57, 0xbfb8aa3b
  s_cmp_lt_u32 s56, 3
  s_cselect_b32 s57, s57, 1.0
  s_lshl_b32 s58, s53, 8
  s_add_u32 s58, s58, 65536
  s_waitcnt lgkmcnt(0)
  v_mul_f32 v10, s57, v10
  buffer_atomic_add_f32 v10, v8, s[8:11], s58 offen
  s_waitcnt vmcnt(0)
adaLN_cond__mha_block__glu_gated_glu__prompt_noub94:
  s_barrier
  v_lshlrev_b32 v5, 4, v1
  s_sub_u32 s60, s12, 4
  s_mul_i32 s61, s60, 6144
  s_mul_i32 s62, s7, 245760
  s_add_u32 s62, s62, s61
  s_add_u32 s62, s62, 2748416
  s_add_u32 m0, s61, 49152
  s_add_u32 s63, s62, 49152
  buffer_load_dwordx4 v5, s[8:11], s63 offen sc1 lds
  s_add_u32 m0, s61, 50176
  s_add_u32 s63, s62, 50176
  buffer_load_dwordx4 v5, s[8:11], s63 offen sc1 lds
  s_add_u32 m0, s61, 51200
  s_add_u32 s63, s62, 51200
  buffer_load_dwordx4 v5, s[8:11], s63 offen sc1 lds
  s_add_u32 m0, s61, 52224
  s_add_u32 s63, s62, 52224
  buffer_load_dwordx4 v5, s[8:11], s63 offen sc1 lds
  s_add_u32 m0, s61, 53248
  s_add_u32 s63, s62, 53248
  buffer_load_dwordx4 v5, s[8:11], s63 offen sc1 lds
  s_add_u32 m0, s61, 54272
  s_add_u32 s63, s62, 54272
  buffer_load_dwordx4 v5, s[8:11], s63 offen sc1 lds
  s_add_u32 m0, s61, 73728
  s_add_u32 s63, s62, 73728
  buffer_load_dwordx4 v5, s[8:11], s63 offen sc1 lds
  s_add_u32 m0, s61, 74752
  s_add_u32 s63, s62, 74752
  buffer_load_dwordx4 v5, s[8:11], s63 offen sc1 lds
  s_add_u32 m0, s61, 75776
  s_add_u32 s63, s62, 75776
  buffer_load_dwordx4 v5, s[8:11], s63 offen sc1 lds
  s_add_u32 m0, s61, 76800
  s_add_u32 s63, s62, 76800
  buffer_load_dwordx4 v5, s[8:11], s63 offen sc1 lds
  s_add_u32 m0, s61, 77824
  s_add_u32 s63, s62, 77824
  buffer_load_dwordx4 v5, s[8:11], s63 offen sc1 lds
  s_add_u32 m0, s61, 78848
  s_add_u32 s63, s62, 78848
  buffer_load_dwordx4 v5, s[8:11], s63 offen sc1 lds
  s_add_u32 m0, s61, 98304
  s_add_u32 s63, s62, 98304
  buffer_load_dwordx4 v5, s[8:11], s63 offen sc1 lds
  s_add_u32 m0, s61, 99328
  s_add_u32 s63, s62, 99328
  buffer_load_dwordx4 v5, s[8:11], s63 offen sc1 lds
  s_add_u32 m0, s61, 100352
  s_add_u32 s63, s62, 100352
  buffer_load_dwordx4 v5, s[8:11], s63 offen sc1 lds
  s_add_u32 m0, s61, 101376
  s_add_u32 s63, s62, 101376
  buffer_load_dwordx4 v5, s[8:11], s63 offen sc1 lds
  s_add_u32 m0, s61, 102400
  s_add_u32 s63, s62, 102400
  buffer_load_dwordx4 v5, s[8:11], s63 offen sc1 lds
  s_add_u32 m0, s61, 103424
  s_add_u32 s63, s62, 103424
  buffer_load_dwordx4 v5, s[8:11], s63 offen sc1 lds
  s_add_u32 m0, s61, 122880
  s_add_u32 s63, s62, 122880
  buffer_load_dwordx4 v5, s[8:11], s63 offen sc1 lds
  s_add_u32 m0, s61, 123904
  s_add_u32 s63, s62, 123904
  buffer_load_dwordx4 v5, s[8:11], s63 offen sc1 lds
  s_add_u32 m0, s61, 124928
  s_add_u32 s63, s62, 124928
  buffer_load_dwordx4 v5, s[8:11], s63 offen sc1 lds
  s_add_u32 m0, s61, 125952
  s_add_u32 s63, s62, 125952
  buffer_load_dwordx4 v5, s[8:11], s63 offen sc1 lds
  s_add_u32 m0, s61, 126976
  s_add_u32 s63, s62, 126976
  buffer_load_dwordx4 v5, s[8:11], s63 offen sc1 lds
  s_add_u32 m0, s61, 128000
  s_add_u32 s63, s62, 128000
  buffer_load_dwordx4 v5, s[8:11], s63 offen sc1 lds
  s_waitcnt vmcnt(30)
  s_barrier
  s_waitcnt vmcnt(24)
  s_barrier
  s_waitcnt vmcnt(18)
  s_barrier
  s_add_u32 m0, s61, 0
  s_add_u32 s63, s62, 147456
  buffer_load_dwordx4 v5, s[8:11], s63 offen sc1 lds
  s_add_u32 m0, s61, 1024
  s_add_u32 s63, s62, 148480
  buffer_load_dwordx4 v5, s[8:11], s63 offen sc1 lds
  s_add_u32 m0, s61, 2048
  s_add_u32 s63, s62, 149504
  buffer_load_dwordx4 v5, s[8:11], s63 offen sc1 lds
  s_add_u32 m0, s61, 3072
  s_add_u32 s63, s62, 150528
  buffer_load_dwordx4 v5, s[8:11], s63 offen sc1 lds
  s_add_u32 m0, s61, 4096
  s_add_u32 s63, s62, 151552
  buffer_load_dwordx4 v5, s[8:11], s63 offen sc1 lds
  s_add_u32 m0, s61, 5120
  s_add_u32 s63, s62, 152576
  buffer_load_dwordx4 v5, s[8:11], s63 offen sc1 lds
  s_waitcnt vmcnt(18)
  s_barrier
  s_add_u32 m0, s61, 24576
  s_add_u32 s63, s62, 172032
  buffer_load_dwordx4 v5, s[8:11], s63 offen sc1 lds
  s_add_u32 m0, s61, 25600
  s_add_u32 s63, s62, 173056
  buffer_load_dwordx4 v5, s[8:11], s63 offen sc1 lds
  s_add_u32 m0, s61, 26624
  s_add_u32 s63, s62, 174080
  buffer_load_dwordx4 v5, s[8:11], s63 offen sc1 lds
  s_add_u32 m0, s61, 27648
  s_add_u32 s63, s62, 175104
  buffer_load_dwordx4 v5, s[8:11], s63 offen sc1 lds
  s_add_u32 m0, s61, 28672
  s_add_u32 s63, s62, 176128
  buffer_load_dwordx4 v5, s[8:11], s63 offen sc1 lds
  s_add_u32 m0, s61, 29696
  s_add_u32 s63, s62, 177152
  buffer_load_dwordx4 v5, s[8:11], s63 offen sc1 lds
  s_waitcnt vmcnt(18)
  s_barrier
  s_add_u32 m0, s61, 49152
  s_add_u32 s63, s62, 196608
  buffer_load_dwordx4 v5, s[8:11], s63 offen sc1 lds
  s_add_u32 m0, s61, 50176
  s_add_u32 s63, s62, 197632
  buffer_load_dwordx4 v5, s[8:11], s63 offen sc1 lds
  s_add_u32 m0, s61, 51200
  s_add_u32 s63, s62, 198656
  buffer_load_dwordx4 v5, s[8:11], s63 offen sc1 lds
  s_add_u32 m0, s61, 52224
  s_add_u32 s63, s62, 199680
  buffer_load_dwordx4 v5, s[8:11], s63 offen sc1 lds
  s_add_u32 m0, s61, 53248
  s_add_u32 s63, s62, 200704
  buffer_load_dwordx4 v5, s[8:11], s63 offen sc1 lds
  s_add_u32 m0, s61, 54272
  s_add_u32 s63, s62, 201728
  buffer_load_dwordx4 v5, s[8:11], s63 offen sc1 lds
  s_waitcnt vmcnt(18)
  s_barrier
  s_cmp_lg_u32 s12, 4
  s_cbranch_scc1 adaLN_cond__mha_block__glu_gated_glu__prompt_noubd95
  v_mov_b32 v6, 1
  v_mov_b32 v7, 44288
  s_mov_b32 s49, 0
  s_mov_b32 s50, 0
adaLN_cond__mha_block__glu_gated_glu__prompt_poll96:
  buffer_load_dword v8, v7, s[8:11], s49 offen sc1
  s_waitcnt vmcnt(0)
  v_cmp_lt_u32 vcc, v8, v6
  s_nop 3
  s_cmp_eq_u64 vcc, 0
  s_cbranch_scc1 adaLN_cond__mha_block__glu_gated_glu__prompt_polled97
  s_add_u32 s50, s50, 1
  s_cmp_ge_u32 s50, 200000
  s_cbranch_scc1 adaLN_cond__mha_block__glu_gated_glu__prompt_polled97
  s_sleep 2
  s_branch adaLN_cond__mha_block__glu_gated_glu__prompt_poll96
adaLN_cond__mha_block__glu_gated_glu__prompt_polled97:
  s_mul_i32 s63, s7, 1536
  s_add_u32 s63, s63, 65536
  s_mov_b32 m0, 147456
  s_nop 0
  buffer_load_dwordx4 v5, s[8:11], s63 offen sc1 lds
  s_add_u32 s63, s63, 1024
  s_mov_b32 m0, 148480
  s_nop 0
  buffer_load_dwordx4 v5, s[8:11], s63 offen sc1 lds
adaLN_cond__mha_block__glu_gated_glu__prompt_noubd95:
  s_add_u32 m0, s61, 73728
  s_add_u32 s63, s62, 221184
  buffer_load_dwordx4 v5, s[8:11], s63 offen sc1 lds
  s_add_u32 m0, s61, 74752
  s_add_u32 s63, s62, 222208
  buffer_load_dwordx4 v5, s[8:11], s63 offen sc1 lds
  s_add_u32 m0, s61, 75776
  s_add_u32 s63, s62, 223232
  buffer_load_dwordx4 v5, s[8:11], s63 offen sc1 lds
  s_add_u32 m0, s61, 76800
  s_add_u32 s63, s62, 224256
  buffer_load_dwordx4 v5, s[8:11], s63 offen sc1 lds
  s_add_u32 m0, s61, 77824
  s_add_u32 s63, s62, 225280
  buffer_load_dwordx4 v5, s[8:11], s63 offen sc1 lds
  s_add_u32 m0, s61, 78848
  s_add_u32 s63, s62, 226304
  buffer_load_dwordx4 v5, s[8:11], s63 offen sc1 lds
  s_waitcnt vmcnt(18)
  s_barrier
  s_waitcnt vmcnt(12)
  s_barrier
  s_waitcnt vmcnt(6)
  s_barrier
  s_waitcnt vmcnt(0)
  s_barrier
  s_mul_i32 s64, s60, 5120
  s_mul_i32 s65, s5, 245760
  s_add_u32 s65, s65, s64
  s_add_u32 s65, s65, 7499776
  s_lshr_b32 s66, s14, 3
  s_mul_i32 s66, s66, 0
  s_lshr_b32 s66, s66, 2
  s_mul_i32 s67, s66, 20480
  s_add_u32 s67, s67, s65
  s_sub_u32 s68, s67, 245760
  s_sub_u32 s69, 12, s66
  s_cmp_lg_u32 s12, 7
  s_cbranch_scc1 adaLN_cond__mha_block__glu_gated_glu__prompt_nov598
  s_movk_i32 s52, 3277
  v_mul_u32_u24 v6, s52, v1
  v_lshrrev_b32 v6, 16, v6
  v_mad_i32_i24 v7, v6, -16, v1
  v_mad_i32_i24 v7, v6, -4, v7
  v_mov_b32 v8, 12800
  v_mov_b32 v10, 0
  s_mul_i32 s52, s5, 320
  s_add_u32 s52, s52, 50176
  v_lshl_add_u32 v8, v7, 4, v8
  buffer_load_dwordx4 v[12:15], v8, s[8:11], s52 offen sc1
  s_waitcnt vmcnt(0)
  v_add_f32 v12, v12, v10
  v_add_f32 v13, v13, v10
  v_add_f32 v14, v14, v10
  v_add_f32 v15, v15, v10
  v_lshlrev_b32 v9, 4, v1
  v_add_u32 v9, 159744, v9
  v_cmp_gt_u32 vcc, 20, v1
  s_nop 3
  s_and_saveexec_b64 s[52:53], vcc
  ds_write_b128 v9, v[12:15]
  s_mov_b64 exec, s[52:53]
  s_waitcnt lgkmcnt(0)
  v_lshlrev_b32 v5, 4, v1
adaLN_cond__mha_block__glu_gated_glu__prompt_nov598:
  s_cmp_le_u32 s69, 0
  s_cselect_b32 s63, s68, s67
  s_add_u32 s63, s63, 0
  s_add_u32 m0, s64, 0
  s_nop 0
  buffer_load_dwordx4 v5, s[8:11], s63 offen sc1 lds
  s_cmp_le_u32 s69, 0
  s_cselect_b32 s63, s68, s67
  s_add_u32 s63, s63, 1024
  s_add_u32 m0, s64, 1024
  s_nop 0
  buffer_load_dwordx4 v5, s[8:11], s63 offen sc1 lds
  s_cmp_le_u32 s69, 0
  s_cselect_b32 s63, s68, s67
  s_add_u32 s63, s63, 2048
  s_add_u32 m0, s64, 2048
  s_nop 0
  buffer_load_dwordx4 v5, s[8:11], s63 offen sc1 lds
  s_cmp_le_u32 s69, 0
  s_cselect_b32 s63, s68, s67
  s_add_u32 s63, s63, 3072
  s_add_u32 m0, s64, 3072
  s_nop 0
  buffer_load_dwordx4 v5, s[8:11], s63 offen sc1 lds
  s_cmp_le_u32 s69, 0
  s_cselect_b32 s63, s68, s67
  s_add_u32 s63, s63, 4096
  s_add_u32 m0, s64, 4096
  s_nop 0
  buffer_load_dwordx4 v5, s[8:11], s63 offen sc1 lds
  s_cmp_le_u32 s69, 1
  s_cselect_b32 s63, s68, s67
  s_add_u32 s63, s63, 20480
  s_add_u32 m0, s64, 20480
  s_nop 0
  buffer_load_dwordx4 v5, s[8:11], s63 offen sc1 lds
  s_cmp_le_u32 s69, 1
  s_cselect_b32 s63, s68, s67
  s_add_u32 s63, s63, 21504
  s_add_u32 m0, s64, 21504
  s_nop 0
  buffer_load_dwordx4 v5, s[8:11], s63 offen sc1 lds
  s_cmp_le_u32 s69, 1
  s_cselect_b32 s63, s68, s67
  s_add_u32 s63, s63, 22528
  s_add_u32 m0, s64, 22528
  s_nop 0
  buffer_load_dwordx4 v5, s[8:11], s63 offen sc1 lds
  s_cmp_le_u32 s69, 1
  s_cselect_b32 s63, s68, s67
  s_add_u32 s63, s63, 23552
  s_add_u32 m0, s64, 23552
  s_nop 0
  buffer_load_dwordx4 v5, s[8:11], s63 offen sc1 lds
  s_cmp_le_u32 s69, 1
  s_cselect_b32 s63, s68, s67
  s_add_u32 s63, s63, 24576
  s_add_u32 m0, s64, 24576
  s_nop 0
  buffer_load_dwordx4 v5, s[8:11], s63 offen sc1 lds
  s_cmp_le_u32 s69, 2
  s_cselect_b32 s63, s68, s67
  s_add_u32 s63, s63, 40960
  s_add_u32 m0, s64, 98304
  s_nop 0
  buffer_load_dwordx4 v5, s[8:11], s63 offen sc1 lds
  s_cmp_le_u32 s69, 2
  s_cselect_b32 s63, s68, s67
  s_add_u32 s63, s63, 41984
  s_add_u32 m0, s64, 99328
  s_nop 0
  buffer_load_dwordx4 v5, s[8:11], s63 offen sc1 lds
  s_cmp_le_u32 s69, 2
  s_cselect_b32 s63, s68, s67
  s_add_u32 s63, s63, 43008
  s_add_u32 m0, s64, 100352
  s_nop 0
  buffer_load_dwordx4 v5, s[8:11], s63 offen sc1 lds
  s_cmp_le_u32 s69, 2
  s_cselect_b32 s63, s68, s67
  s_add_u32 s63, s63, 44032
  s_add_u32 m0, s64, 101376
  s_nop 0
  buffer_load_dwordx4 v5, s[8:11], s63 offen sc1 lds
  s_cmp_le_u32 s69, 2
  s_cselect_b32 s63, s68, s67
  s_add_u32 s63, s63, 45056
  s_add_u32 m0, s64, 102400
  s_nop 0
  buffer_load_dwordx4 v5, s[8:11], s63 offen sc1 lds
  s_cmp_le_u32 s69, 3
  s_cselect_b32 s63, s68, s67
  s_add_u32 s63, s63, 61440
  s_add_u32 m0, s64, 118784
  s_nop 0
  buffer_load_dwordx4 v5, s[8:11], s63 offen sc1 lds
  s_cmp_le_u32 s69, 3
  s_cselect_b32 s63, s68, s67
  s_add_u32 s63, s63, 62464
  s_add_u32 m0, s64, 119808
  s_nop 0
  buffer_load_dwordx4 v5, s[8:11], s63 offen sc1 lds
  s_cmp_le_u32 s69, 3
  s_cselect_b32 s63, s68, s67
  s_add_u32 s63, s63, 63488
  s_add_u32 m0, s64, 120832
  s_nop 0
  buffer_load_dwordx4 v5, s[8:11], s63 offen sc1 lds
  s_cmp_le_u32 s69, 3
  s_cselect_b32 s63, s68, s67
  s_add_u32 s63, s63, 64512
  s_add_u32 m0, s64, 121856
  s_nop 0
  buffer_load_dwordx4 v5, s[8:11], s63 offen sc1 lds
  s_cmp_le_u32 s69, 3
  s_cselect_b32 s63, s68, s67
  s_add_u32 s63, s63, 65536
  s_add_u32 m0, s64, 122880
  s_nop 0
  buffer_load_dwordx4 v5, s[8:11], s63 offen sc1 lds
  s_barrier
  s_cmp_le_u32 s69, 4
  s_cselect_b32 s63, s68, s67
  s_add_u32 s63, s63, 81920
  s_add_u32 m0, s64, 49152
  s_nop 0
  buffer_load_dwordx4 v5, s[8:11], s63 offen sc1 lds
  s_cmp_le_u32 s69, 4
  s_cselect_b32 s63, s68, s67
  s_add_u32 s63, s63, 82944
  s_add_u32 m0, s64, 50176
  s_nop 0
  buffer_load_dwordx4 v5, s[8:11], s63 offen sc1 lds
  s_cmp_le_u32 s69, 4
  s_cselect_b32 s63, s68, s67
  s_add_u32 s63, s63, 83968
  s_add_u32 m0, s64, 51200
  s_nop 0
  buffer_load_dwordx4 v5, s[8:11], s63 offen sc1 lds
  s_cmp_le_u32 s69, 4
  s_cselect_b32 s63, s68, s67
  s_add_u32 s63, s63, 84992
  s_add_u32 m0, s64, 52224
  s_nop 0
  buffer_load_dwordx4 v5, s[8:11], s63 offen sc1 lds
  s_cmp_le_u32 s69, 4
  s_cselect_b32 s63, s68, s67
  s_add_u32 s63, s63, 86016
  s_add_u32 m0, s64, 53248
  s_nop 0
  buffer_load_dwordx4 v5, s[8:11], s63 offen sc1 lds
  s_cmp_le_u32 s69, 5
  s_cselect_b32 s63, s68, s67
  s_add_u32 s63, s63, 102400
  s_add_u32 m0, s64, 69632
  s_nop 0
  buffer_load_dwordx4 v5, s[8:11], s63 offen sc1 lds
  s_cmp_le_u32 s69, 5
  s_cselect_b32 s63, s68, s67
  s_add_u32 s63, s63, 103424
  s_add_u32 m0, s64, 70656
  s_nop 0
  buffer_load_dwordx4 v5, s[8:11], s63 offen sc1 lds
  s_cmp_le_u32 s69, 5
  s_cselect_b32 s63, s68, s67
  s_add_u32 s63, s63, 104448
  s_add_u32 m0, s64, 71680
  s_nop 0
  buffer_load_dwordx4 v5, s[8:11], s63 offen sc1 lds
  s_cmp_le_u32 s69, 5
  s_cselect_b32 s63, s68, s67
  s_add_u32 s63, s63, 105472
  s_add_u32 m0, s64, 72704
  s_nop 0
  buffer_load_dwordx4 v5, s[8:11], s63 offen sc1 lds
  s_cmp_le_u32 s69, 5
  s_cselect_b32 s63, s68, s67
  s_add_u32 s63, s63, 106496
  s_add_u32 m0, s64, 73728
  s_nop 0
  buffer_load_dwordx4 v5, s[8:11], s63 offen sc1 lds
  s_cmp_le_u32 s69, 6
  s_cselect_b32 s63, s68, s67
  s_add_u32 s63, s63, 122880
  s_add_u32 m0, s64, 139264
  s_nop 0
  buffer_load_dwordx4 v5, s[8:11], s63 offen sc1 lds
  s_cmp_le_u32 s69, 6
  s_cselect_b32 s63, s68, s67
  s_add_u32 s63, s63, 123904
  s_add_u32 m0, s64, 140288
  s_nop 0
  buffer_load_dwordx4 v5, s[8:11], s63 offen sc1 lds
  s_cmp_le_u32 s69, 6
  s_cselect_b32 s63, s68, s67
  s_add_u32 s63, s63, 124928
  s_add_u32 m0, s64, 141312
  s_nop 0
  buffer_load_dwordx4 v5, s[8:11], s63 offen sc1 lds
  s_cmp_le_u32 s69, 6
  s_cselect_b32 s63, s68, s67
  s_add_u32 s63, s63, 125952
  s_add_u32 m0, s64, 142336
  s_nop 0
  buffer_load_dwordx4 v5, s[8:11], s63 offen sc1 lds
  s_cmp_le_u32 s69, 6
  s_cselect_b32 s63, s68, s67
  s_add_u32 s63, s63, 126976
  s_add_u32 m0, s64, 143360
  s_nop 0
  buffer_load_dwordx4 v5, s[8:11], s63 offen sc1 lds
  s_waitcnt vmcnt(30)
  s_barrier
  s_waitcnt vmcnt(25)
  s_barrier
  s_waitcnt vmcnt(20)
  s_barrier
  s_cmp_le_u32 s69, 7
  s_cselect_b32 s63, s68, s67
  s_add_u32 s63, s63, 143360
  s_add_u32 m0, s64, 0
  s_nop 0
  buffer_load_dwordx4 v5, s[8:11], s63 offen sc1 lds
  s_cmp_le_u32 s69, 7
  s_cselect_b32 s63, s68, s67
  s_add_u32 s63, s63, 144384
  s_add_u32 m0, s64, 1024
  s_nop 0
  buffer_load_dwordx4 v5, s[8:11], s63 offen sc1 lds
  s_cmp_le_u32 s69, 7
  s_cselect_b32 s63, s68, s67
  s_add_u32 s63, s63, 145408
  s_add_u32 m0, s64, 2048
  s_nop 0
  buffer_load_dwordx4 v5, s[8:11], s63 offen sc1 lds
  s_cmp_le_u32 s69, 7
  s_cselect_b32 s63, s68, s67
  s_add_u32 s63, s63, 146432
  s_add_u32 m0, s64, 3072
  s_nop 0
  buffer_load_dwordx4 v5, s[8:11], s63 offen sc1 lds
  s_cmp_le_u32 s69, 7
  s_cselect_b32 s63, s68, s67
  s_add_u32 s63, s63, 147456
  s_add_u32 m0, s64, 4096
  s_nop 0
  buffer_load_dwordx4 v5, s[8:11], s63 offen sc1 lds
  s_waitcnt vmcnt(20)
  s_barrier
  s_cmp_le_u32 s69, 8
  s_cselect_b32 s63, s68, s67
  s_add_u32 s63, s63, 163840
  s_add_u32 m0, s64, 20480
  s_nop 0
  buffer_load_dwordx4 v5, s[8:11], s63 offen sc1 lds
  s_cmp_le_u32 s69, 8
  s_cselect_b32 s63, s68, s67
  s_add_u32 s63, s63, 164864
  s_add_u32 m0, s64, 21504
  s_nop 0
  buffer_load_dwordx4 v5, s[8:11], s63 offen sc1 lds
  s_cmp_le_u32 s69, 8
  s_cselect_b32 s63, s68, s67
  s_add_u32 s63, s63, 165888
  s_add_u32 m0, s64, 22528
  s_nop 0
  buffer_load_dwordx4 v5, s[8:11], s63 offen sc1 lds
  s_cmp_le_u32 s69, 8
  s_cselect_b32 s63, s68, s67
  s_add_u32 s63, s63, 166912
  s_add_u32 m0, s64, 23552
  s_nop 0
  buffer_load_dwordx4 v5, s[8:11], s63 offen sc1 lds
  s_cmp_le_u32 s69, 8
  s_cselect_b32 s63, s68, s67
  s_add_u32 s63, s63, 167936
  s_add_u32 m0, s64, 24576
  s_nop 0
  buffer_load_dwordx4 v5, s[8:11], s63 offen sc1 lds
  s_waitcnt vmcnt(20)
  s_barrier
  s_cmp_le_u32 s69, 9
  s_cselect_b32 s63, s68, s67
  s_add_u32 s63, s63, 184320
  s_add_u32 m0, s64, 98304
  s_nop 0
  buffer_load_dwordx4 v5, s[8:11], s63 offen sc1 lds
  s_cmp_le_u32 s69, 9
  s_cselect_b32 s63, s68, s67
  s_add_u32 s63, s63, 185344
  s_add_u32 m0, s64, 99328
  s_nop 0
  buffer_load_dwordx4 v5, s[8:11], s63 offen sc1 lds
  s_cmp_le_u32 s69, 9
  s_cselect_b32 s63, s68, s67
  s_add_u32 s63, s63, 186368
  s_add_u32 m0, s64, 100352
  s_nop 0
  buffer_load_dwordx4 v5, s[8:11], s63 offen sc1 lds
  s_cmp_le_u32 s69, 9
  s_cselect_b32 s63, s68, s67
  s_add_u32 s63, s63, 187392
  s_add_u32 m0, s64, 101376
  s_nop 0
  buffer_load_dwordx4 v5, s[8:11], s63 offen sc1 lds
  s_cmp_le_u32 s69, 9
  s_cselect_b32 s63, s68, s67
  s_add_u32 s63, s63, 188416
  s_add_u32 m0, s64, 102400
  s_nop 0
  buffer_load_dwordx4 v5, s[8:11], s63 offen sc1 lds
  s_waitcnt vmcnt(20)
  s_barrier
  s_cmp_le_u32 s69, 10
  s_cselect_b32 s63, s68, s67
  s_add_u32 s63, s63, 204800
  s_add_u32 m0, s64, 118784
  s_nop 0
  buffer_load_dwordx4 v5, s[8:11], s63 offen sc1 lds
  s_cmp_le_u32 s69, 10
  s_cselect_b32 s63, s68, s67
  s_add_u32 s63, s63, 205824
  s_add_u32 m0, s64, 119808
  s_nop 0
  buffer_load_dwordx4 v5, s[8:11], s63 offen sc1 lds
  s_cmp_le_u32 s69, 10
  s_cselect_b32 s63, s68, s67
  s_add_u32 s63, s63, 206848
  s_add_u32 m0, s64, 120832
  s_nop 0
  buffer_load_dwordx4 v5, s[8:11], s63 offen sc1 lds
  s_cmp_le_u32 s69, 10
  s_cselect_b32 s63, s68, s67
  s_add_u32 s63, s63, 207872
  s_add_u32 m0, s64, 121856
  s_nop 0
  buffer_load_dwordx4 v5, s[8:11], s63 offen sc1 lds
  s_cmp_le_u32 s69, 10
  s_cselect_b32 s63, s68, s67
  s_add_u32 s63, s63, 208896
  s_add_u32 m0, s64, 122880
  s_nop 0
  buffer_load_dwordx4 v5, s[8:11], s63 offen sc1 lds
  s_waitcnt vmcnt(20)
  s_barrier
  s_cmp_le_u32 s69, 11
  s_cselect_b32 s63, s68, s67
  s_add_u32 s63, s63, 225280
  s_add_u32 m0, s64, 49152
  s_nop 0
  buffer_load_dwordx4 v5, s[8:11], s63 offen sc1 lds
  s_cmp_le_u32 s69, 11
  s_cselect_b32 s63, s68, s67
  s_add_u32 s63, s63, 226304
  s_add_u32 m0, s64, 50176
  s_nop 0
  buffer_load_dwordx4 v5, s[8:11], s63 offen sc1 lds
  s_cmp_le_u32 s69, 11
  s_cselect_b32 s63, s68, s67
  s_add_u32 s63, s63, 227328
  s_add_u32 m0, s64, 51200
  s_nop 0
  buffer_load_dwordx4 v5, s[8:11], s63 offen sc1 lds
  s_cmp_le_u32 s69, 11
  s_cselect_b32 s63, s68, s67
  s_add_u32 s63, s63, 228352
  s_add_u32 m0, s64, 52224
  s_nop 0
  buffer_load_dwordx4 v5, s[8:11], s63 offen sc1 lds
  s_cmp_le_u32 s69, 11
  s_cselect_b32 s63, s68, s67
  s_add_u32 s63, s63, 229376
  s_add_u32 m0, s64, 53248
  s_nop 0
  buffer_load_dwordx4 v5, s[8:11], s63 offen sc1 lds
  s_waitcnt vmcnt(20)
  s_barrier
  s_waitcnt vmcnt(15)
  s_barrier
  s_waitcnt vmcnt(10)
  s_barrier
  s_waitcnt vmcnt(5)
  s_barrier
  s_waitcnt vmcnt(0)
  s_barrier
  s_endpgm
adaLN_cond__mha_block__glu_gated_glu__prompt_end1:
  s_endpgm
CODE_END:
.section .rodata,"a"
.p2align 6
.amdhsa_kernel adaLN_cond__mha_block__glu_gated_glu__prompt_kernel
  .amdhsa_next_free_vgpr 256
  .amdhsa_next_free_sgpr 102
  .amdhsa_accum_offset 256
  .amdhsa_group_segment_fixed_size 0
  .amdhsa_kernarg_size 96
  .amdhsa_user_sgpr_count 2
  .amdhsa_user_sgpr_kernarg_segment_ptr 1
  .amdhsa_system_sgpr_workgroup_id_x 1
.end_amdhsa_kernel
```
